```python
import torch

def _softmax(x, axis=-1):
    return torch.softmax(x, dim=axis)
def _gelu(x):
    return torch.nn.functional.gelu(x, approximate="tanh")
def _silu(x):
    return torch.nn.functional.silu(x)
def _sigmoid(x):
    return torch.sigmoid(x)
def _layernorm(x, axis=-1, eps=1e-5):
    m = x.mean(dim=axis, keepdim=True)
    v = x.var(dim=axis, keepdim=True, unbiased=False)
    return (x - m) / torch.sqrt(v + eps)
def _scatter_add(tgt, idx, src, axis=0):
    return tgt.clone().index_add_(axis, idx, src)
def _segment_sum(src, seg, n):
    out = torch.zeros((n,) + src.shape[1:], dtype=src.dtype)
    return out.index_add_(0, seg, src)
def _pad(x, pw):
    flat = tuple(v for pair in reversed(pw) for v in pair)
    return torch.nn.functional.pad(x, flat)

kernel_name = 'standalone__mha_block_cached__near_ridge'

def setup_inputs():

    _w = (lambda a: (lambda t: t.to(torch.bfloat16) if t.is_floating_point() else t)(torch.as_tensor(a)))
    B, Sq, D = 16, 144, 576
    H, Sk, Dh = 32, 1024, 128
    return {
        "x": _w((lambda *s: torch.randn(*s, dtype=torch.bfloat16) * 0.8)(B, Sq, D)),
        "k_cache": _w((lambda *s: torch.randn(*s, dtype=torch.bfloat16) * 0.8)(B, H, Sk, Dh)),
        "v_cache": _w((lambda *s: torch.randn(*s, dtype=torch.bfloat16) * 0.05)(B, H, Sk, Dh)),
        "wq": _w((lambda *s: torch.randn(*s, dtype=torch.bfloat16) * 0.8)(D, H * Dh) * (D ** -0.5)),
        "wo": _w((lambda *s: torch.randn(*s, dtype=torch.bfloat16) * 0.05)(H * Dh, D) * ((H * Dh) ** -0.5)),
    }

def reference(x, k_cache, v_cache, wq, wo):
    B, Sq, D = x.shape
    H, Dh = 32, 128
    q = (lambda x, *d: x.permute(*d))((x @ wq).reshape(B, Sq, H, Dh), 0, 2, 1, 3)
    scores = torch.einsum("bhqd,bhkd->bhqk", q, k_cache) * (Dh ** -0.5)
    p = _softmax(scores, axis=-1)
    o = torch.einsum("bhqk,bhkd->bhqd", p, v_cache)
    return (lambda x, *d: x.permute(*d))(o, 0, 2, 1, 3).reshape(B, Sq, H * Dh) @ wo
```

```asm
; @launch grid=(256,1,1) block=(512,1,1) lds=163840
.amdgcn_target "amdgcn-amd-amdhsa--gfx950"
.text
.globl standalone__mha_block_cached__near_ridge_kernel
.p2align 8
.type standalone__mha_block_cached__near_ridge_kernel,@function
standalone__mha_block_cached__near_ridge_kernel:
    s_cmp_ge_u32 s2, 256
    s_cbranch_scc1 attn_end
    s_load_dwordx4 s[4:7], s[0:1], 0
    s_load_dwordx4 s[24:27], s[0:1], 16
    s_load_dwordx4 s[88:91], s[0:1], 48
    s_getpc_b64 s[94:95]
    s_lshr_b32 s96, s2, 3
    s_mul_i32 s96, s96, 20
    v_min_u32 v2, 19, v0
    v_add_u32 v2, s96, v2
    v_min_u32 v2, 519, v2
    v_lshlrev_b32 v2, 7, v2
    global_load_dword v255, v2, s[94:95]
    v_lshrrev_b32 v1, 6, v0
    v_and_b32 v250, 63, v0
    v_readfirstlane_b32 s30, v1
    s_and_b32 s31, s2, 1
    s_lshl_b32 s31, s31, 3
    s_lshr_b32 s44, s2, 5
    s_add_u32 s31, s31, s44
    s_bfe_u32 s84, s2, 0x20001
    s_bfe_u32 s85, s2, 0x20003
    s_lshl_b32 s99, s84, 2
    s_add_u32 s99, s99, s85
    v_lshrrev_b32 v251, 4, v250
    v_and_b32 v252, 15, v250
    v_lshrrev_b32 v253, 5, v250
    v_lshlrev_b32 v248, 15, v253
    v_and_b32 v253, 31, v250
    v_lshl_add_u32 v248, v253, 4, v248
    s_lshr_b32 s32, s30, 2
    s_lshl_b32 s46, s32, 2
    s_add_u32 s46, s46, s30
    s_lshl_b32 s46, s46, 13
    s_lshl_b32 s44, s99, 9
    s_add_u32 s46, s46, s44
    s_mul_i32 s58, s30, 2080
    s_and_b32 s44, s30, 1
    s_lshl_b32 s44, s44, 2
    v_add_u32 v253, s44, v251
    v_and_b32 v247, 7, v250
    v_xor_b32 v253, v253, v247
    v_lshrrev_b32 v247, 3, v250
    v_mul_u32_u24 v247, 1152, v247
    v_lshl_add_u32 v247, v253, 4, v247
    s_mul_i32 s40, s31, 165888
    s_mul_i32 s44, s30, 9216
    s_add_u32 s47, s40, s44
    s_lshl_b32 s59, s30, 10
    s_cmp_lt_u32 s30, 2
    s_mov_b32 s44, 8192
    s_cselect_b32 s82, 16384, s44
    s_mov_b32 s44, 73728
    s_cselect_b32 s83, 147456, s44
    s_add_u32 s53, s82, s59
    s_lshr_b32 s44, s2, 5
    s_lshl_b32 s45, s85, 1
    s_add_u32 s44, s44, s45
    s_sub_u32 s45, s44, 7
    s_cmp_ge_u32 s44, 7
    s_cselect_b32 s52, s45, s44
    s_lshl_b32 s45, s52, 7
    s_add_u32 s50, s47, s45
    s_sub_u32 s51, s50, 896
    s_lshl_b32 s45, s52, 19
    s_add_u32 s48, s46, s45
    s_sub_u32 s49, s48, 3670016
    s_waitcnt lgkmcnt(0)
    s_mov_b32 s8, s4
    s_mov_b32 s9, s5
    s_mov_b32 s10, 2654208
    s_mov_b32 s11, 0x20000
    s_mov_b32 s12, s26
    s_mov_b32 s13, s27
    s_mov_b32 s14, 4718592
    s_mov_b32 s15, 0x20000
    s_mov_b32 s44, s46
    s_add_u32 m0, s58, 95488
    s_add_u32 s44, s44, 0
    buffer_load_dwordx4 v248, s[12:15], s44 offen lds
    s_add_u32 s44, s44, 130048
    buffer_load_dwordx4 v248, s[12:15], s44 offen offset:1024 lds
    s_mov_b32 s45, s47
    s_add_u32 m0, s59, 25344
    s_add_u32 s45, s45, 0
    buffer_load_dwordx4 v247, s[8:11], s45 offen lds
    s_add_u32 m0, s59, 33536
    s_add_u32 s44, s45, 73728
    buffer_load_dwordx4 v247, s[8:11], s44 offen lds
    s_add_u32 m0, s53, 25344
    s_add_u32 s45, s45, s83
    buffer_load_dwordx4 v247, s[8:11], s45 offen lds
    s_mov_b32 s44, s46
    s_add_u32 m0, s58, 112128
    s_add_u32 s44, s44, 262144
    buffer_load_dwordx4 v248, s[12:15], s44 offen lds
    s_add_u32 s44, s44, 130048
    buffer_load_dwordx4 v248, s[12:15], s44 offen offset:1024 lds
    s_lshl_b32 s99, s84, 2
    s_add_u32 s99, s99, s85
    s_mov_b32 s16, s6
    s_mov_b32 s17, s7
    s_mov_b32 s18, 0x8000000
    s_mov_b32 s19, 0x20000
    s_mov_b32 s26, 0x8000000
    s_mov_b32 s27, 0x20000
    s_mov_b32 s20, s90
    s_mov_b32 s21, s91
    s_mov_b32 s22, 0x8000000
    s_mov_b32 s23, 0x20000
    s_mov_b32 s90, 256
    s_mov_b32 s91, 0x20000
    s_load_dwordx4 s[4:7], s[0:1], 32
    v_lshlrev_b32 v254, 4, v250
    s_lshl_b32 s35, s31, 4
    s_lshl_b32 s98, s31, 2
    s_add_u32 s98, s98, s84
    s_lshl_b32 s98, s98, 8
    s_add_u32 s98, s98, 25165824
    s_cmp_lg_u32 s30, 7
    s_cbranch_scc1 attn_noreg
    s_cmp_lg_u32 s85, 0
    s_cbranch_scc1 attn_nozero
    v_mov_b32 v180, 0
    v_lshlrev_b32 v181, 2, v250
    buffer_store_dword v180, v181, s[20:23], s98 offen sc1
    s_waitcnt vmcnt(0)
attn_nozero:
    v_mov_b32 v182, 1
    s_mov_b64 exec, 1
    buffer_atomic_add v182, off, s[88:91], s35 sc1
    s_mov_b64 exec, -1
attn_noreg:
    s_lshl_b32 s37, s31, 4
    s_add_u32 s37, s37, s99
    s_lshl_b32 s37, s37, 19
    s_and_b32 s45, s30, 1
    s_lshl_b32 s44, s32, 1
    s_add_u32 s45, s45, s44
    s_lshl_b32 s44, s45, 9
    s_add_u32 s37, s37, s44
    s_mul_i32 s38, s45, 2112
    v_lshlrev_b32 v241, 11, v251
    v_lshl_add_u32 v241, v252, 4, v241
    s_sub_u32 s33, s30, s32
    s_and_b32 s33, s33, 3
    s_lshl_b32 s36, s33, 1
    s_add_u32 s36, s36, 1
    s_cmp_eq_u32 s33, 0
    s_cselect_b32 s36, 0, s36
    s_add_u32 s34, s33, 2
    s_lshl_b32 s34, s34, 11
    v_and_b32 v253, 7, v250
    v_mul_u32_u24 v239, 1056, v253
    v_bfe_u32 v253, v250, 3, 1
    v_lshl_add_u32 v239, v253, 8, v239
    v_lshl_add_u32 v239, v251, 4, v239
    s_mul_i32 s44, s32, 16896
    v_add_u32 v239, s44, v239
    v_bfe_u32 v253, v250, 2, 3
    v_mul_u32_u24 v240, 1056, v253
    v_mul_u32_u24 v242, 2080, v253
    v_lshrrev_b32 v253, 5, v250
    v_lshl_add_u32 v240, v253, 8, v240
    v_lshl_add_u32 v242, v253, 10, v242
    v_and_b32 v253, 3, v250
    v_lshl_add_u32 v240, v253, 3, v240
    v_lshl_add_u32 v242, v253, 3, v242
    s_add_u32 s44, s44, 8448
    v_add_u32 v240, s44, v240
    s_lshl_b32 s44, s32, 8
    v_add_u32 v242, s44, v242
    v_lshrrev_b32 v253, 1, v252
    v_xor_b32 v253, v253, v251
    v_lshlrev_b32 v243, 7, v252
    v_lshl_add_u32 v243, v253, 4, v243
    s_lshl_b32 s44, s36, 11
    v_add_u32 v243, s44, v243
    v_xor_b32 v244, 64, v243
    s_mul_i32 s44, s32, 3
    s_sub_u32 s45, s33, 1
    s_max_i32 s45, s45, 0
    s_add_u32 s44, s44, s45
    s_lshl_b32 s44, s44, 10
    s_add_u32 s44, s44, 148480
    v_add_u32 v249, s44, v254
    s_lshl_b32 s86, s31, 4
    s_add_u32 s86, s86, s99
    s_lshl_b32 s86, s86, 1
    s_add_u32 s86, s86, s32
    s_mul_i32 s86, s86, 18
    s_add_u32 s86, s86, s36
    s_lshl_b32 s86, s86, 11
    s_and_b32 s87, s31, 7
    s_lshl_b32 s87, s87, 2
    s_add_u32 s87, s87, s85
    s_lshl_b32 s87, s87, 3
    s_add_u32 s87, s87, s30
    s_mul_i32 s87, s87, 4608
    s_mul_i32 s44, s84, 1179648
    s_add_u32 s87, s87, s44
    v_min_u32 v202, 35, v250
    v_lshlrev_b32 v202, 7, v202
    v_add_u32 v202, s87, v202
    s_waitcnt lgkmcnt(0)
    s_sub_u32 s94, s30, 2
    s_max_i32 s94, s94, 0
    s_add_u32 s95, s30, 6
    s_add_u32 s96, s30, 14
    s_cmp_lt_u32 s30, 5
    s_cselect_b32 s96, s96, s95
    s_lshl_b32 s44, s94, 6
    v_add_u32 v208, s44, v250
    v_cmp_le_u32 vcc, 592, v208
    s_nop 1
    v_cndmask_b32 v209, 0, 1, vcc
    v_mul_u32_u24 v210, 592, v209
    v_sub_u32 v210, v208, v210
    v_mul_u32_u24 v211, 886, v210
    v_lshrrev_b32 v211, 16, v211
    v_mul_u32_u24 v212, 74, v211
    v_sub_u32 v210, v210, v212
    v_lshl_add_u32 v211, v209, 5, v211
    v_mul_u32_u24 v212, 3641, v210
    v_lshrrev_b32 v212, 16, v212
    v_lshl_add_u32 v211, v212, 3, v211
    v_mul_u32_u24 v212, 18, v212
    v_sub_u32 v212, v210, v212
    v_mul_u32_u24 v211, 1152, v211
    v_lshl_add_u32 v220, v212, 4, v211
    v_mov_b32 v212, 0x7ff00000
    v_cmp_le_u32 vcc, 72, v210
    s_nop 1
    v_cndmask_b32 v220, v220, v212, vcc
    v_cmp_le_u32 vcc, 1184, v208
    s_nop 1
    v_cndmask_b32 v220, v220, v212, vcc
    s_lshl_b32 s44, s95, 6
    v_add_u32 v208, s44, v250
    v_cmp_le_u32 vcc, 592, v208
    s_nop 1
    v_cndmask_b32 v209, 0, 1, vcc
    v_mul_u32_u24 v210, 592, v209
    v_sub_u32 v210, v208, v210
    v_mul_u32_u24 v211, 886, v210
    v_lshrrev_b32 v211, 16, v211
    v_mul_u32_u24 v212, 74, v211
    v_sub_u32 v210, v210, v212
    v_lshl_add_u32 v211, v209, 5, v211
    v_mul_u32_u24 v212, 3641, v210
    v_lshrrev_b32 v212, 16, v212
    v_lshl_add_u32 v211, v212, 3, v211
    v_mul_u32_u24 v212, 18, v212
    v_sub_u32 v212, v210, v212
    v_mul_u32_u24 v211, 1152, v211
    v_lshl_add_u32 v221, v212, 4, v211
    v_mov_b32 v212, 0x7ff00000
    v_cmp_le_u32 vcc, 72, v210
    s_nop 1
    v_cndmask_b32 v221, v221, v212, vcc
    v_cmp_le_u32 vcc, 1184, v208
    s_nop 1
    v_cndmask_b32 v221, v221, v212, vcc
    s_lshl_b32 s44, s96, 6
    v_add_u32 v208, s44, v250
    v_cmp_le_u32 vcc, 592, v208
    s_nop 1
    v_cndmask_b32 v209, 0, 1, vcc
    v_mul_u32_u24 v210, 592, v209
    v_sub_u32 v210, v208, v210
    v_mul_u32_u24 v211, 886, v210
    v_lshrrev_b32 v211, 16, v211
    v_mul_u32_u24 v212, 74, v211
    v_sub_u32 v210, v210, v212
    v_lshl_add_u32 v211, v209, 5, v211
    v_mul_u32_u24 v212, 3641, v210
    v_lshrrev_b32 v212, 16, v212
    v_lshl_add_u32 v211, v212, 3, v211
    v_mul_u32_u24 v212, 18, v212
    v_sub_u32 v212, v210, v212
    v_mul_u32_u24 v211, 1152, v211
    v_lshl_add_u32 v222, v212, 4, v211
    v_mov_b32 v212, 0x7ff00000
    v_cmp_le_u32 vcc, 72, v210
    s_nop 1
    v_cndmask_b32 v222, v222, v212, vcc
    v_cmp_le_u32 vcc, 1184, v208
    s_nop 1
    v_cndmask_b32 v222, v222, v212, vcc
    s_lshl_b32 s78, s94, 10
    s_lshl_b32 s79, s95, 10
    s_lshl_b32 s80, s96, 10
    s_mul_i32 s77, s84, 1179648
    s_mul_i32 s44, s85, 295200
    s_add_u32 s77, s77, s44
    s_mov_b32 s56, 0x3e0293ee
    s_mov_b32 s57, 0x3e0293ee
    s_mov_b32 s44, s46
    s_add_u32 m0, s58, 147200
    s_add_u32 s44, s44, 524288
    buffer_load_dwordx4 v248, s[12:15], s44 offen lds
    s_add_u32 s44, s44, 130048
    buffer_load_dwordx4 v248, s[12:15], s44 offen offset:1024 lds
    s_mov_b32 s45, s47
    s_add_u32 m0, s59, 77056
    s_add_u32 s45, s45, 128
    buffer_load_dwordx4 v247, s[8:11], s45 offen lds
    s_add_u32 m0, s59, 85248
    s_add_u32 s44, s45, 73728
    buffer_load_dwordx4 v247, s[8:11], s44 offen lds
    s_add_u32 m0, s53, 77056
    s_add_u32 s45, s45, s83
    buffer_load_dwordx4 v247, s[8:11], s45 offen lds
    s_mov_b32 s44, s46
    s_add_u32 m0, s58, 43776
    s_add_u32 s44, s44, 786432
    buffer_load_dwordx4 v248, s[12:15], s44 offen lds
    s_add_u32 s44, s44, 130048
    buffer_load_dwordx4 v248, s[12:15], s44 offen offset:1024 lds
    v_mov_b64 v[0:1], 0
    v_mov_b64 v[2:3], 0
    v_mov_b64 v[4:5], 0
    v_mov_b64 v[6:7], 0
    v_mov_b64 v[8:9], 0
    v_mov_b64 v[10:11], 0
    v_mov_b64 v[12:13], 0
    v_mov_b64 v[14:15], 0
    v_mov_b64 v[16:17], 0
    v_mov_b64 v[18:19], 0
    v_mov_b64 v[20:21], 0
    v_mov_b64 v[22:23], 0
    v_mov_b64 v[24:25], 0
    v_mov_b64 v[26:27], 0
    v_mov_b64 v[28:29], 0
    v_mov_b64 v[30:31], 0
    v_mov_b64 v[32:33], 0
    v_mov_b64 v[34:35], 0
    v_mov_b64 v[36:37], 0
    v_mov_b64 v[38:39], 0
    v_mov_b64 v[40:41], 0
    v_mov_b64 v[42:43], 0
    v_mov_b64 v[44:45], 0
    v_mov_b64 v[46:47], 0
    v_mov_b64 v[48:49], 0
    v_mov_b64 v[50:51], 0
    v_mov_b64 v[52:53], 0
    v_mov_b64 v[54:55], 0
    v_mov_b64 v[56:57], 0
    v_mov_b64 v[58:59], 0
    v_mov_b64 v[60:61], 0
    v_mov_b64 v[62:63], 0
    v_mov_b64 v[64:65], 0
    v_mov_b64 v[66:67], 0
    v_mov_b64 v[68:69], 0
    v_mov_b64 v[70:71], 0
    v_mov_b64 v[72:73], 0
    v_mov_b64 v[74:75], 0
    v_mov_b64 v[76:77], 0
    v_mov_b64 v[78:79], 0
    v_mov_b64 v[80:81], 0
    v_mov_b64 v[82:83], 0
    v_mov_b64 v[84:85], 0
    v_mov_b64 v[86:87], 0
    v_mov_b64 v[88:89], 0
    v_mov_b64 v[90:91], 0
    v_mov_b64 v[92:93], 0
    v_mov_b64 v[94:95], 0
    v_mov_b64 v[144:145], 0
    v_mov_b64 v[146:147], 0
    v_mov_b64 v[148:149], 0
    v_mov_b64 v[150:151], 0
    v_mov_b64 v[152:153], 0
    v_mov_b64 v[154:155], 0
    v_mov_b64 v[156:157], 0
    v_mov_b64 v[158:159], 0
    v_mov_b64 v[160:161], 0
    v_mov_b64 v[162:163], 0
    v_mov_b64 v[164:165], 0
    v_mov_b64 v[166:167], 0
    v_mov_b64 v[168:169], 0
    v_mov_b64 v[170:171], 0
    v_mov_b64 v[172:173], 0
    v_mov_b64 v[174:175], 0
    v_mov_b64 v[108:109], 0
    v_mov_b64 v[110:111], 0
    v_mov_b64 v[112:113], 0
    v_mov_b64 v[114:115], 0
    v_mov_b64 v[116:117], 0
    v_mov_b64 v[118:119], 0
    s_bitcmp1_b32 s30, 1
    s_cbranch_scc1 attn_wl
    s_cmp_lg_u32 s33, 0
    s_cbranch_scc1 attn_wx
    s_waitcnt vmcnt(9)
    s_barrier
    v_add_u32 v245, 95488, v242
    v_add_u32 v246, 25344, v243
    v_mfma_f32_16x16x32_bf16 v[12:15], v[156:159], v[108:111], v[12:15]
    ds_read_b64_tr_b16 v[144:145], v245 offset:0
    s_cmp_ge_u32 s52, 7
    v_mfma_f32_16x16x32_bf16 v[44:47], v[156:159], v[112:115], v[44:47]
    ds_read_b64_tr_b16 v[146:147], v245 offset:512
    ds_read_b128 v[96:99], v246 offset:0
    v_mfma_f32_16x16x32_bf16 v[76:79], v[156:159], v[116:119], v[76:79]
    ds_read_b128 v[100:103], v246 offset:2048
    v_mfma_f32_16x16x32_bf16 v[16:19], v[160:163], v[108:111], v[16:19]
    ds_read_b128 v[104:107], v246 offset:4096
    s_cselect_b32 s44, s49, s48
    v_mfma_f32_16x16x32_bf16 v[48:51], v[160:163], v[112:115], v[48:51]
    ds_read_b64_tr_b16 v[148:149], v245 offset:32
    s_add_u32 m0, s58, 60416
    v_mfma_f32_16x16x32_bf16 v[80:83], v[160:163], v[116:119], v[80:83]
    ds_read_b64_tr_b16 v[150:151], v245 offset:544
    ds_read_b64_tr_b16 v[152:153], v245 offset:64
    v_mfma_f32_16x16x32_bf16 v[20:23], v[164:167], v[108:111], v[20:23]
    ds_read_b64_tr_b16 v[154:155], v245 offset:576
    s_add_u32 s44, s44, 1048576
    v_mfma_f32_16x16x32_bf16 v[52:55], v[164:167], v[112:115], v[52:55]
    buffer_load_dwordx4 v248, s[12:15], s44 offen lds
    s_add_u32 s44, s44, 130048
    v_mfma_f32_16x16x32_bf16 v[84:87], v[164:167], v[116:119], v[84:87]
    buffer_load_dwordx4 v248, s[12:15], s44 offen offset:1024 lds
    s_waitcnt lgkmcnt(4)
    v_mfma_f32_16x16x32_bf16 v[0:3], v[144:147], v[96:99], v[0:3]
    ds_read_b64_tr_b16 v[156:157], v245 offset:96
    s_cmp_ge_u32 s52, 7
    v_mfma_f32_16x16x32_bf16 v[32:35], v[144:147], v[100:103], v[32:35]
    ds_read_b64_tr_b16 v[158:159], v245 offset:608
    s_cselect_b32 s45, s51, s50
    v_mfma_f32_16x16x32_bf16 v[64:67], v[144:147], v[104:107], v[64:67]
    ds_read_b64_tr_b16 v[160:161], v245 offset:128
    s_add_u32 m0, s59, 128768
    s_waitcnt lgkmcnt(3)
    v_mfma_f32_16x16x32_bf16 v[4:7], v[148:151], v[96:99], v[4:7]
    ds_read_b64_tr_b16 v[162:163], v245 offset:640
    s_add_u32 s45, s45, 256
    v_mfma_f32_16x16x32_bf16 v[36:39], v[148:151], v[100:103], v[36:39]
    ds_read_b64_tr_b16 v[164:165], v245 offset:160
    buffer_load_dwordx4 v247, s[8:11], s45 offen lds
    v_mfma_f32_16x16x32_bf16 v[68:71], v[148:151], v[104:107], v[68:71]
    ds_read_b64_tr_b16 v[166:167], v245 offset:672
    v_mfma_f32_16x16x32_bf16 v[8:11], v[152:155], v[96:99], v[8:11]
    s_add_u32 m0, s59, 136960
    s_add_u32 s44, s45, 73728
    v_mfma_f32_16x16x32_bf16 v[40:43], v[152:155], v[100:103], v[40:43]
    buffer_load_dwordx4 v247, s[8:11], s44 offen lds
    s_add_u32 m0, s53, 128768
    v_mfma_f32_16x16x32_bf16 v[72:75], v[152:155], v[104:107], v[72:75]
    s_add_u32 s45, s45, s83
    buffer_load_dwordx4 v247, s[8:11], s45 offen lds
    s_waitcnt lgkmcnt(0)
    s_waitcnt vmcnt(12)
    s_barrier
    v_add_u32 v245, 112128, v242
    v_add_u32 v246, 25344, v244
    v_mfma_f32_16x16x32_bf16 v[12:15], v[156:159], v[96:99], v[12:15]
    ds_read_b64_tr_b16 v[144:145], v245 offset:0
    v_mfma_f32_16x16x32_bf16 v[44:47], v[156:159], v[100:103], v[44:47]
    ds_read_b64_tr_b16 v[146:147], v245 offset:512
    ds_read_b128 v[108:111], v246 offset:0
    v_mfma_f32_16x16x32_bf16 v[76:79], v[156:159], v[104:107], v[76:79]
    ds_read_b128 v[112:115], v246 offset:2048
    v_mfma_f32_16x16x32_bf16 v[16:19], v[160:163], v[96:99], v[16:19]
    ds_read_b128 v[116:119], v246 offset:4096
    v_mfma_f32_16x16x32_bf16 v[48:51], v[160:163], v[100:103], v[48:51]
    ds_read_b64_tr_b16 v[148:149], v245 offset:32
    v_mfma_f32_16x16x32_bf16 v[80:83], v[160:163], v[104:107], v[80:83]
    ds_read_b64_tr_b16 v[150:151], v245 offset:544
    ds_read_b64_tr_b16 v[152:153], v245 offset:64
    v_mfma_f32_16x16x32_bf16 v[20:23], v[164:167], v[96:99], v[20:23]
    ds_read_b64_tr_b16 v[154:155], v245 offset:576
    v_mfma_f32_16x16x32_bf16 v[52:55], v[164:167], v[100:103], v[52:55]
    s_cmp_ge_u32 s52, 7
    v_mfma_f32_16x16x32_bf16 v[84:87], v[164:167], v[104:107], v[84:87]
    s_cselect_b32 s44, s49, s48
    s_waitcnt lgkmcnt(4)
    v_mfma_f32_16x16x32_bf16 v[0:3], v[144:147], v[108:111], v[0:3]
    ds_read_b64_tr_b16 v[156:157], v245 offset:96
    v_mfma_f32_16x16x32_bf16 v[32:35], v[144:147], v[112:115], v[32:35]
    ds_read_b64_tr_b16 v[158:159], v245 offset:608
    v_mfma_f32_16x16x32_bf16 v[64:67], v[144:147], v[116:119], v[64:67]
    ds_read_b64_tr_b16 v[160:161], v245 offset:128
    s_add_u32 m0, s58, 95488
    s_waitcnt lgkmcnt(3)
    v_mfma_f32_16x16x32_bf16 v[4:7], v[148:151], v[108:111], v[4:7]
    ds_read_b64_tr_b16 v[162:163], v245 offset:640
    v_mfma_f32_16x16x32_bf16 v[36:39], v[148:151], v[112:115], v[36:39]
    ds_read_b64_tr_b16 v[164:165], v245 offset:160
    v_mfma_f32_16x16x32_bf16 v[68:71], v[148:151], v[116:119], v[68:71]
    ds_read_b64_tr_b16 v[166:167], v245 offset:672
    v_mfma_f32_16x16x32_bf16 v[8:11], v[152:155], v[108:111], v[8:11]
    s_add_u32 s44, s44, 1310720
    buffer_load_dwordx4 v248, s[12:15], s44 offen lds
    v_mfma_f32_16x16x32_bf16 v[40:43], v[152:155], v[112:115], v[40:43]
    s_add_u32 s44, s44, 130048
    v_mfma_f32_16x16x32_bf16 v[72:75], v[152:155], v[116:119], v[72:75]
    buffer_load_dwordx4 v248, s[12:15], s44 offen offset:1024 lds
    s_waitcnt lgkmcnt(0)
    s_waitcnt vmcnt(9)
    s_barrier
    v_add_u32 v245, 147200, v242
    v_add_u32 v246, 77056, v243
    v_mfma_f32_16x16x32_bf16 v[12:15], v[156:159], v[108:111], v[12:15]
    ds_read_b64_tr_b16 v[144:145], v245 offset:0
    s_cmp_ge_u32 s52, 6
    v_mfma_f32_16x16x32_bf16 v[44:47], v[156:159], v[112:115], v[44:47]
    ds_read_b64_tr_b16 v[146:147], v245 offset:512
    ds_read_b128 v[96:99], v246 offset:0
    v_mfma_f32_16x16x32_bf16 v[76:79], v[156:159], v[116:119], v[76:79]
    ds_read_b128 v[100:103], v246 offset:2048
    v_mfma_f32_16x16x32_bf16 v[16:19], v[160:163], v[108:111], v[16:19]
    ds_read_b128 v[104:107], v246 offset:4096
    s_cselect_b32 s44, s49, s48
    v_mfma_f32_16x16x32_bf16 v[48:51], v[160:163], v[112:115], v[48:51]
    ds_read_b64_tr_b16 v[148:149], v245 offset:32
    s_add_u32 m0, s58, 112128
    v_mfma_f32_16x16x32_bf16 v[80:83], v[160:163], v[116:119], v[80:83]
    ds_read_b64_tr_b16 v[150:151], v245 offset:544
    ds_read_b64_tr_b16 v[152:153], v245 offset:64
    v_mfma_f32_16x16x32_bf16 v[20:23], v[164:167], v[108:111], v[20:23]
    ds_read_b64_tr_b16 v[154:155], v245 offset:576
    s_add_u32 s44, s44, 1572864
    v_mfma_f32_16x16x32_bf16 v[52:55], v[164:167], v[112:115], v[52:55]
    buffer_load_dwordx4 v248, s[12:15], s44 offen lds
    s_add_u32 s44, s44, 130048
    v_mfma_f32_16x16x32_bf16 v[84:87], v[164:167], v[116:119], v[84:87]
    buffer_load_dwordx4 v248, s[12:15], s44 offen offset:1024 lds
    s_waitcnt lgkmcnt(4)
    v_mfma_f32_16x16x32_bf16 v[0:3], v[144:147], v[96:99], v[0:3]
    ds_read_b64_tr_b16 v[156:157], v245 offset:96
    s_cmp_ge_u32 s52, 6
    v_mfma_f32_16x16x32_bf16 v[32:35], v[144:147], v[100:103], v[32:35]
    ds_read_b64_tr_b16 v[158:159], v245 offset:608
    s_cselect_b32 s45, s51, s50
    v_mfma_f32_16x16x32_bf16 v[64:67], v[144:147], v[104:107], v[64:67]
    ds_read_b64_tr_b16 v[160:161], v245 offset:128
    s_add_u32 m0, s59, 25344
    s_waitcnt lgkmcnt(3)
    v_mfma_f32_16x16x32_bf16 v[4:7], v[148:151], v[96:99], v[4:7]
    ds_read_b64_tr_b16 v[162:163], v245 offset:640
    s_add_u32 s45, s45, 384
    v_mfma_f32_16x16x32_bf16 v[36:39], v[148:151], v[100:103], v[36:39]
    ds_read_b64_tr_b16 v[164:165], v245 offset:160
    buffer_load_dwordx4 v247, s[8:11], s45 offen lds
    v_mfma_f32_16x16x32_bf16 v[68:71], v[148:151], v[104:107], v[68:71]
    ds_read_b64_tr_b16 v[166:167], v245 offset:672
    v_mfma_f32_16x16x32_bf16 v[8:11], v[152:155], v[96:99], v[8:11]
    s_add_u32 m0, s59, 33536
    s_add_u32 s44, s45, 73728
    v_mfma_f32_16x16x32_bf16 v[40:43], v[152:155], v[100:103], v[40:43]
    buffer_load_dwordx4 v247, s[8:11], s44 offen lds
    s_add_u32 m0, s53, 25344
    v_mfma_f32_16x16x32_bf16 v[72:75], v[152:155], v[104:107], v[72:75]
    s_add_u32 s45, s45, s83
    buffer_load_dwordx4 v247, s[8:11], s45 offen lds
    s_waitcnt lgkmcnt(0)
    s_waitcnt vmcnt(12)
    s_barrier
    v_add_u32 v245, 43776, v242
    v_add_u32 v246, 77056, v244
    v_mfma_f32_16x16x32_bf16 v[12:15], v[156:159], v[96:99], v[12:15]
    ds_read_b64_tr_b16 v[144:145], v245 offset:0
    v_mfma_f32_16x16x32_bf16 v[44:47], v[156:159], v[100:103], v[44:47]
    ds_read_b64_tr_b16 v[146:147], v245 offset:512
    ds_read_b128 v[108:111], v246 offset:0
    v_mfma_f32_16x16x32_bf16 v[76:79], v[156:159], v[104:107], v[76:79]
    ds_read_b128 v[112:115], v246 offset:2048
    v_mfma_f32_16x16x32_bf16 v[16:19], v[160:163], v[96:99], v[16:19]
    ds_read_b128 v[116:119], v246 offset:4096
    v_mfma_f32_16x16x32_bf16 v[48:51], v[160:163], v[100:103], v[48:51]
    ds_read_b64_tr_b16 v[148:149], v245 offset:32
    v_mfma_f32_16x16x32_bf16 v[80:83], v[160:163], v[104:107], v[80:83]
    ds_read_b64_tr_b16 v[150:151], v245 offset:544
    ds_read_b64_tr_b16 v[152:153], v245 offset:64
    v_mfma_f32_16x16x32_bf16 v[20:23], v[164:167], v[96:99], v[20:23]
    ds_read_b64_tr_b16 v[154:155], v245 offset:576
    v_mfma_f32_16x16x32_bf16 v[52:55], v[164:167], v[100:103], v[52:55]
    s_cmp_ge_u32 s52, 6
    v_mfma_f32_16x16x32_bf16 v[84:87], v[164:167], v[104:107], v[84:87]
    s_cselect_b32 s44, s49, s48
    s_waitcnt lgkmcnt(4)
    v_mfma_f32_16x16x32_bf16 v[0:3], v[144:147], v[108:111], v[0:3]
    ds_read_b64_tr_b16 v[156:157], v245 offset:96
    v_mfma_f32_16x16x32_bf16 v[32:35], v[144:147], v[112:115], v[32:35]
    ds_read_b64_tr_b16 v[158:159], v245 offset:608
    v_mfma_f32_16x16x32_bf16 v[64:67], v[144:147], v[116:119], v[64:67]
    ds_read_b64_tr_b16 v[160:161], v245 offset:128
    s_add_u32 m0, s58, 147200
    s_waitcnt lgkmcnt(3)
    v_mfma_f32_16x16x32_bf16 v[4:7], v[148:151], v[108:111], v[4:7]
    ds_read_b64_tr_b16 v[162:163], v245 offset:640
    v_mfma_f32_16x16x32_bf16 v[36:39], v[148:151], v[112:115], v[36:39]
    ds_read_b64_tr_b16 v[164:165], v245 offset:160
    v_mfma_f32_16x16x32_bf16 v[68:71], v[148:151], v[116:119], v[68:71]
    ds_read_b64_tr_b16 v[166:167], v245 offset:672
    v_mfma_f32_16x16x32_bf16 v[8:11], v[152:155], v[108:111], v[8:11]
    s_add_u32 s44, s44, 1835008
    buffer_load_dwordx4 v248, s[12:15], s44 offen lds
    v_mfma_f32_16x16x32_bf16 v[40:43], v[152:155], v[112:115], v[40:43]
    s_add_u32 s44, s44, 130048
    v_mfma_f32_16x16x32_bf16 v[72:75], v[152:155], v[116:119], v[72:75]
    buffer_load_dwordx4 v248, s[12:15], s44 offen offset:1024 lds
    s_waitcnt lgkmcnt(0)
    s_waitcnt vmcnt(9)
    s_barrier
    v_add_u32 v245, 60416, v242
    v_add_u32 v246, 128768, v243
    v_mfma_f32_16x16x32_bf16 v[12:15], v[156:159], v[108:111], v[12:15]
    ds_read_b64_tr_b16 v[144:145], v245 offset:0
    s_cmp_ge_u32 s52, 5
    v_mfma_f32_16x16x32_bf16 v[44:47], v[156:159], v[112:115], v[44:47]
    ds_read_b64_tr_b16 v[146:147], v245 offset:512
    ds_read_b128 v[96:99], v246 offset:0
    v_mfma_f32_16x16x32_bf16 v[76:79], v[156:159], v[116:119], v[76:79]
    ds_read_b128 v[100:103], v246 offset:2048
    v_mfma_f32_16x16x32_bf16 v[16:19], v[160:163], v[108:111], v[16:19]
    ds_read_b128 v[104:107], v246 offset:4096
    s_cselect_b32 s44, s49, s48
    v_mfma_f32_16x16x32_bf16 v[48:51], v[160:163], v[112:115], v[48:51]
    ds_read_b64_tr_b16 v[148:149], v245 offset:32
    s_add_u32 m0, s58, 43776
    v_mfma_f32_16x16x32_bf16 v[80:83], v[160:163], v[116:119], v[80:83]
    ds_read_b64_tr_b16 v[150:151], v245 offset:544
    ds_read_b64_tr_b16 v[152:153], v245 offset:64
    v_mfma_f32_16x16x32_bf16 v[20:23], v[164:167], v[108:111], v[20:23]
    ds_read_b64_tr_b16 v[154:155], v245 offset:576
    s_add_u32 s44, s44, 2097152
    v_mfma_f32_16x16x32_bf16 v[52:55], v[164:167], v[112:115], v[52:55]
    buffer_load_dwordx4 v248, s[12:15], s44 offen lds
    s_add_u32 s44, s44, 130048
    v_mfma_f32_16x16x32_bf16 v[84:87], v[164:167], v[116:119], v[84:87]
    buffer_load_dwordx4 v248, s[12:15], s44 offen offset:1024 lds
    s_waitcnt lgkmcnt(4)
    v_mfma_f32_16x16x32_bf16 v[0:3], v[144:147], v[96:99], v[0:3]
    ds_read_b64_tr_b16 v[156:157], v245 offset:96
    s_cmp_ge_u32 s52, 5
    v_mfma_f32_16x16x32_bf16 v[32:35], v[144:147], v[100:103], v[32:35]
    ds_read_b64_tr_b16 v[158:159], v245 offset:608
    s_cselect_b32 s45, s51, s50
    v_mfma_f32_16x16x32_bf16 v[64:67], v[144:147], v[104:107], v[64:67]
    ds_read_b64_tr_b16 v[160:161], v245 offset:128
    s_add_u32 m0, s59, 77056
    s_waitcnt lgkmcnt(3)
    v_mfma_f32_16x16x32_bf16 v[4:7], v[148:151], v[96:99], v[4:7]
    ds_read_b64_tr_b16 v[162:163], v245 offset:640
    s_add_u32 s45, s45, 512
    v_mfma_f32_16x16x32_bf16 v[36:39], v[148:151], v[100:103], v[36:39]
    ds_read_b64_tr_b16 v[164:165], v245 offset:160
    buffer_load_dwordx4 v247, s[8:11], s45 offen lds
    v_mfma_f32_16x16x32_bf16 v[68:71], v[148:151], v[104:107], v[68:71]
    ds_read_b64_tr_b16 v[166:167], v245 offset:672
    v_mfma_f32_16x16x32_bf16 v[8:11], v[152:155], v[96:99], v[8:11]
    s_add_u32 m0, s59, 85248
    s_add_u32 s44, s45, 73728
    v_mfma_f32_16x16x32_bf16 v[40:43], v[152:155], v[100:103], v[40:43]
    buffer_load_dwordx4 v247, s[8:11], s44 offen lds
    s_add_u32 m0, s53, 77056
    v_mfma_f32_16x16x32_bf16 v[72:75], v[152:155], v[104:107], v[72:75]
    s_add_u32 s45, s45, s83
    buffer_load_dwordx4 v247, s[8:11], s45 offen lds
    s_waitcnt lgkmcnt(0)
    s_waitcnt vmcnt(12)
    s_barrier
    v_add_u32 v245, 95488, v242
    v_add_u32 v246, 128768, v244
    v_mfma_f32_16x16x32_bf16 v[12:15], v[156:159], v[96:99], v[12:15]
    ds_read_b64_tr_b16 v[144:145], v245 offset:0
    v_mfma_f32_16x16x32_bf16 v[44:47], v[156:159], v[100:103], v[44:47]
    ds_read_b64_tr_b16 v[146:147], v245 offset:512
    ds_read_b128 v[108:111], v246 offset:0
    v_mfma_f32_16x16x32_bf16 v[76:79], v[156:159], v[104:107], v[76:79]
    ds_read_b128 v[112:115], v246 offset:2048
    v_mfma_f32_16x16x32_bf16 v[16:19], v[160:163], v[96:99], v[16:19]
    ds_read_b128 v[116:119], v246 offset:4096
    v_mfma_f32_16x16x32_bf16 v[48:51], v[160:163], v[100:103], v[48:51]
    ds_read_b64_tr_b16 v[148:149], v245 offset:32
    v_mfma_f32_16x16x32_bf16 v[80:83], v[160:163], v[104:107], v[80:83]
    ds_read_b64_tr_b16 v[150:151], v245 offset:544
    ds_read_b64_tr_b16 v[152:153], v245 offset:64
    v_mfma_f32_16x16x32_bf16 v[20:23], v[164:167], v[96:99], v[20:23]
    ds_read_b64_tr_b16 v[154:155], v245 offset:576
    v_mfma_f32_16x16x32_bf16 v[52:55], v[164:167], v[100:103], v[52:55]
    s_cmp_ge_u32 s52, 5
    v_mfma_f32_16x16x32_bf16 v[84:87], v[164:167], v[104:107], v[84:87]
    s_cselect_b32 s44, s49, s48
    s_waitcnt lgkmcnt(4)
    v_mfma_f32_16x16x32_bf16 v[0:3], v[144:147], v[108:111], v[0:3]
    ds_read_b64_tr_b16 v[156:157], v245 offset:96
    v_mfma_f32_16x16x32_bf16 v[32:35], v[144:147], v[112:115], v[32:35]
    ds_read_b64_tr_b16 v[158:159], v245 offset:608
    v_mfma_f32_16x16x32_bf16 v[64:67], v[144:147], v[116:119], v[64:67]
    ds_read_b64_tr_b16 v[160:161], v245 offset:128
    s_add_u32 m0, s58, 60416
    s_waitcnt lgkmcnt(3)
    v_mfma_f32_16x16x32_bf16 v[4:7], v[148:151], v[108:111], v[4:7]
    ds_read_b64_tr_b16 v[162:163], v245 offset:640
    v_mfma_f32_16x16x32_bf16 v[36:39], v[148:151], v[112:115], v[36:39]
    ds_read_b64_tr_b16 v[164:165], v245 offset:160
    v_mfma_f32_16x16x32_bf16 v[68:71], v[148:151], v[116:119], v[68:71]
    ds_read_b64_tr_b16 v[166:167], v245 offset:672
    v_mfma_f32_16x16x32_bf16 v[8:11], v[152:155], v[108:111], v[8:11]
    s_add_u32 s44, s44, 2359296
    buffer_load_dwordx4 v248, s[12:15], s44 offen lds
    v_mfma_f32_16x16x32_bf16 v[40:43], v[152:155], v[112:115], v[40:43]
    s_add_u32 s44, s44, 130048
    v_mfma_f32_16x16x32_bf16 v[72:75], v[152:155], v[116:119], v[72:75]
    buffer_load_dwordx4 v248, s[12:15], s44 offen offset:1024 lds
    s_waitcnt lgkmcnt(0)
    s_waitcnt vmcnt(9)
    s_barrier
    v_add_u32 v245, 112128, v242
    v_add_u32 v246, 25344, v243
    v_mfma_f32_16x16x32_bf16 v[12:15], v[156:159], v[108:111], v[12:15]
    ds_read_b64_tr_b16 v[144:145], v245 offset:0
    s_cmp_ge_u32 s52, 4
    v_mfma_f32_16x16x32_bf16 v[44:47], v[156:159], v[112:115], v[44:47]
    ds_read_b64_tr_b16 v[146:147], v245 offset:512
    ds_read_b128 v[96:99], v246 offset:0
    v_mfma_f32_16x16x32_bf16 v[76:79], v[156:159], v[116:119], v[76:79]
    ds_read_b128 v[100:103], v246 offset:2048
    v_mfma_f32_16x16x32_bf16 v[16:19], v[160:163], v[108:111], v[16:19]
    ds_read_b128 v[104:107], v246 offset:4096
    s_cselect_b32 s44, s49, s48
    v_mfma_f32_16x16x32_bf16 v[48:51], v[160:163], v[112:115], v[48:51]
    ds_read_b64_tr_b16 v[148:149], v245 offset:32
    s_add_u32 m0, s58, 95488
    v_mfma_f32_16x16x32_bf16 v[80:83], v[160:163], v[116:119], v[80:83]
    ds_read_b64_tr_b16 v[150:151], v245 offset:544
    ds_read_b64_tr_b16 v[152:153], v245 offset:64
    v_mfma_f32_16x16x32_bf16 v[20:23], v[164:167], v[108:111], v[20:23]
    ds_read_b64_tr_b16 v[154:155], v245 offset:576
    s_add_u32 s44, s44, 2621440
    v_mfma_f32_16x16x32_bf16 v[52:55], v[164:167], v[112:115], v[52:55]
    buffer_load_dwordx4 v248, s[12:15], s44 offen lds
    s_add_u32 s44, s44, 130048
    v_mfma_f32_16x16x32_bf16 v[84:87], v[164:167], v[116:119], v[84:87]
    buffer_load_dwordx4 v248, s[12:15], s44 offen offset:1024 lds
    s_waitcnt lgkmcnt(4)
    v_mfma_f32_16x16x32_bf16 v[0:3], v[144:147], v[96:99], v[0:3]
    ds_read_b64_tr_b16 v[156:157], v245 offset:96
    s_cmp_ge_u32 s52, 4
    v_mfma_f32_16x16x32_bf16 v[32:35], v[144:147], v[100:103], v[32:35]
    ds_read_b64_tr_b16 v[158:159], v245 offset:608
    s_cselect_b32 s45, s51, s50
    v_mfma_f32_16x16x32_bf16 v[64:67], v[144:147], v[104:107], v[64:67]
    ds_read_b64_tr_b16 v[160:161], v245 offset:128
    s_add_u32 m0, s59, 128768
    s_waitcnt lgkmcnt(3)
    v_mfma_f32_16x16x32_bf16 v[4:7], v[148:151], v[96:99], v[4:7]
    ds_read_b64_tr_b16 v[162:163], v245 offset:640
    s_add_u32 s45, s45, 640
    v_mfma_f32_16x16x32_bf16 v[36:39], v[148:151], v[100:103], v[36:39]
    ds_read_b64_tr_b16 v[164:165], v245 offset:160
    buffer_load_dwordx4 v247, s[8:11], s45 offen lds
    v_mfma_f32_16x16x32_bf16 v[68:71], v[148:151], v[104:107], v[68:71]
    ds_read_b64_tr_b16 v[166:167], v245 offset:672
    v_mfma_f32_16x16x32_bf16 v[8:11], v[152:155], v[96:99], v[8:11]
    s_add_u32 m0, s59, 136960
    s_add_u32 s44, s45, 73728
    v_mfma_f32_16x16x32_bf16 v[40:43], v[152:155], v[100:103], v[40:43]
    buffer_load_dwordx4 v247, s[8:11], s44 offen lds
    s_add_u32 m0, s53, 128768
    v_mfma_f32_16x16x32_bf16 v[72:75], v[152:155], v[104:107], v[72:75]
    s_add_u32 s45, s45, s83
    buffer_load_dwordx4 v247, s[8:11], s45 offen lds
    s_waitcnt lgkmcnt(0)
    s_waitcnt vmcnt(12)
    s_barrier
    v_add_u32 v245, 147200, v242
    v_add_u32 v246, 25344, v244
    v_mfma_f32_16x16x32_bf16 v[12:15], v[156:159], v[96:99], v[12:15]
    ds_read_b64_tr_b16 v[144:145], v245 offset:0
    v_mfma_f32_16x16x32_bf16 v[44:47], v[156:159], v[100:103], v[44:47]
    ds_read_b64_tr_b16 v[146:147], v245 offset:512
    ds_read_b128 v[108:111], v246 offset:0
    v_mfma_f32_16x16x32_bf16 v[76:79], v[156:159], v[104:107], v[76:79]
    ds_read_b128 v[112:115], v246 offset:2048
    v_mfma_f32_16x16x32_bf16 v[16:19], v[160:163], v[96:99], v[16:19]
    ds_read_b128 v[116:119], v246 offset:4096
    v_mfma_f32_16x16x32_bf16 v[48:51], v[160:163], v[100:103], v[48:51]
    ds_read_b64_tr_b16 v[148:149], v245 offset:32
    v_mfma_f32_16x16x32_bf16 v[80:83], v[160:163], v[104:107], v[80:83]
    ds_read_b64_tr_b16 v[150:151], v245 offset:544
    ds_read_b64_tr_b16 v[152:153], v245 offset:64
    v_mfma_f32_16x16x32_bf16 v[20:23], v[164:167], v[96:99], v[20:23]
    ds_read_b64_tr_b16 v[154:155], v245 offset:576
    v_mfma_f32_16x16x32_bf16 v[52:55], v[164:167], v[100:103], v[52:55]
    s_cmp_ge_u32 s52, 4
    v_mfma_f32_16x16x32_bf16 v[84:87], v[164:167], v[104:107], v[84:87]
    s_cselect_b32 s44, s49, s48
    s_waitcnt lgkmcnt(4)
    v_mfma_f32_16x16x32_bf16 v[0:3], v[144:147], v[108:111], v[0:3]
    ds_read_b64_tr_b16 v[156:157], v245 offset:96
    v_mfma_f32_16x16x32_bf16 v[32:35], v[144:147], v[112:115], v[32:35]
    ds_read_b64_tr_b16 v[158:159], v245 offset:608
    v_mfma_f32_16x16x32_bf16 v[64:67], v[144:147], v[116:119], v[64:67]
    ds_read_b64_tr_b16 v[160:161], v245 offset:128
    s_add_u32 m0, s58, 112128
    s_waitcnt lgkmcnt(3)
    v_mfma_f32_16x16x32_bf16 v[4:7], v[148:151], v[108:111], v[4:7]
    ds_read_b64_tr_b16 v[162:163], v245 offset:640
    v_mfma_f32_16x16x32_bf16 v[36:39], v[148:151], v[112:115], v[36:39]
    ds_read_b64_tr_b16 v[164:165], v245 offset:160
    v_mfma_f32_16x16x32_bf16 v[68:71], v[148:151], v[116:119], v[68:71]
    ds_read_b64_tr_b16 v[166:167], v245 offset:672
    v_mfma_f32_16x16x32_bf16 v[8:11], v[152:155], v[108:111], v[8:11]
    s_add_u32 s44, s44, 2883584
    buffer_load_dwordx4 v248, s[12:15], s44 offen lds
    v_mfma_f32_16x16x32_bf16 v[40:43], v[152:155], v[112:115], v[40:43]
    s_add_u32 s44, s44, 130048
    v_mfma_f32_16x16x32_bf16 v[72:75], v[152:155], v[116:119], v[72:75]
    buffer_load_dwordx4 v248, s[12:15], s44 offen offset:1024 lds
    s_waitcnt lgkmcnt(0)
    s_waitcnt vmcnt(9)
    s_barrier
    v_add_u32 v245, 43776, v242
    v_add_u32 v246, 77056, v243
    v_mfma_f32_16x16x32_bf16 v[12:15], v[156:159], v[108:111], v[12:15]
    ds_read_b64_tr_b16 v[144:145], v245 offset:0
    global_load_dword v255, v202, s[4:5]
    v_mfma_f32_16x16x32_bf16 v[44:47], v[156:159], v[112:115], v[44:47]
    ds_read_b64_tr_b16 v[146:147], v245 offset:512
    ds_read_b128 v[96:99], v246 offset:0
    v_mfma_f32_16x16x32_bf16 v[76:79], v[156:159], v[116:119], v[76:79]
    ds_read_b128 v[100:103], v246 offset:2048
    s_cmp_ge_u32 s52, 3
    v_mfma_f32_16x16x32_bf16 v[16:19], v[160:163], v[108:111], v[16:19]
    ds_read_b128 v[104:107], v246 offset:4096
    s_cselect_b32 s44, s49, s48
    v_mfma_f32_16x16x32_bf16 v[48:51], v[160:163], v[112:115], v[48:51]
    ds_read_b64_tr_b16 v[148:149], v245 offset:32
    v_mfma_f32_16x16x32_bf16 v[80:83], v[160:163], v[116:119], v[80:83]
    ds_read_b64_tr_b16 v[150:151], v245 offset:544
    ds_read_b64_tr_b16 v[152:153], v245 offset:64
    v_mfma_f32_16x16x32_bf16 v[20:23], v[164:167], v[108:111], v[20:23]
    ds_read_b64_tr_b16 v[154:155], v245 offset:576
    s_add_u32 m0, s58, 147200
    v_mfma_f32_16x16x32_bf16 v[52:55], v[164:167], v[112:115], v[52:55]
    s_add_u32 s44, s44, 3145728
    buffer_load_dwordx4 v248, s[12:15], s44 offen lds
    v_mfma_f32_16x16x32_bf16 v[84:87], v[164:167], v[116:119], v[84:87]
    s_add_u32 s44, s44, 130048
    buffer_load_dwordx4 v248, s[12:15], s44 offen offset:1024 lds
    s_waitcnt lgkmcnt(4)
    v_mfma_f32_16x16x32_bf16 v[0:3], v[144:147], v[96:99], v[0:3]
    ds_read_b64_tr_b16 v[156:157], v245 offset:96
    s_cmp_ge_u32 s52, 3
    v_mfma_f32_16x16x32_bf16 v[32:35], v[144:147], v[100:103], v[32:35]
    ds_read_b64_tr_b16 v[158:159], v245 offset:608
    s_cselect_b32 s45, s51, s50
    v_mfma_f32_16x16x32_bf16 v[64:67], v[144:147], v[104:107], v[64:67]
    ds_read_b64_tr_b16 v[160:161], v245 offset:128
    s_add_u32 m0, s59, 25344
    s_waitcnt lgkmcnt(3)
    v_mfma_f32_16x16x32_bf16 v[4:7], v[148:151], v[96:99], v[4:7]
    ds_read_b64_tr_b16 v[162:163], v245 offset:640
    s_add_u32 s45, s45, 768
    v_mfma_f32_16x16x32_bf16 v[36:39], v[148:151], v[100:103], v[36:39]
    ds_read_b64_tr_b16 v[164:165], v245 offset:160
    v_mfma_f32_16x16x32_bf16 v[68:71], v[148:151], v[104:107], v[68:71]
    ds_read_b64_tr_b16 v[166:167], v245 offset:672
    buffer_load_dwordx4 v247, s[8:11], s45 offen lds
    v_mfma_f32_16x16x32_bf16 v[8:11], v[152:155], v[96:99], v[8:11]
    s_add_u32 m0, s59, 33536
    s_add_u32 s44, s45, 73728
    v_mfma_f32_16x16x32_bf16 v[40:43], v[152:155], v[100:103], v[40:43]
    buffer_load_dwordx4 v247, s[8:11], s44 offen lds
    s_add_u32 m0, s53, 25344
    v_mfma_f32_16x16x32_bf16 v[72:75], v[152:155], v[104:107], v[72:75]
    s_add_u32 s45, s45, s83
    buffer_load_dwordx4 v247, s[8:11], s45 offen lds
    s_waitcnt lgkmcnt(0)
    s_waitcnt vmcnt(13)
    s_barrier
    v_add_u32 v245, 60416, v242
    v_add_u32 v246, 77056, v244
    v_mfma_f32_16x16x32_bf16 v[12:15], v[156:159], v[96:99], v[12:15]
    ds_read_b64_tr_b16 v[144:145], v245 offset:0
    v_mfma_f32_16x16x32_bf16 v[44:47], v[156:159], v[100:103], v[44:47]
    ds_read_b64_tr_b16 v[146:147], v245 offset:512
    ds_read_b128 v[108:111], v246 offset:0
    v_mfma_f32_16x16x32_bf16 v[76:79], v[156:159], v[104:107], v[76:79]
    ds_read_b128 v[112:115], v246 offset:2048
    v_mfma_f32_16x16x32_bf16 v[16:19], v[160:163], v[96:99], v[16:19]
    ds_read_b128 v[116:119], v246 offset:4096
    v_mfma_f32_16x16x32_bf16 v[48:51], v[160:163], v[100:103], v[48:51]
    ds_read_b64_tr_b16 v[148:149], v245 offset:32
    v_mfma_f32_16x16x32_bf16 v[80:83], v[160:163], v[104:107], v[80:83]
    ds_read_b64_tr_b16 v[150:151], v245 offset:544
    ds_read_b64_tr_b16 v[152:153], v245 offset:64
    v_mfma_f32_16x16x32_bf16 v[20:23], v[164:167], v[96:99], v[20:23]
    ds_read_b64_tr_b16 v[154:155], v245 offset:576
    v_mfma_f32_16x16x32_bf16 v[52:55], v[164:167], v[100:103], v[52:55]
    s_cmp_ge_u32 s52, 3
    v_mfma_f32_16x16x32_bf16 v[84:87], v[164:167], v[104:107], v[84:87]
    s_cselect_b32 s44, s49, s48
    s_waitcnt lgkmcnt(4)
    v_mfma_f32_16x16x32_bf16 v[0:3], v[144:147], v[108:111], v[0:3]
    ds_read_b64_tr_b16 v[156:157], v245 offset:96
    v_mfma_f32_16x16x32_bf16 v[32:35], v[144:147], v[112:115], v[32:35]
    ds_read_b64_tr_b16 v[158:159], v245 offset:608
    v_mfma_f32_16x16x32_bf16 v[64:67], v[144:147], v[116:119], v[64:67]
    ds_read_b64_tr_b16 v[160:161], v245 offset:128
    s_add_u32 m0, s58, 43776
    s_waitcnt lgkmcnt(3)
    v_mfma_f32_16x16x32_bf16 v[4:7], v[148:151], v[108:111], v[4:7]
    ds_read_b64_tr_b16 v[162:163], v245 offset:640
    v_mfma_f32_16x16x32_bf16 v[36:39], v[148:151], v[112:115], v[36:39]
    ds_read_b64_tr_b16 v[164:165], v245 offset:160
    v_mfma_f32_16x16x32_bf16 v[68:71], v[148:151], v[116:119], v[68:71]
    ds_read_b64_tr_b16 v[166:167], v245 offset:672
    v_mfma_f32_16x16x32_bf16 v[8:11], v[152:155], v[108:111], v[8:11]
    s_add_u32 s44, s44, 3407872
    buffer_load_dwordx4 v248, s[12:15], s44 offen lds
    v_mfma_f32_16x16x32_bf16 v[40:43], v[152:155], v[112:115], v[40:43]
    s_add_u32 s44, s44, 130048
    v_mfma_f32_16x16x32_bf16 v[72:75], v[152:155], v[116:119], v[72:75]
    buffer_load_dwordx4 v248, s[12:15], s44 offen offset:1024 lds
    s_waitcnt lgkmcnt(0)
    s_waitcnt vmcnt(10)
    s_barrier
    v_add_u32 v245, 95488, v242
    v_add_u32 v246, 128768, v243
    v_mfma_f32_16x16x32_bf16 v[12:15], v[156:159], v[108:111], v[12:15]
    ds_read_b64_tr_b16 v[144:145], v245 offset:0
    s_cmp_ge_u32 s52, 2
    v_mfma_f32_16x16x32_bf16 v[44:47], v[156:159], v[112:115], v[44:47]
    ds_read_b64_tr_b16 v[146:147], v245 offset:512
    ds_read_b128 v[96:99], v246 offset:0
    v_mfma_f32_16x16x32_bf16 v[76:79], v[156:159], v[116:119], v[76:79]
    ds_read_b128 v[100:103], v246 offset:2048
    v_mfma_f32_16x16x32_bf16 v[16:19], v[160:163], v[108:111], v[16:19]
    ds_read_b128 v[104:107], v246 offset:4096
    s_cselect_b32 s44, s49, s48
    v_mfma_f32_16x16x32_bf16 v[48:51], v[160:163], v[112:115], v[48:51]
    ds_read_b64_tr_b16 v[148:149], v245 offset:32
    s_add_u32 m0, s58, 60416
    v_mfma_f32_16x16x32_bf16 v[80:83], v[160:163], v[116:119], v[80:83]
    ds_read_b64_tr_b16 v[150:151], v245 offset:544
    ds_read_b64_tr_b16 v[152:153], v245 offset:64
    v_mfma_f32_16x16x32_bf16 v[20:23], v[164:167], v[108:111], v[20:23]
    ds_read_b64_tr_b16 v[154:155], v245 offset:576
    s_add_u32 s44, s44, 3670016
    v_mfma_f32_16x16x32_bf16 v[52:55], v[164:167], v[112:115], v[52:55]
    buffer_load_dwordx4 v248, s[12:15], s44 offen lds
    s_add_u32 s44, s44, 130048
    v_mfma_f32_16x16x32_bf16 v[84:87], v[164:167], v[116:119], v[84:87]
    buffer_load_dwordx4 v248, s[12:15], s44 offen offset:1024 lds
    s_waitcnt lgkmcnt(4)
    v_mfma_f32_16x16x32_bf16 v[0:3], v[144:147], v[96:99], v[0:3]
    ds_read_b64_tr_b16 v[156:157], v245 offset:96
    s_cmp_ge_u32 s52, 2
    v_mfma_f32_16x16x32_bf16 v[32:35], v[144:147], v[100:103], v[32:35]
    ds_read_b64_tr_b16 v[158:159], v245 offset:608
    s_cselect_b32 s45, s51, s50
    v_mfma_f32_16x16x32_bf16 v[64:67], v[144:147], v[104:107], v[64:67]
    ds_read_b64_tr_b16 v[160:161], v245 offset:128
    s_add_u32 m0, s59, 77056
    s_waitcnt lgkmcnt(3)
    v_mfma_f32_16x16x32_bf16 v[4:7], v[148:151], v[96:99], v[4:7]
    ds_read_b64_tr_b16 v[162:163], v245 offset:640
    s_add_u32 s45, s45, 896
    v_mfma_f32_16x16x32_bf16 v[36:39], v[148:151], v[100:103], v[36:39]
    ds_read_b64_tr_b16 v[164:165], v245 offset:160
    buffer_load_dwordx4 v247, s[8:11], s45 offen lds
    v_mfma_f32_16x16x32_bf16 v[68:71], v[148:151], v[104:107], v[68:71]
    ds_read_b64_tr_b16 v[166:167], v245 offset:672
    v_mfma_f32_16x16x32_bf16 v[8:11], v[152:155], v[96:99], v[8:11]
    s_add_u32 m0, s59, 85248
    s_add_u32 s44, s45, 73728
    v_mfma_f32_16x16x32_bf16 v[40:43], v[152:155], v[100:103], v[40:43]
    buffer_load_dwordx4 v247, s[8:11], s44 offen lds
    s_add_u32 m0, s53, 77056
    v_mfma_f32_16x16x32_bf16 v[72:75], v[152:155], v[104:107], v[72:75]
    s_add_u32 s45, s45, s83
    buffer_load_dwordx4 v247, s[8:11], s45 offen lds
    s_waitcnt lgkmcnt(0)
    s_waitcnt vmcnt(13)
    s_barrier
    v_add_u32 v245, 112128, v242
    v_add_u32 v246, 128768, v244
    v_mfma_f32_16x16x32_bf16 v[12:15], v[156:159], v[96:99], v[12:15]
    ds_read_b64_tr_b16 v[144:145], v245 offset:0
    v_mfma_f32_16x16x32_bf16 v[44:47], v[156:159], v[100:103], v[44:47]
    ds_read_b64_tr_b16 v[146:147], v245 offset:512
    ds_read_b128 v[108:111], v246 offset:0
    v_mfma_f32_16x16x32_bf16 v[76:79], v[156:159], v[104:107], v[76:79]
    ds_read_b128 v[112:115], v246 offset:2048
    v_mfma_f32_16x16x32_bf16 v[16:19], v[160:163], v[96:99], v[16:19]
    ds_read_b128 v[116:119], v246 offset:4096
    v_mfma_f32_16x16x32_bf16 v[48:51], v[160:163], v[100:103], v[48:51]
    ds_read_b64_tr_b16 v[148:149], v245 offset:32
    v_mfma_f32_16x16x32_bf16 v[80:83], v[160:163], v[104:107], v[80:83]
    ds_read_b64_tr_b16 v[150:151], v245 offset:544
    ds_read_b64_tr_b16 v[152:153], v245 offset:64
    v_mfma_f32_16x16x32_bf16 v[20:23], v[164:167], v[96:99], v[20:23]
    ds_read_b64_tr_b16 v[154:155], v245 offset:576
    v_mfma_f32_16x16x32_bf16 v[52:55], v[164:167], v[100:103], v[52:55]
    s_cmp_ge_u32 s52, 2
    v_mfma_f32_16x16x32_bf16 v[84:87], v[164:167], v[104:107], v[84:87]
    s_cselect_b32 s44, s49, s48
    s_waitcnt lgkmcnt(4)
    v_mfma_f32_16x16x32_bf16 v[0:3], v[144:147], v[108:111], v[0:3]
    ds_read_b64_tr_b16 v[156:157], v245 offset:96
    v_mfma_f32_16x16x32_bf16 v[32:35], v[144:147], v[112:115], v[32:35]
    ds_read_b64_tr_b16 v[158:159], v245 offset:608
    v_mfma_f32_16x16x32_bf16 v[64:67], v[144:147], v[116:119], v[64:67]
    ds_read_b64_tr_b16 v[160:161], v245 offset:128
    s_add_u32 m0, s58, 95488
    s_waitcnt lgkmcnt(3)
    v_mfma_f32_16x16x32_bf16 v[4:7], v[148:151], v[108:111], v[4:7]
    ds_read_b64_tr_b16 v[162:163], v245 offset:640
    v_mfma_f32_16x16x32_bf16 v[36:39], v[148:151], v[112:115], v[36:39]
    ds_read_b64_tr_b16 v[164:165], v245 offset:160
    v_mfma_f32_16x16x32_bf16 v[68:71], v[148:151], v[116:119], v[68:71]
    ds_read_b64_tr_b16 v[166:167], v245 offset:672
    v_mfma_f32_16x16x32_bf16 v[8:11], v[152:155], v[108:111], v[8:11]
    s_add_u32 s44, s44, 3932160
    buffer_load_dwordx4 v248, s[12:15], s44 offen lds
    v_mfma_f32_16x16x32_bf16 v[40:43], v[152:155], v[112:115], v[40:43]
    s_add_u32 s44, s44, 130048
    v_mfma_f32_16x16x32_bf16 v[72:75], v[152:155], v[116:119], v[72:75]
    buffer_load_dwordx4 v248, s[12:15], s44 offen offset:1024 lds
    s_waitcnt lgkmcnt(0)
    s_waitcnt vmcnt(9)
    s_barrier
    v_add_u32 v245, 147200, v242
    v_add_u32 v246, 25344, v243
    v_mfma_f32_16x16x32_bf16 v[12:15], v[156:159], v[108:111], v[12:15]
    ds_read_b64_tr_b16 v[144:145], v245 offset:0
    s_cmp_ge_u32 s52, 1
    v_mfma_f32_16x16x32_bf16 v[44:47], v[156:159], v[112:115], v[44:47]
    ds_read_b64_tr_b16 v[146:147], v245 offset:512
    ds_read_b128 v[96:99], v246 offset:0
    v_mfma_f32_16x16x32_bf16 v[76:79], v[156:159], v[116:119], v[76:79]
    ds_read_b128 v[100:103], v246 offset:2048
    v_mfma_f32_16x16x32_bf16 v[16:19], v[160:163], v[108:111], v[16:19]
    ds_read_b128 v[104:107], v246 offset:4096
    s_cselect_b32 s44, s49, s48
    v_mfma_f32_16x16x32_bf16 v[48:51], v[160:163], v[112:115], v[48:51]
    ds_read_b64_tr_b16 v[148:149], v245 offset:32
    s_add_u32 m0, s58, 112128
    v_mfma_f32_16x16x32_bf16 v[80:83], v[160:163], v[116:119], v[80:83]
    ds_read_b64_tr_b16 v[150:151], v245 offset:544
    ds_read_b64_tr_b16 v[152:153], v245 offset:64
    v_mfma_f32_16x16x32_bf16 v[20:23], v[164:167], v[108:111], v[20:23]
    ds_read_b64_tr_b16 v[154:155], v245 offset:576
    s_add_u32 s44, s44, 4194304
    v_mfma_f32_16x16x32_bf16 v[52:55], v[164:167], v[112:115], v[52:55]
    buffer_load_dwordx4 v248, s[12:15], s44 offen lds
    s_add_u32 s44, s44, 130048
    v_mfma_f32_16x16x32_bf16 v[84:87], v[164:167], v[116:119], v[84:87]
    buffer_load_dwordx4 v248, s[12:15], s44 offen offset:1024 lds
    s_waitcnt lgkmcnt(4)
    v_mfma_f32_16x16x32_bf16 v[0:3], v[144:147], v[96:99], v[0:3]
    ds_read_b64_tr_b16 v[156:157], v245 offset:96
    s_cmp_ge_u32 s52, 1
    v_mfma_f32_16x16x32_bf16 v[32:35], v[144:147], v[100:103], v[32:35]
    ds_read_b64_tr_b16 v[158:159], v245 offset:608
    s_cselect_b32 s45, s51, s50
    v_mfma_f32_16x16x32_bf16 v[64:67], v[144:147], v[104:107], v[64:67]
    ds_read_b64_tr_b16 v[160:161], v245 offset:128
    s_add_u32 m0, s59, 128768
    s_waitcnt lgkmcnt(3)
    v_mfma_f32_16x16x32_bf16 v[4:7], v[148:151], v[96:99], v[4:7]
    ds_read_b64_tr_b16 v[162:163], v245 offset:640
    s_add_u32 s45, s45, 1024
    v_mfma_f32_16x16x32_bf16 v[36:39], v[148:151], v[100:103], v[36:39]
    ds_read_b64_tr_b16 v[164:165], v245 offset:160
    buffer_load_dwordx4 v247, s[8:11], s45 offen lds
    v_mfma_f32_16x16x32_bf16 v[68:71], v[148:151], v[104:107], v[68:71]
    ds_read_b64_tr_b16 v[166:167], v245 offset:672
    v_mfma_f32_16x16x32_bf16 v[8:11], v[152:155], v[96:99], v[8:11]
    s_add_u32 m0, s59, 136960
    s_add_u32 s44, s45, 73728
    v_mfma_f32_16x16x32_bf16 v[40:43], v[152:155], v[100:103], v[40:43]
    buffer_load_dwordx4 v247, s[8:11], s44 offen lds
    s_add_u32 m0, s53, 128768
    v_mfma_f32_16x16x32_bf16 v[72:75], v[152:155], v[104:107], v[72:75]
    s_add_u32 s45, s45, s83
    buffer_load_dwordx4 v247, s[8:11], s45 offen lds
    s_waitcnt lgkmcnt(0)
    s_waitcnt vmcnt(12)
    s_barrier
    v_add_u32 v245, 43776, v242
    v_add_u32 v246, 25344, v244
    v_mfma_f32_16x16x32_bf16 v[12:15], v[156:159], v[96:99], v[12:15]
    ds_read_b64_tr_b16 v[144:145], v245 offset:0
    v_mfma_f32_16x16x32_bf16 v[44:47], v[156:159], v[100:103], v[44:47]
    ds_read_b64_tr_b16 v[146:147], v245 offset:512
    ds_read_b128 v[108:111], v246 offset:0
    v_mfma_f32_16x16x32_bf16 v[76:79], v[156:159], v[104:107], v[76:79]
    ds_read_b128 v[112:115], v246 offset:2048
    v_mfma_f32_16x16x32_bf16 v[16:19], v[160:163], v[96:99], v[16:19]
    ds_read_b128 v[116:119], v246 offset:4096
    v_mfma_f32_16x16x32_bf16 v[48:51], v[160:163], v[100:103], v[48:51]
    ds_read_b64_tr_b16 v[148:149], v245 offset:32
    v_mfma_f32_16x16x32_bf16 v[80:83], v[160:163], v[104:107], v[80:83]
    ds_read_b64_tr_b16 v[150:151], v245 offset:544
    ds_read_b64_tr_b16 v[152:153], v245 offset:64
    v_mfma_f32_16x16x32_bf16 v[20:23], v[164:167], v[96:99], v[20:23]
    ds_read_b64_tr_b16 v[154:155], v245 offset:576
    v_mfma_f32_16x16x32_bf16 v[52:55], v[164:167], v[100:103], v[52:55]
    s_cmp_ge_u32 s52, 1
    v_mfma_f32_16x16x32_bf16 v[84:87], v[164:167], v[104:107], v[84:87]
    s_cselect_b32 s44, s49, s48
    s_waitcnt lgkmcnt(4)
    v_mfma_f32_16x16x32_bf16 v[0:3], v[144:147], v[108:111], v[0:3]
    ds_read_b64_tr_b16 v[156:157], v245 offset:96
    s_add_u32 m0, s58, 147200
    v_mfma_f32_16x16x32_bf16 v[32:35], v[144:147], v[112:115], v[32:35]
    ds_read_b64_tr_b16 v[158:159], v245 offset:608
    v_mfma_f32_16x16x32_bf16 v[64:67], v[144:147], v[116:119], v[64:67]
    ds_read_b64_tr_b16 v[160:161], v245 offset:128
    s_waitcnt lgkmcnt(3)
    v_mfma_f32_16x16x32_bf16 v[4:7], v[148:151], v[108:111], v[4:7]
    ds_read_b64_tr_b16 v[162:163], v245 offset:640
    s_add_u32 s44, s44, 4456448
    v_mfma_f32_16x16x32_bf16 v[36:39], v[148:151], v[112:115], v[36:39]
    ds_read_b64_tr_b16 v[164:165], v245 offset:160
    v_mfma_f32_16x16x32_bf16 v[68:71], v[148:151], v[116:119], v[68:71]
    ds_read_b64_tr_b16 v[166:167], v245 offset:672
    v_mfma_f32_16x16x32_bf16 v[8:11], v[152:155], v[108:111], v[8:11]
    buffer_load_dwordx4 v248, s[12:15], s44 offen lds
    v_mfma_f32_16x16x32_bf16 v[40:43], v[152:155], v[112:115], v[40:43]
    s_add_u32 s44, s44, 130048
    buffer_load_dwordx4 v248, s[12:15], s44 offen offset:1024 lds
    v_mfma_f32_16x16x32_bf16 v[72:75], v[152:155], v[116:119], v[72:75]
    buffer_load_dword v184, off, s[88:91], s35 sc1
    s_waitcnt lgkmcnt(0)
    s_waitcnt vmcnt(10)
    s_barrier
    v_add_u32 v245, 60416, v242
    v_add_u32 v246, 77056, v243
    v_mfma_f32_16x16x32_bf16 v[12:15], v[156:159], v[108:111], v[12:15]
    ds_read_b64_tr_b16 v[144:145], v245 offset:0
    v_mfma_f32_16x16x32_bf16 v[44:47], v[156:159], v[112:115], v[44:47]
    ds_read_b64_tr_b16 v[146:147], v245 offset:512
    ds_read_b128 v[96:99], v246 offset:0
    v_mfma_f32_16x16x32_bf16 v[76:79], v[156:159], v[116:119], v[76:79]
    ds_read_b128 v[100:103], v246 offset:2048
    v_mfma_f32_16x16x32_bf16 v[16:19], v[160:163], v[108:111], v[16:19]
    ds_read_b128 v[104:107], v246 offset:4096
    v_mfma_f32_16x16x32_bf16 v[48:51], v[160:163], v[112:115], v[48:51]
    ds_read_b64_tr_b16 v[148:149], v245 offset:32
    v_mfma_f32_16x16x32_bf16 v[80:83], v[160:163], v[116:119], v[80:83]
    ds_read_b64_tr_b16 v[150:151], v245 offset:544
    ds_read_b64_tr_b16 v[152:153], v245 offset:64
    v_mfma_f32_16x16x32_bf16 v[20:23], v[164:167], v[108:111], v[20:23]
    ds_read_b64_tr_b16 v[154:155], v245 offset:576
    v_mfma_f32_16x16x32_bf16 v[52:55], v[164:167], v[112:115], v[52:55]
    v_mfma_f32_16x16x32_bf16 v[84:87], v[164:167], v[116:119], v[84:87]
    s_waitcnt lgkmcnt(4)
    v_mfma_f32_16x16x32_bf16 v[0:3], v[144:147], v[96:99], v[0:3]
    ds_read_b64_tr_b16 v[156:157], v245 offset:96
    v_mfma_f32_16x16x32_bf16 v[32:35], v[144:147], v[100:103], v[32:35]
    ds_read_b64_tr_b16 v[158:159], v245 offset:608
    v_mfma_f32_16x16x32_bf16 v[64:67], v[144:147], v[104:107], v[64:67]
    ds_read_b64_tr_b16 v[160:161], v245 offset:128
    s_waitcnt lgkmcnt(3)
    v_mfma_f32_16x16x32_bf16 v[4:7], v[148:151], v[96:99], v[4:7]
    ds_read_b64_tr_b16 v[162:163], v245 offset:640
    v_mfma_f32_16x16x32_bf16 v[36:39], v[148:151], v[100:103], v[36:39]
    ds_read_b64_tr_b16 v[164:165], v245 offset:160
    v_mfma_f32_16x16x32_bf16 v[68:71], v[148:151], v[104:107], v[68:71]
    ds_read_b64_tr_b16 v[166:167], v245 offset:672
    v_mfma_f32_16x16x32_bf16 v[8:11], v[152:155], v[96:99], v[8:11]
    v_mfma_f32_16x16x32_bf16 v[40:43], v[152:155], v[100:103], v[40:43]
    v_mfma_f32_16x16x32_bf16 v[72:75], v[152:155], v[104:107], v[72:75]
    s_waitcnt lgkmcnt(0)
    s_waitcnt vmcnt(8)
    s_barrier
    v_add_u32 v245, 95488, v242
    v_add_u32 v246, 77056, v244
    v_mfma_f32_16x16x32_bf16 v[12:15], v[156:159], v[96:99], v[12:15]
    ds_read_b64_tr_b16 v[144:145], v245 offset:0
    v_mfma_f32_16x16x32_bf16 v[44:47], v[156:159], v[100:103], v[44:47]
    ds_read_b64_tr_b16 v[146:147], v245 offset:512
    ds_read_b128 v[108:111], v246 offset:0
    v_mfma_f32_16x16x32_bf16 v[76:79], v[156:159], v[104:107], v[76:79]
    ds_read_b128 v[112:115], v246 offset:2048
    v_mfma_f32_16x16x32_bf16 v[16:19], v[160:163], v[96:99], v[16:19]
    ds_read_b128 v[116:119], v246 offset:4096
    v_mfma_f32_16x16x32_bf16 v[48:51], v[160:163], v[100:103], v[48:51]
    ds_read_b64_tr_b16 v[148:149], v245 offset:32
    v_mfma_f32_16x16x32_bf16 v[80:83], v[160:163], v[104:107], v[80:83]
    ds_read_b64_tr_b16 v[150:151], v245 offset:544
    ds_read_b64_tr_b16 v[152:153], v245 offset:64
    v_mfma_f32_16x16x32_bf16 v[20:23], v[164:167], v[96:99], v[20:23]
    ds_read_b64_tr_b16 v[154:155], v245 offset:576
    v_mfma_f32_16x16x32_bf16 v[52:55], v[164:167], v[100:103], v[52:55]
    v_mfma_f32_16x16x32_bf16 v[84:87], v[164:167], v[104:107], v[84:87]
    s_waitcnt lgkmcnt(4)
    v_mfma_f32_16x16x32_bf16 v[0:3], v[144:147], v[108:111], v[0:3]
    ds_read_b64_tr_b16 v[156:157], v245 offset:96
    v_mfma_f32_16x16x32_bf16 v[32:35], v[144:147], v[112:115], v[32:35]
    ds_read_b64_tr_b16 v[158:159], v245 offset:608
    v_mfma_f32_16x16x32_bf16 v[64:67], v[144:147], v[116:119], v[64:67]
    ds_read_b64_tr_b16 v[160:161], v245 offset:128
    s_waitcnt lgkmcnt(3)
    v_mfma_f32_16x16x32_bf16 v[4:7], v[148:151], v[108:111], v[4:7]
    ds_read_b64_tr_b16 v[162:163], v245 offset:640
    v_mfma_f32_16x16x32_bf16 v[36:39], v[148:151], v[112:115], v[36:39]
    ds_read_b64_tr_b16 v[164:165], v245 offset:160
    v_mfma_f32_16x16x32_bf16 v[68:71], v[148:151], v[116:119], v[68:71]
    ds_read_b64_tr_b16 v[166:167], v245 offset:672
    v_mfma_f32_16x16x32_bf16 v[8:11], v[152:155], v[108:111], v[8:11]
    v_mfma_f32_16x16x32_bf16 v[40:43], v[152:155], v[112:115], v[40:43]
    v_mfma_f32_16x16x32_bf16 v[72:75], v[152:155], v[116:119], v[72:75]
    s_waitcnt lgkmcnt(0)
    s_waitcnt vmcnt(3)
    s_barrier
    v_add_u32 v245, 112128, v242
    v_add_u32 v246, 128768, v243
    v_mfma_f32_16x16x32_bf16 v[12:15], v[156:159], v[108:111], v[12:15]
    ds_read_b64_tr_b16 v[144:145], v245 offset:0
    v_mfma_f32_16x16x32_bf16 v[44:47], v[156:159], v[112:115], v[44:47]
    ds_read_b64_tr_b16 v[146:147], v245 offset:512
    ds_read_b128 v[96:99], v246 offset:0
    v_mfma_f32_16x16x32_bf16 v[76:79], v[156:159], v[116:119], v[76:79]
    ds_read_b128 v[100:103], v246 offset:2048
    v_mfma_f32_16x16x32_bf16 v[16:19], v[160:163], v[108:111], v[16:19]
    ds_read_b128 v[104:107], v246 offset:4096
    v_mfma_f32_16x16x32_bf16 v[48:51], v[160:163], v[112:115], v[48:51]
    ds_read_b64_tr_b16 v[148:149], v245 offset:32
    v_mfma_f32_16x16x32_bf16 v[80:83], v[160:163], v[116:119], v[80:83]
    ds_read_b64_tr_b16 v[150:151], v245 offset:544
    ds_read_b64_tr_b16 v[152:153], v245 offset:64
    v_mfma_f32_16x16x32_bf16 v[20:23], v[164:167], v[108:111], v[20:23]
    ds_read_b64_tr_b16 v[154:155], v245 offset:576
    v_mfma_f32_16x16x32_bf16 v[52:55], v[164:167], v[112:115], v[52:55]
    v_mfma_f32_16x16x32_bf16 v[84:87], v[164:167], v[116:119], v[84:87]
    s_waitcnt lgkmcnt(4)
    v_mfma_f32_16x16x32_bf16 v[0:3], v[144:147], v[96:99], v[0:3]
    ds_read_b64_tr_b16 v[156:157], v245 offset:96
    v_mfma_f32_16x16x32_bf16 v[32:35], v[144:147], v[100:103], v[32:35]
    ds_read_b64_tr_b16 v[158:159], v245 offset:608
    v_mfma_f32_16x16x32_bf16 v[64:67], v[144:147], v[104:107], v[64:67]
    ds_read_b64_tr_b16 v[160:161], v245 offset:128
    s_waitcnt lgkmcnt(3)
    v_mfma_f32_16x16x32_bf16 v[4:7], v[148:151], v[96:99], v[4:7]
    ds_read_b64_tr_b16 v[162:163], v245 offset:640
    v_mfma_f32_16x16x32_bf16 v[36:39], v[148:151], v[100:103], v[36:39]
    ds_read_b64_tr_b16 v[164:165], v245 offset:160
    v_mfma_f32_16x16x32_bf16 v[68:71], v[148:151], v[104:107], v[68:71]
    ds_read_b64_tr_b16 v[166:167], v245 offset:672
    v_mfma_f32_16x16x32_bf16 v[8:11], v[152:155], v[96:99], v[8:11]
    v_mfma_f32_16x16x32_bf16 v[40:43], v[152:155], v[100:103], v[40:43]
    v_mfma_f32_16x16x32_bf16 v[72:75], v[152:155], v[104:107], v[72:75]
    s_waitcnt lgkmcnt(0)
    s_waitcnt vmcnt(1)
    s_barrier
    v_add_u32 v245, 147200, v242
    v_add_u32 v246, 128768, v244
    v_mfma_f32_16x16x32_bf16 v[12:15], v[156:159], v[96:99], v[12:15]
    ds_read_b64_tr_b16 v[144:145], v245 offset:0
    v_mfma_f32_16x16x32_bf16 v[44:47], v[156:159], v[100:103], v[44:47]
    ds_read_b64_tr_b16 v[146:147], v245 offset:512
    ds_read_b128 v[108:111], v246 offset:0
    v_mfma_f32_16x16x32_bf16 v[76:79], v[156:159], v[104:107], v[76:79]
    ds_read_b128 v[112:115], v246 offset:2048
    v_mfma_f32_16x16x32_bf16 v[16:19], v[160:163], v[96:99], v[16:19]
    ds_read_b128 v[116:119], v246 offset:4096
    v_mfma_f32_16x16x32_bf16 v[48:51], v[160:163], v[100:103], v[48:51]
    ds_read_b64_tr_b16 v[148:149], v245 offset:32
    v_mfma_f32_16x16x32_bf16 v[80:83], v[160:163], v[104:107], v[80:83]
    ds_read_b64_tr_b16 v[150:151], v245 offset:544
    ds_read_b64_tr_b16 v[152:153], v245 offset:64
    v_mfma_f32_16x16x32_bf16 v[20:23], v[164:167], v[96:99], v[20:23]
    ds_read_b64_tr_b16 v[154:155], v245 offset:576
    v_mfma_f32_16x16x32_bf16 v[52:55], v[164:167], v[100:103], v[52:55]
    v_mfma_f32_16x16x32_bf16 v[84:87], v[164:167], v[104:107], v[84:87]
    s_waitcnt lgkmcnt(4)
    v_mfma_f32_16x16x32_bf16 v[0:3], v[144:147], v[108:111], v[0:3]
    ds_read_b64_tr_b16 v[156:157], v245 offset:96
    v_mfma_f32_16x16x32_bf16 v[32:35], v[144:147], v[112:115], v[32:35]
    ds_read_b64_tr_b16 v[158:159], v245 offset:608
    v_mfma_f32_16x16x32_bf16 v[64:67], v[144:147], v[116:119], v[64:67]
    ds_read_b64_tr_b16 v[160:161], v245 offset:128
    s_waitcnt lgkmcnt(3)
    v_mfma_f32_16x16x32_bf16 v[4:7], v[148:151], v[108:111], v[4:7]
    ds_read_b64_tr_b16 v[162:163], v245 offset:640
    v_mfma_f32_16x16x32_bf16 v[36:39], v[148:151], v[112:115], v[36:39]
    ds_read_b64_tr_b16 v[164:165], v245 offset:160
    v_mfma_f32_16x16x32_bf16 v[68:71], v[148:151], v[116:119], v[68:71]
    ds_read_b64_tr_b16 v[166:167], v245 offset:672
    v_mfma_f32_16x16x32_bf16 v[8:11], v[152:155], v[108:111], v[8:11]
    v_mfma_f32_16x16x32_bf16 v[40:43], v[152:155], v[112:115], v[40:43]
    v_mfma_f32_16x16x32_bf16 v[72:75], v[152:155], v[116:119], v[72:75]
    s_waitcnt lgkmcnt(0)
    s_barrier
    v_mfma_f32_16x16x32_bf16 v[12:15], v[156:159], v[108:111], v[12:15]
    v_mfma_f32_16x16x32_bf16 v[44:47], v[156:159], v[112:115], v[44:47]
    v_mfma_f32_16x16x32_bf16 v[76:79], v[156:159], v[116:119], v[76:79]
    v_mfma_f32_16x16x32_bf16 v[16:19], v[160:163], v[108:111], v[16:19]
    v_mfma_f32_16x16x32_bf16 v[48:51], v[160:163], v[112:115], v[48:51]
    v_mfma_f32_16x16x32_bf16 v[80:83], v[160:163], v[116:119], v[80:83]
    v_mfma_f32_16x16x32_bf16 v[20:23], v[164:167], v[108:111], v[20:23]
    v_mfma_f32_16x16x32_bf16 v[52:55], v[164:167], v[112:115], v[52:55]
    v_mfma_f32_16x16x32_bf16 v[84:87], v[164:167], v[116:119], v[84:87]
    v_mov_b32 v244, v220
    v_mov_b32 v245, v221
    v_mov_b32 v246, v222
    v_mov_b32 v248, v202
    s_mov_b32 s76, 0
    s_waitcnt vmcnt(0)
w0_rg:
    v_readfirstlane_b32 s44, v184
    s_nop 0
    s_cmp_eq_u32 s44, 16
    s_cbranch_scc1 w0_rg_ok
    s_sleep 16
    buffer_load_dword v184, off, s[88:91], s35 sc1
    s_waitcnt vmcnt(0)
    s_branch w0_rg
w0_rg_ok:
    v_pk_mul_f32 v[0:1], v[0:1], s[56:57]
    v_pk_mul_f32 v[2:3], v[2:3], s[56:57]
    v_pk_mul_f32 v[4:5], v[4:5], s[56:57]
    v_pk_mul_f32 v[6:7], v[6:7], s[56:57]
    v_pk_mul_f32 v[8:9], v[8:9], s[56:57]
    v_pk_mul_f32 v[10:11], v[10:11], s[56:57]
    v_pk_mul_f32 v[12:13], v[12:13], s[56:57]
    v_pk_mul_f32 v[14:15], v[14:15], s[56:57]
    v_pk_mul_f32 v[16:17], v[16:17], s[56:57]
    v_pk_mul_f32 v[18:19], v[18:19], s[56:57]
    v_pk_mul_f32 v[20:21], v[20:21], s[56:57]
    v_pk_mul_f32 v[22:23], v[22:23], s[56:57]
    v_pk_mul_f32 v[32:33], v[32:33], s[56:57]
    v_pk_mul_f32 v[34:35], v[34:35], s[56:57]
    v_pk_mul_f32 v[36:37], v[36:37], s[56:57]
    v_pk_mul_f32 v[38:39], v[38:39], s[56:57]
    v_pk_mul_f32 v[40:41], v[40:41], s[56:57]
    v_pk_mul_f32 v[42:43], v[42:43], s[56:57]
    v_pk_mul_f32 v[44:45], v[44:45], s[56:57]
    v_pk_mul_f32 v[46:47], v[46:47], s[56:57]
    v_pk_mul_f32 v[48:49], v[48:49], s[56:57]
    v_pk_mul_f32 v[50:51], v[50:51], s[56:57]
    v_pk_mul_f32 v[52:53], v[52:53], s[56:57]
    v_pk_mul_f32 v[54:55], v[54:55], s[56:57]
    v_pk_mul_f32 v[64:65], v[64:65], s[56:57]
    v_pk_mul_f32 v[66:67], v[66:67], s[56:57]
    v_pk_mul_f32 v[68:69], v[68:69], s[56:57]
    v_pk_mul_f32 v[70:71], v[70:71], s[56:57]
    v_pk_mul_f32 v[72:73], v[72:73], s[56:57]
    v_pk_mul_f32 v[74:75], v[74:75], s[56:57]
    v_pk_mul_f32 v[76:77], v[76:77], s[56:57]
    v_pk_mul_f32 v[78:79], v[78:79], s[56:57]
    v_pk_mul_f32 v[80:81], v[80:81], s[56:57]
    v_pk_mul_f32 v[82:83], v[82:83], s[56:57]
    v_pk_mul_f32 v[84:85], v[84:85], s[56:57]
    v_pk_mul_f32 v[86:87], v[86:87], s[56:57]
    v_cvt_pk_bf16_f32 v96, v0, v1
    v_cvt_pk_bf16_f32 v97, v2, v3
    v_cvt_pk_bf16_f32 v98, v4, v5
    v_cvt_pk_bf16_f32 v99, v6, v7
    v_cvt_pk_bf16_f32 v100, v8, v9
    v_cvt_pk_bf16_f32 v101, v10, v11
    v_cvt_pk_bf16_f32 v102, v12, v13
    v_cvt_pk_bf16_f32 v103, v14, v15
    v_cvt_pk_bf16_f32 v104, v16, v17
    v_cvt_pk_bf16_f32 v105, v18, v19
    v_cvt_pk_bf16_f32 v106, v20, v21
    v_cvt_pk_bf16_f32 v107, v22, v23
    v_cvt_pk_bf16_f32 v112, v32, v33
    v_cvt_pk_bf16_f32 v113, v34, v35
    v_cvt_pk_bf16_f32 v114, v36, v37
    v_cvt_pk_bf16_f32 v115, v38, v39
    v_cvt_pk_bf16_f32 v116, v40, v41
    v_cvt_pk_bf16_f32 v117, v42, v43
    v_cvt_pk_bf16_f32 v118, v44, v45
    v_cvt_pk_bf16_f32 v119, v46, v47
    v_cvt_pk_bf16_f32 v120, v48, v49
    v_cvt_pk_bf16_f32 v121, v50, v51
    v_cvt_pk_bf16_f32 v122, v52, v53
    v_cvt_pk_bf16_f32 v123, v54, v55
    v_cvt_pk_bf16_f32 v128, v64, v65
    v_cvt_pk_bf16_f32 v129, v66, v67
    v_cvt_pk_bf16_f32 v130, v68, v69
    v_cvt_pk_bf16_f32 v131, v70, v71
    v_cvt_pk_bf16_f32 v132, v72, v73
    v_cvt_pk_bf16_f32 v133, v74, v75
    v_cvt_pk_bf16_f32 v134, v76, v77
    v_cvt_pk_bf16_f32 v135, v78, v79
    v_cvt_pk_bf16_f32 v136, v80, v81
    v_cvt_pk_bf16_f32 v137, v82, v83
    v_cvt_pk_bf16_f32 v138, v84, v85
    v_cvt_pk_bf16_f32 v139, v86, v87
    v_permlane32_swap_b32 v96, v98
    v_permlane32_swap_b32 v97, v99
    v_permlane32_swap_b32 v100, v102
    v_permlane32_swap_b32 v101, v103
    v_permlane32_swap_b32 v104, v106
    v_permlane32_swap_b32 v105, v107
    v_permlane32_swap_b32 v112, v114
    v_permlane32_swap_b32 v113, v115
    v_permlane32_swap_b32 v116, v118
    v_permlane32_swap_b32 v117, v119
    v_permlane32_swap_b32 v120, v122
    v_permlane32_swap_b32 v121, v123
    v_permlane32_swap_b32 v128, v130
    v_permlane32_swap_b32 v129, v131
    v_permlane32_swap_b32 v132, v134
    v_permlane32_swap_b32 v133, v135
    v_permlane32_swap_b32 v136, v138
    v_permlane32_swap_b32 v137, v139
    v_permlane16_swap_b32 v96, v98
    v_permlane16_swap_b32 v97, v99
    v_permlane16_swap_b32 v100, v102
    v_permlane16_swap_b32 v101, v103
    v_permlane16_swap_b32 v104, v106
    v_permlane16_swap_b32 v105, v107
    v_permlane16_swap_b32 v112, v114
    v_permlane16_swap_b32 v113, v115
    v_permlane16_swap_b32 v116, v118
    v_permlane16_swap_b32 v117, v119
    v_permlane16_swap_b32 v120, v122
    v_permlane16_swap_b32 v121, v123
    v_permlane16_swap_b32 v128, v130
    v_permlane16_swap_b32 v129, v131
    v_permlane16_swap_b32 v132, v134
    v_permlane16_swap_b32 v133, v135
    v_permlane16_swap_b32 v136, v138
    v_permlane16_swap_b32 v137, v139
    v_mov_b64 v[0:1], 0
    v_mov_b64 v[2:3], 0
    v_mov_b64 v[4:5], 0
    v_mov_b64 v[6:7], 0
    v_mov_b64 v[8:9], 0
    v_mov_b64 v[10:11], 0
    v_mov_b64 v[12:13], 0
    v_mov_b64 v[14:15], 0
    v_mov_b64 v[16:17], 0
    v_mov_b64 v[18:19], 0
    v_mov_b64 v[20:21], 0
    v_mov_b64 v[22:23], 0
    v_mov_b64 v[24:25], 0
    v_mov_b64 v[26:27], 0
    v_mov_b64 v[28:29], 0
    v_mov_b64 v[30:31], 0
    v_mov_b64 v[220:221], 0
    v_mov_b64 v[222:223], 0
    v_mov_b32 v232, 0
    v_mov_b64 v[32:33], 0
    v_mov_b64 v[34:35], 0
    v_mov_b64 v[36:37], 0
    v_mov_b64 v[38:39], 0
    v_mov_b64 v[40:41], 0
    v_mov_b64 v[42:43], 0
    v_mov_b64 v[44:45], 0
    v_mov_b64 v[46:47], 0
    v_mov_b64 v[48:49], 0
    v_mov_b64 v[50:51], 0
    v_mov_b64 v[52:53], 0
    v_mov_b64 v[54:55], 0
    v_mov_b64 v[56:57], 0
    v_mov_b64 v[58:59], 0
    v_mov_b64 v[60:61], 0
    v_mov_b64 v[62:63], 0
    v_mov_b64 v[224:225], 0
    v_mov_b64 v[226:227], 0
    v_mov_b32 v233, 0
    v_mov_b64 v[64:65], 0
    v_mov_b64 v[66:67], 0
    v_mov_b64 v[68:69], 0
    v_mov_b64 v[70:71], 0
    v_mov_b64 v[72:73], 0
    v_mov_b64 v[74:75], 0
    v_mov_b64 v[76:77], 0
    v_mov_b64 v[78:79], 0
    v_mov_b64 v[80:81], 0
    v_mov_b64 v[82:83], 0
    v_mov_b64 v[84:85], 0
    v_mov_b64 v[86:87], 0
    v_mov_b64 v[88:89], 0
    v_mov_b64 v[90:91], 0
    v_mov_b64 v[92:93], 0
    v_mov_b64 v[94:95], 0
    v_mov_b64 v[228:229], 0
    v_mov_b64 v[230:231], 0
    v_mov_b32 v234, 0
    v_mov_b64 v[216:217], 0
    v_mov_b64 v[218:219], 0
    s_add_u32 s37, s37, 8192
    s_mov_b32 s39, 33792
    s_mov_b32 s54, 67584
    s_mov_b32 s41, 0
    s_mov_b32 s40, 0
    s_mov_b32 s42, 0xbf800000
    s_mov_b32 s43, 0xff800000
    s_waitcnt lgkmcnt(0)
    s_mov_b32 s12, s4
    s_mov_b32 s13, s5
    s_mov_b32 s8, s6
    s_mov_b32 s9, s7
    s_barrier
    ds_read_b128 v[108:111], v249 offset:0
    ds_read_b128 v[124:127], v249 offset:1024
    ds_read_b128 v[140:143], v249 offset:2048
    s_waitcnt lgkmcnt(0)
w0_loop:
    s_barrier
    v_add_u32 v237, s40, v239
    v_mfma_f32_16x16x32_bf16 v[64:67], v[144:147], v[216:219], v[64:67]
    ds_read_b128 v[144:147], v237 offset:0
    v_mfma_f32_16x16x32_bf16 v[68:71], v[148:151], v[216:219], v[68:71]
    ds_read_b128 v[148:151], v237 offset:64
    v_mfma_f32_16x16x32_bf16 v[72:75], v[152:155], v[216:219], v[72:75]
    ds_read_b128 v[152:155], v237 offset:128
    v_mfma_f32_16x16x32_bf16 v[76:79], v[156:159], v[216:219], v[76:79]
    ds_read_b128 v[156:159], v237 offset:192
    v_mfma_f32_16x16x32_bf16 v[80:83], v[160:163], v[216:219], v[80:83]
    ds_read_b128 v[160:163], v237 offset:512
    v_mfma_f32_16x16x32_bf16 v[84:87], v[164:167], v[216:219], v[84:87]
    ds_read_b128 v[164:167], v237 offset:576
    v_mfma_f32_16x16x32_bf16 v[88:91], v[168:171], v[216:219], v[88:91]
    ds_read_b128 v[168:171], v237 offset:640
    v_mfma_f32_16x16x32_bf16 v[92:95], v[172:175], v[216:219], v[92:95]
    ds_read_b128 v[172:175], v237 offset:704
    s_waitcnt lgkmcnt(6)
    v_mfma_f32_16x16x32_bf16 v[176:179], v[144:147], v[96:99], v[220:223]
    v_mfma_f32_16x16x32_bf16 v[176:179], v[148:151], v[100:103], v[176:179]
    s_waitcnt lgkmcnt(4)
    v_mfma_f32_16x16x32_bf16 v[176:179], v[152:155], v[104:107], v[176:179]
    v_add_u32 v238, s40, v240
    v_mfma_f32_16x16x32_bf16 v[176:179], v[156:159], v[108:111], v[176:179]
    s_add_u32 s41, s41, 1
    s_waitcnt lgkmcnt(2)
    v_mfma_f32_16x16x32_bf16 v[180:183], v[160:163], v[96:99], v[220:223]
    s_add_u32 s40, s40, 33792
    v_mfma_f32_16x16x32_bf16 v[180:183], v[164:167], v[100:103], v[180:183]
    s_waitcnt lgkmcnt(0)
    v_mfma_f32_16x16x32_bf16 v[180:183], v[168:171], v[104:107], v[180:183]
    s_cmp_ge_u32 s40, 135168
    v_mfma_f32_16x16x32_bf16 v[180:183], v[172:175], v[108:111], v[180:183]
    s_cselect_b32 s40, 0, s40
    v_mfma_f32_16x16x32_bf16 v[184:187], v[144:147], v[112:115], v[224:227]
    v_exp_f32 v200, v176
    v_exp_f32 v201, v177
    v_mfma_f32_16x16x32_bf16 v[184:187], v[148:151], v[116:119], v[184:187]
    v_exp_f32 v202, v178
    v_mfma_f32_16x16x32_bf16 v[184:187], v[152:155], v[120:123], v[184:187]
    v_exp_f32 v203, v179
    v_add_f32 v235, v200, v201
    v_mfma_f32_16x16x32_bf16 v[184:187], v[156:159], v[124:127], v[184:187]
    v_add_f32 v236, v202, v203
    v_cvt_pk_bf16_f32 v208, v200, v201
    v_cvt_pk_bf16_f32 v209, v202, v203
    v_mfma_f32_16x16x32_bf16 v[188:191], v[160:163], v[112:115], v[224:227]
    v_exp_f32 v204, v180
    v_exp_f32 v205, v181
    v_mfma_f32_16x16x32_bf16 v[188:191], v[164:167], v[116:119], v[188:191]
    v_add_f32 v235, v235, v236
    v_exp_f32 v206, v182
    v_mfma_f32_16x16x32_bf16 v[188:191], v[168:171], v[120:123], v[188:191]
    v_add_f32 v236, v204, v205
    v_exp_f32 v207, v183
    v_mfma_f32_16x16x32_bf16 v[188:191], v[172:175], v[124:127], v[188:191]
    v_add_f32 v235, v235, v206
    v_add_f32 v236, v236, v207
    v_cvt_pk_bf16_f32 v210, v204, v205
    v_mfma_f32_16x16x32_bf16 v[192:195], v[144:147], v[128:131], v[228:231]
    ds_read_b64_tr_b16 v[144:145], v238 offset:0
    ds_read_b64_tr_b16 v[146:147], v238 offset:512
    v_add_f32 v235, v235, v236
    v_mfma_f32_16x16x32_bf16 v[192:195], v[148:151], v[132:135], v[192:195]
    ds_read_b64_tr_b16 v[148:149], v238 offset:32
    ds_read_b64_tr_b16 v[150:151], v238 offset:544
    v_cvt_pk_bf16_f32 v211, v206, v207
    v_mfma_f32_16x16x32_bf16 v[192:195], v[152:155], v[136:139], v[192:195]
    ds_read_b64_tr_b16 v[152:153], v238 offset:64
    ds_read_b64_tr_b16 v[154:155], v238 offset:576
    v_cmp_nge_f32 vcc, s42, v235
    v_mfma_f32_16x16x32_bf16 v[192:195], v[156:159], v[140:143], v[192:195]
    ds_read_b64_tr_b16 v[156:157], v238 offset:96
    ds_read_b64_tr_b16 v[158:159], v238 offset:608
    v_exp_f32 v200, v184
    v_mfma_f32_16x16x32_bf16 v[196:199], v[160:163], v[128:131], v[228:231]
    ds_read_b64_tr_b16 v[160:161], v238 offset:128
    ds_read_b64_tr_b16 v[162:163], v238 offset:640
    s_cbranch_vccnz w0_rare0
w0_back0:
    v_add_f32 v232, v232, v235
    v_mfma_f32_16x16x32_bf16 v[196:199], v[164:167], v[132:135], v[196:199]
    ds_read_b64_tr_b16 v[164:165], v238 offset:160
    ds_read_b64_tr_b16 v[166:167], v238 offset:672
    v_exp_f32 v201, v185
    v_mfma_f32_16x16x32_bf16 v[196:199], v[168:171], v[136:139], v[196:199]
    ds_read_b64_tr_b16 v[168:169], v238 offset:192
    ds_read_b64_tr_b16 v[170:171], v238 offset:704
    v_exp_f32 v202, v186
    v_mfma_f32_16x16x32_bf16 v[196:199], v[172:175], v[140:143], v[196:199]
    ds_read_b64_tr_b16 v[172:173], v238 offset:224
    ds_read_b64_tr_b16 v[174:175], v238 offset:736
    v_exp_f32 v203, v187
    s_waitcnt lgkmcnt(12)
    v_mfma_f32_16x16x32_bf16 v[0:3], v[144:147], v[208:211], v[0:3]
    v_add_f32 v242, v200, v201
    v_add_f32 v236, v202, v203
    v_cvt_pk_bf16_f32 v212, v200, v201
    v_cvt_pk_bf16_f32 v213, v202, v203
    v_mfma_f32_16x16x32_bf16 v[4:7], v[148:151], v[208:211], v[4:7]
    v_exp_f32 v204, v188
    v_exp_f32 v205, v189
    s_waitcnt lgkmcnt(8)
    v_mfma_f32_16x16x32_bf16 v[8:11], v[152:155], v[208:211], v[8:11]
    v_add_f32 v242, v242, v236
    v_exp_f32 v206, v190
    v_add_f32 v236, v204, v205
    v_mfma_f32_16x16x32_bf16 v[12:15], v[156:159], v[208:211], v[12:15]
    v_exp_f32 v207, v191
    v_add_f32 v242, v242, v206
    v_add_f32 v236, v236, v207
    s_waitcnt lgkmcnt(4)
    v_mfma_f32_16x16x32_bf16 v[16:19], v[160:163], v[208:211], v[16:19]
    v_cvt_pk_bf16_f32 v214, v204, v205
    v_add_f32 v242, v242, v236
    v_cvt_pk_bf16_f32 v215, v206, v207
    v_cmp_nge_f32 vcc, s42, v242
    v_mfma_f32_16x16x32_bf16 v[20:23], v[164:167], v[208:211], v[20:23]
    v_exp_f32 v200, v192
    v_exp_f32 v201, v193
    s_waitcnt lgkmcnt(0)
    v_mfma_f32_16x16x32_bf16 v[24:27], v[168:171], v[208:211], v[24:27]
    s_cbranch_vccnz w0_rare1
w0_back1:
    v_add_f32 v233, v233, v242
    v_mfma_f32_16x16x32_bf16 v[28:31], v[172:175], v[208:211], v[28:31]
    v_exp_f32 v202, v194
    v_exp_f32 v203, v195
    v_mfma_f32_16x16x32_bf16 v[32:35], v[144:147], v[212:215], v[32:35]
    v_add_f32 v243, v200, v201
    v_add_f32 v236, v202, v203
    v_cvt_pk_bf16_f32 v216, v200, v201
    v_mfma_f32_16x16x32_bf16 v[36:39], v[148:151], v[212:215], v[36:39]
    v_cvt_pk_bf16_f32 v217, v202, v203
    v_exp_f32 v204, v196
    v_mfma_f32_16x16x32_bf16 v[40:43], v[152:155], v[212:215], v[40:43]
    v_exp_f32 v205, v197
    v_add_f32 v243, v243, v236
    v_exp_f32 v206, v198
    v_mfma_f32_16x16x32_bf16 v[44:47], v[156:159], v[212:215], v[44:47]
    v_add_f32 v236, v204, v205
    v_exp_f32 v207, v199
    v_mfma_f32_16x16x32_bf16 v[48:51], v[160:163], v[212:215], v[48:51]
    v_add_f32 v243, v243, v206
    v_add_f32 v236, v236, v207
    v_cvt_pk_bf16_f32 v218, v204, v205
    v_mfma_f32_16x16x32_bf16 v[52:55], v[164:167], v[212:215], v[52:55]
    v_add_f32 v243, v243, v236
    v_cvt_pk_bf16_f32 v219, v206, v207
    v_cmp_nge_f32 vcc, s42, v243
    v_mfma_f32_16x16x32_bf16 v[56:59], v[168:171], v[212:215], v[56:59]
    v_mfma_f32_16x16x32_bf16 v[60:63], v[172:175], v[212:215], v[60:63]
    s_cbranch_vccnz w0_rare2
w0_back2:
    v_add_f32 v234, v234, v243
    s_cmp_lt_u32 s41, 30
    s_waitcnt lgkmcnt(0)
    s_cbranch_scc1 w0_loop
    s_cmp_lt_u32 s30, 2
    s_cbranch_scc1 w0_pa
    s_add_u32 m0, s76, s78
    s_nop 0
    buffer_load_dwordx4 v244, s[12:15], s77 offen lds
w0_pa:
    s_add_u32 m0, s76, s79
    s_nop 0
    buffer_load_dwordx4 v245, s[12:15], s77 offen lds
    s_add_u32 m0, s76, s80
    s_nop 0
    buffer_load_dwordx4 v246, s[12:15], s77 offen lds
    s_add_u32 s76, s76, 19456
    s_add_u32 s77, s77, 73728
    s_cmp_lg_u32 s41, 31
    s_cbranch_scc1 w0_pf1
    s_cmp_lt_u32 s30, 2
    s_cbranch_scc1 w0_pb
    s_add_u32 m0, s76, s78
    s_nop 0
    buffer_load_dwordx4 v244, s[12:15], s77 offen lds
w0_pb:
    s_add_u32 m0, s76, s79
    s_nop 0
    buffer_load_dwordx4 v245, s[12:15], s77 offen lds
    s_add_u32 m0, s76, s80
    s_nop 0
    buffer_load_dwordx4 v246, s[12:15], s77 offen lds
    s_add_u32 s76, s76, 19456
    s_add_u32 s77, s77, 73728
w0_pf1:
    s_cmp_lt_u32 s41, 32
    s_cbranch_scc1 w0_loop
    v_mfma_f32_16x16x32_bf16 v[64:67], v[144:147], v[216:219], v[64:67]
    v_mfma_f32_16x16x32_bf16 v[68:71], v[148:151], v[216:219], v[68:71]
    v_mfma_f32_16x16x32_bf16 v[72:75], v[152:155], v[216:219], v[72:75]
    v_mfma_f32_16x16x32_bf16 v[76:79], v[156:159], v[216:219], v[76:79]
    v_mfma_f32_16x16x32_bf16 v[80:83], v[160:163], v[216:219], v[80:83]
    v_mfma_f32_16x16x32_bf16 v[84:87], v[164:167], v[216:219], v[84:87]
    v_mfma_f32_16x16x32_bf16 v[88:91], v[168:171], v[216:219], v[88:91]
    v_mfma_f32_16x16x32_bf16 v[92:95], v[172:175], v[216:219], v[92:95]
    v_mov_b32 v252, v232
    s_nop 1
    v_permlane32_swap_b32 v232, v252
    v_add_f32 v232, v232, v252
    v_mov_b32 v252, v232
    s_nop 1
    v_permlane16_swap_b32 v232, v252
    v_add_f32 v232, v232, v252
    v_rcp_f32 v232, v232
    v_mov_b32 v252, v233
    s_nop 1
    v_permlane32_swap_b32 v233, v252
    v_add_f32 v233, v233, v252
    v_mov_b32 v252, v233
    s_nop 1
    v_permlane16_swap_b32 v233, v252
    v_add_f32 v233, v233, v252
    v_rcp_f32 v233, v233
    v_mov_b32 v252, v234
    s_nop 1
    v_permlane32_swap_b32 v234, v252
    v_add_f32 v234, v234, v252
    v_mov_b32 v252, v234
    s_nop 1
    v_permlane16_swap_b32 v234, v252
    v_add_f32 v234, v234, v252
    v_rcp_f32 v234, v234
    s_mul_i32 s44, s32, 38912
    s_add_u32 s44, s44, 77824
    s_lshl_b32 s45, s36, 11
    s_add_u32 s44, s44, s45
    v_add_u32 v253, s44, v254
    v_mov_b32 v176, v232
    v_pk_mul_f32 v[0:1], v[0:1], v[176:177] op_sel_hi:[1,0]
    v_pk_mul_f32 v[2:3], v[2:3], v[176:177] op_sel_hi:[1,0]
    v_pk_mul_f32 v[4:5], v[4:5], v[176:177] op_sel_hi:[1,0]
    v_pk_mul_f32 v[6:7], v[6:7], v[176:177] op_sel_hi:[1,0]
    v_pk_mul_f32 v[8:9], v[8:9], v[176:177] op_sel_hi:[1,0]
    v_pk_mul_f32 v[10:11], v[10:11], v[176:177] op_sel_hi:[1,0]
    v_pk_mul_f32 v[12:13], v[12:13], v[176:177] op_sel_hi:[1,0]
    v_pk_mul_f32 v[14:15], v[14:15], v[176:177] op_sel_hi:[1,0]
    v_pk_mul_f32 v[16:17], v[16:17], v[176:177] op_sel_hi:[1,0]
    v_pk_mul_f32 v[18:19], v[18:19], v[176:177] op_sel_hi:[1,0]
    v_pk_mul_f32 v[20:21], v[20:21], v[176:177] op_sel_hi:[1,0]
    v_pk_mul_f32 v[22:23], v[22:23], v[176:177] op_sel_hi:[1,0]
    v_pk_mul_f32 v[24:25], v[24:25], v[176:177] op_sel_hi:[1,0]
    v_pk_mul_f32 v[26:27], v[26:27], v[176:177] op_sel_hi:[1,0]
    v_pk_mul_f32 v[28:29], v[28:29], v[176:177] op_sel_hi:[1,0]
    v_pk_mul_f32 v[30:31], v[30:31], v[176:177] op_sel_hi:[1,0]
    v_cvt_pk_bf16_f32 v96, v0, v1
    v_cvt_pk_bf16_f32 v97, v2, v3
    v_cvt_pk_bf16_f32 v98, v4, v5
    v_cvt_pk_bf16_f32 v99, v6, v7
    v_cvt_pk_bf16_f32 v100, v8, v9
    v_cvt_pk_bf16_f32 v101, v10, v11
    v_cvt_pk_bf16_f32 v102, v12, v13
    v_cvt_pk_bf16_f32 v103, v14, v15
    v_cvt_pk_bf16_f32 v104, v16, v17
    v_cvt_pk_bf16_f32 v105, v18, v19
    v_cvt_pk_bf16_f32 v106, v20, v21
    v_cvt_pk_bf16_f32 v107, v22, v23
    v_cvt_pk_bf16_f32 v108, v24, v25
    v_cvt_pk_bf16_f32 v109, v26, v27
    v_cvt_pk_bf16_f32 v110, v28, v29
    v_cvt_pk_bf16_f32 v111, v30, v31
    s_add_u32 s44, s86, 18432
    buffer_store_dwordx4 v[96:99], v254, s[20:23], s86 offen offset:0 sc1
    buffer_store_dwordx4 v[100:103], v254, s[20:23], s86 offen offset:1024 sc1
    buffer_store_dwordx4 v[104:107], v254, s[20:23], s44 offen offset:0 sc1
    buffer_store_dwordx4 v[108:111], v254, s[20:23], s44 offen offset:1024 sc1
    s_add_u32 s86, s86, 2048
    v_mov_b32 v176, v233
    v_pk_mul_f32 v[32:33], v[32:33], v[176:177] op_sel_hi:[1,0]
    v_pk_mul_f32 v[34:35], v[34:35], v[176:177] op_sel_hi:[1,0]
    v_pk_mul_f32 v[36:37], v[36:37], v[176:177] op_sel_hi:[1,0]
    v_pk_mul_f32 v[38:39], v[38:39], v[176:177] op_sel_hi:[1,0]
    v_pk_mul_f32 v[40:41], v[40:41], v[176:177] op_sel_hi:[1,0]
    v_pk_mul_f32 v[42:43], v[42:43], v[176:177] op_sel_hi:[1,0]
    v_pk_mul_f32 v[44:45], v[44:45], v[176:177] op_sel_hi:[1,0]
    v_pk_mul_f32 v[46:47], v[46:47], v[176:177] op_sel_hi:[1,0]
    v_pk_mul_f32 v[48:49], v[48:49], v[176:177] op_sel_hi:[1,0]
    v_pk_mul_f32 v[50:51], v[50:51], v[176:177] op_sel_hi:[1,0]
    v_pk_mul_f32 v[52:53], v[52:53], v[176:177] op_sel_hi:[1,0]
    v_pk_mul_f32 v[54:55], v[54:55], v[176:177] op_sel_hi:[1,0]
    v_pk_mul_f32 v[56:57], v[56:57], v[176:177] op_sel_hi:[1,0]
    v_pk_mul_f32 v[58:59], v[58:59], v[176:177] op_sel_hi:[1,0]
    v_pk_mul_f32 v[60:61], v[60:61], v[176:177] op_sel_hi:[1,0]
    v_pk_mul_f32 v[62:63], v[62:63], v[176:177] op_sel_hi:[1,0]
    v_cvt_pk_bf16_f32 v112, v32, v33
    v_cvt_pk_bf16_f32 v113, v34, v35
    v_cvt_pk_bf16_f32 v114, v36, v37
    v_cvt_pk_bf16_f32 v115, v38, v39
    v_cvt_pk_bf16_f32 v116, v40, v41
    v_cvt_pk_bf16_f32 v117, v42, v43
    v_cvt_pk_bf16_f32 v118, v44, v45
    v_cvt_pk_bf16_f32 v119, v46, v47
    v_cvt_pk_bf16_f32 v120, v48, v49
    v_cvt_pk_bf16_f32 v121, v50, v51
    v_cvt_pk_bf16_f32 v122, v52, v53
    v_cvt_pk_bf16_f32 v123, v54, v55
    v_cvt_pk_bf16_f32 v124, v56, v57
    v_cvt_pk_bf16_f32 v125, v58, v59
    v_cvt_pk_bf16_f32 v126, v60, v61
    v_cvt_pk_bf16_f32 v127, v62, v63
    s_add_u32 s44, s86, 18432
    buffer_store_dwordx4 v[112:115], v254, s[20:23], s86 offen offset:0 sc1
    buffer_store_dwordx4 v[116:119], v254, s[20:23], s86 offen offset:1024 sc1
    buffer_store_dwordx4 v[120:123], v254, s[20:23], s44 offen offset:0 sc1
    buffer_store_dwordx4 v[124:127], v254, s[20:23], s44 offen offset:1024 sc1
    s_add_u32 s86, s86, 2048
    v_mov_b32 v176, v234
    v_pk_mul_f32 v[64:65], v[64:65], v[176:177] op_sel_hi:[1,0]
    v_pk_mul_f32 v[66:67], v[66:67], v[176:177] op_sel_hi:[1,0]
    v_pk_mul_f32 v[68:69], v[68:69], v[176:177] op_sel_hi:[1,0]
    v_pk_mul_f32 v[70:71], v[70:71], v[176:177] op_sel_hi:[1,0]
    v_pk_mul_f32 v[72:73], v[72:73], v[176:177] op_sel_hi:[1,0]
    v_pk_mul_f32 v[74:75], v[74:75], v[176:177] op_sel_hi:[1,0]
    v_pk_mul_f32 v[76:77], v[76:77], v[176:177] op_sel_hi:[1,0]
    v_pk_mul_f32 v[78:79], v[78:79], v[176:177] op_sel_hi:[1,0]
    v_pk_mul_f32 v[80:81], v[80:81], v[176:177] op_sel_hi:[1,0]
    v_pk_mul_f32 v[82:83], v[82:83], v[176:177] op_sel_hi:[1,0]
    v_pk_mul_f32 v[84:85], v[84:85], v[176:177] op_sel_hi:[1,0]
    v_pk_mul_f32 v[86:87], v[86:87], v[176:177] op_sel_hi:[1,0]
    v_pk_mul_f32 v[88:89], v[88:89], v[176:177] op_sel_hi:[1,0]
    v_pk_mul_f32 v[90:91], v[90:91], v[176:177] op_sel_hi:[1,0]
    v_pk_mul_f32 v[92:93], v[92:93], v[176:177] op_sel_hi:[1,0]
    v_pk_mul_f32 v[94:95], v[94:95], v[176:177] op_sel_hi:[1,0]
    v_cvt_pk_bf16_f32 v128, v64, v65
    v_cvt_pk_bf16_f32 v129, v66, v67
    v_cvt_pk_bf16_f32 v130, v68, v69
    v_cvt_pk_bf16_f32 v131, v70, v71
    v_cvt_pk_bf16_f32 v132, v72, v73
    v_cvt_pk_bf16_f32 v133, v74, v75
    v_cvt_pk_bf16_f32 v134, v76, v77
    v_cvt_pk_bf16_f32 v135, v78, v79
    v_cvt_pk_bf16_f32 v136, v80, v81
    v_cvt_pk_bf16_f32 v137, v82, v83
    v_cvt_pk_bf16_f32 v138, v84, v85
    v_cvt_pk_bf16_f32 v139, v86, v87
    v_cvt_pk_bf16_f32 v140, v88, v89
    v_cvt_pk_bf16_f32 v141, v90, v91
    v_cvt_pk_bf16_f32 v142, v92, v93
    v_cvt_pk_bf16_f32 v143, v94, v95
    s_add_u32 s44, s86, 18432
    buffer_store_dwordx4 v[128:131], v254, s[20:23], s86 offen offset:0 sc1
    buffer_store_dwordx4 v[132:135], v254, s[20:23], s86 offen offset:1024 sc1
    buffer_store_dwordx4 v[136:139], v254, s[20:23], s44 offen offset:0 sc1
    buffer_store_dwordx4 v[140:143], v254, s[20:23], s44 offen offset:1024 sc1
    s_barrier
    ds_write_b128 v253, v[96:99] offset:0
    ds_write_b128 v253, v[100:103] offset:1024
    ds_write_b128 v253, v[104:107] offset:19456
    ds_write_b128 v253, v[108:111] offset:20480
    ds_write_b128 v253, v[112:115] offset:2048
    ds_write_b128 v253, v[116:119] offset:3072
    ds_write_b128 v253, v[120:123] offset:21504
    ds_write_b128 v253, v[124:127] offset:22528
    ds_write_b128 v253, v[128:131] offset:4096
    ds_write_b128 v253, v[132:135] offset:5120
    ds_write_b128 v253, v[136:139] offset:23552
    ds_write_b128 v253, v[140:143] offset:24576
    s_waitcnt vmcnt(12)
    s_branch op_entry
w0_rare0:
    s_nop 7
    v_max3_f32 v251, v176, v177, v178
    v_max3_f32 v251, v251, v179, v180
    v_max3_f32 v251, v251, v181, v182
    v_max_f32 v251, v251, v183
    v_mov_b32 v252, v251
    s_nop 1
    v_permlane32_swap_b32 v251, v252
    v_max_f32 v251, v251, v252
    v_mov_b32 v252, v251
    s_nop 1
    v_permlane16_swap_b32 v251, v252
    v_max_f32 v251, v251, v252
    v_max_f32 v251, s43, v251
    v_max_f32 v252, 0, v251
    v_exp_f32_e64 v252, -v252
    v_sub_f32 v220, v220, v251
    v_sub_f32 v221, v221, v251
    v_sub_f32 v222, v222, v251
    v_sub_f32 v223, v223, v251
    v_mul_f32 v232, v232, v252
    v_mul_f32 v0, v0, v252
    v_mul_f32 v1, v1, v252
    v_mul_f32 v2, v2, v252
    v_mul_f32 v3, v3, v252
    v_mul_f32 v4, v4, v252
    v_mul_f32 v5, v5, v252
    v_mul_f32 v6, v6, v252
    v_mul_f32 v7, v7, v252
    v_mul_f32 v8, v8, v252
    v_mul_f32 v9, v9, v252
    v_mul_f32 v10, v10, v252
    v_mul_f32 v11, v11, v252
    v_mul_f32 v12, v12, v252
    v_mul_f32 v13, v13, v252
    v_mul_f32 v14, v14, v252
    v_mul_f32 v15, v15, v252
    v_mul_f32 v16, v16, v252
    v_mul_f32 v17, v17, v252
    v_mul_f32 v18, v18, v252
    v_mul_f32 v19, v19, v252
    v_mul_f32 v20, v20, v252
    v_mul_f32 v21, v21, v252
    v_mul_f32 v22, v22, v252
    v_mul_f32 v23, v23, v252
    v_mul_f32 v24, v24, v252
    v_mul_f32 v25, v25, v252
    v_mul_f32 v26, v26, v252
    v_mul_f32 v27, v27, v252
    v_mul_f32 v28, v28, v252
    v_mul_f32 v29, v29, v252
    v_mul_f32 v30, v30, v252
    v_mul_f32 v31, v31, v252
    v_sub_f32 v176, v176, v251
    v_sub_f32 v177, v177, v251
    v_sub_f32 v178, v178, v251
    v_sub_f32 v179, v179, v251
    v_sub_f32 v180, v180, v251
    v_sub_f32 v181, v181, v251
    v_sub_f32 v182, v182, v251
    v_sub_f32 v183, v183, v251
    v_exp_f32 v176, v176
    v_exp_f32 v177, v177
    v_exp_f32 v178, v178
    v_exp_f32 v179, v179
    v_exp_f32 v180, v180
    v_exp_f32 v181, v181
    v_exp_f32 v182, v182
    v_exp_f32 v183, v183
    v_add_f32 v235, v176, v177
    v_add_f32 v235, v235, v178
    v_add_f32 v235, v235, v179
    v_add_f32 v235, v235, v180
    v_add_f32 v235, v235, v181
    v_add_f32 v235, v235, v182
    v_add_f32 v235, v235, v183
    v_cvt_pk_bf16_f32 v208, v176, v177
    v_cvt_pk_bf16_f32 v209, v178, v179
    v_cvt_pk_bf16_f32 v210, v180, v181
    v_cvt_pk_bf16_f32 v211, v182, v183
    s_nop 1
    s_branch w0_back0
w0_rare1:
    s_nop 7
    v_max3_f32 v251, v184, v185, v186
    v_max3_f32 v251, v251, v187, v188
    v_max3_f32 v251, v251, v189, v190
    v_max_f32 v251, v251, v191
    v_mov_b32 v252, v251
    s_nop 1
    v_permlane32_swap_b32 v251, v252
    v_max_f32 v251, v251, v252
    v_mov_b32 v252, v251
    s_nop 1
    v_permlane16_swap_b32 v251, v252
    v_max_f32 v251, v251, v252
    v_max_f32 v251, s43, v251
    v_max_f32 v252, 0, v251
    v_exp_f32_e64 v252, -v252
    v_sub_f32 v224, v224, v251
    v_sub_f32 v225, v225, v251
    v_sub_f32 v226, v226, v251
    v_sub_f32 v227, v227, v251
    v_mul_f32 v233, v233, v252
    v_mul_f32 v32, v32, v252
    v_mul_f32 v33, v33, v252
    v_mul_f32 v34, v34, v252
    v_mul_f32 v35, v35, v252
    v_mul_f32 v36, v36, v252
    v_mul_f32 v37, v37, v252
    v_mul_f32 v38, v38, v252
    v_mul_f32 v39, v39, v252
    v_mul_f32 v40, v40, v252
    v_mul_f32 v41, v41, v252
    v_mul_f32 v42, v42, v252
    v_mul_f32 v43, v43, v252
    v_mul_f32 v44, v44, v252
    v_mul_f32 v45, v45, v252
    v_mul_f32 v46, v46, v252
    v_mul_f32 v47, v47, v252
    v_mul_f32 v48, v48, v252
    v_mul_f32 v49, v49, v252
    v_mul_f32 v50, v50, v252
    v_mul_f32 v51, v51, v252
    v_mul_f32 v52, v52, v252
    v_mul_f32 v53, v53, v252
    v_mul_f32 v54, v54, v252
    v_mul_f32 v55, v55, v252
    v_mul_f32 v56, v56, v252
    v_mul_f32 v57, v57, v252
    v_mul_f32 v58, v58, v252
    v_mul_f32 v59, v59, v252
    v_mul_f32 v60, v60, v252
    v_mul_f32 v61, v61, v252
    v_mul_f32 v62, v62, v252
    v_mul_f32 v63, v63, v252
    v_sub_f32 v184, v184, v251
    v_sub_f32 v185, v185, v251
    v_sub_f32 v186, v186, v251
    v_sub_f32 v187, v187, v251
    v_sub_f32 v188, v188, v251
    v_sub_f32 v189, v189, v251
    v_sub_f32 v190, v190, v251
    v_sub_f32 v191, v191, v251
    v_exp_f32 v184, v184
    v_exp_f32 v185, v185
    v_exp_f32 v186, v186
    v_exp_f32 v187, v187
    v_exp_f32 v188, v188
    v_exp_f32 v189, v189
    v_exp_f32 v190, v190
    v_exp_f32 v191, v191
    v_add_f32 v242, v184, v185
    v_add_f32 v242, v242, v186
    v_add_f32 v242, v242, v187
    v_add_f32 v242, v242, v188
    v_add_f32 v242, v242, v189
    v_add_f32 v242, v242, v190
    v_add_f32 v242, v242, v191
    v_cvt_pk_bf16_f32 v212, v184, v185
    v_cvt_pk_bf16_f32 v213, v186, v187
    v_cvt_pk_bf16_f32 v214, v188, v189
    v_cvt_pk_bf16_f32 v215, v190, v191
    s_nop 1
    s_branch w0_back1
w0_rare2:
    s_nop 7
    v_max3_f32 v251, v192, v193, v194
    v_max3_f32 v251, v251, v195, v196
    v_max3_f32 v251, v251, v197, v198
    v_max_f32 v251, v251, v199
    v_mov_b32 v252, v251
    s_nop 1
    v_permlane32_swap_b32 v251, v252
    v_max_f32 v251, v251, v252
    v_mov_b32 v252, v251
    s_nop 1
    v_permlane16_swap_b32 v251, v252
    v_max_f32 v251, v251, v252
    v_max_f32 v251, s43, v251
    v_max_f32 v252, 0, v251
    v_exp_f32_e64 v252, -v252
    v_sub_f32 v228, v228, v251
    v_sub_f32 v229, v229, v251
    v_sub_f32 v230, v230, v251
    v_sub_f32 v231, v231, v251
    v_mul_f32 v234, v234, v252
    v_mul_f32 v64, v64, v252
    v_mul_f32 v65, v65, v252
    v_mul_f32 v66, v66, v252
    v_mul_f32 v67, v67, v252
    v_mul_f32 v68, v68, v252
    v_mul_f32 v69, v69, v252
    v_mul_f32 v70, v70, v252
    v_mul_f32 v71, v71, v252
    v_mul_f32 v72, v72, v252
    v_mul_f32 v73, v73, v252
    v_mul_f32 v74, v74, v252
    v_mul_f32 v75, v75, v252
    v_mul_f32 v76, v76, v252
    v_mul_f32 v77, v77, v252
    v_mul_f32 v78, v78, v252
    v_mul_f32 v79, v79, v252
    v_mul_f32 v80, v80, v252
    v_mul_f32 v81, v81, v252
    v_mul_f32 v82, v82, v252
    v_mul_f32 v83, v83, v252
    v_mul_f32 v84, v84, v252
    v_mul_f32 v85, v85, v252
    v_mul_f32 v86, v86, v252
    v_mul_f32 v87, v87, v252
    v_mul_f32 v88, v88, v252
    v_mul_f32 v89, v89, v252
    v_mul_f32 v90, v90, v252
    v_mul_f32 v91, v91, v252
    v_mul_f32 v92, v92, v252
    v_mul_f32 v93, v93, v252
    v_mul_f32 v94, v94, v252
    v_mul_f32 v95, v95, v252
    v_sub_f32 v192, v192, v251
    v_sub_f32 v193, v193, v251
    v_sub_f32 v194, v194, v251
    v_sub_f32 v195, v195, v251
    v_sub_f32 v196, v196, v251
    v_sub_f32 v197, v197, v251
    v_sub_f32 v198, v198, v251
    v_sub_f32 v199, v199, v251
    v_exp_f32 v192, v192
    v_exp_f32 v193, v193
    v_exp_f32 v194, v194
    v_exp_f32 v195, v195
    v_exp_f32 v196, v196
    v_exp_f32 v197, v197
    v_exp_f32 v198, v198
    v_exp_f32 v199, v199
    v_add_f32 v243, v192, v193
    v_add_f32 v243, v243, v194
    v_add_f32 v243, v243, v195
    v_add_f32 v243, v243, v196
    v_add_f32 v243, v243, v197
    v_add_f32 v243, v243, v198
    v_add_f32 v243, v243, v199
    v_cvt_pk_bf16_f32 v216, v192, v193
    v_cvt_pk_bf16_f32 v217, v194, v195
    v_cvt_pk_bf16_f32 v218, v196, v197
    v_cvt_pk_bf16_f32 v219, v198, v199
    s_mov_b32 s42, 0x43800000
    s_mov_b32 s43, 0
    s_nop 1
    s_branch w0_back2
attn_wx:
    s_waitcnt vmcnt(9)
    s_barrier
    v_add_u32 v245, 95488, v242
    v_add_u32 v246, 25344, v243
    v_subrev_u32 v200, s34, v246
    v_mfma_f32_16x16x32_bf16 v[16:19], v[160:163], v[108:111], v[16:19]
    ds_read_b64_tr_b16 v[144:145], v245 offset:0
    ds_read_b64_tr_b16 v[146:147], v245 offset:512
    v_mfma_f32_16x16x32_bf16 v[48:51], v[160:163], v[112:115], v[48:51]
    ds_read_b128 v[96:99], v246 offset:0
    s_cmp_ge_u32 s52, 7
    v_mfma_f32_16x16x32_bf16 v[20:23], v[164:167], v[108:111], v[20:23]
    ds_read_b128 v[100:103], v246 offset:2048
    ds_read_b128 v[104:107], v200
    v_mfma_f32_16x16x32_bf16 v[52:55], v[164:167], v[112:115], v[52:55]
    ds_read_b64_tr_b16 v[148:149], v245 offset:32
    s_cselect_b32 s44, s49, s48
    v_mfma_f32_16x16x32_bf16 v[24:27], v[168:171], v[108:111], v[24:27]
    ds_read_b64_tr_b16 v[150:151], v245 offset:544
    ds_read_b64_tr_b16 v[152:153], v245 offset:64
    v_mfma_f32_16x16x32_bf16 v[56:59], v[168:171], v[112:115], v[56:59]
    ds_read_b64_tr_b16 v[154:155], v245 offset:576
    s_add_u32 m0, s58, 60416
    v_mfma_f32_16x16x32_bf16 v[88:91], v[168:171], v[116:119], v[88:91]
    ds_read_b64_tr_b16 v[156:157], v245 offset:96
    ds_read_b64_tr_b16 v[158:159], v245 offset:608
    v_mfma_f32_16x16x32_bf16 v[28:31], v[172:175], v[108:111], v[28:31]
    s_add_u32 s44, s44, 1048576
    buffer_load_dwordx4 v248, s[12:15], s44 offen lds
    v_mfma_f32_16x16x32_bf16 v[60:63], v[172:175], v[112:115], v[60:63]
    s_add_u32 s44, s44, 130048
    buffer_load_dwordx4 v248, s[12:15], s44 offen offset:1024 lds
    v_mfma_f32_16x16x32_bf16 v[92:95], v[172:175], v[116:119], v[92:95]
    s_cmp_ge_u32 s52, 7
    s_cselect_b32 s45, s51, s50
    s_add_u32 m0, s59, 128768
    s_waitcnt lgkmcnt(4)
    v_mfma_f32_16x16x32_bf16 v[0:3], v[144:147], v[96:99], v[0:3]
    ds_read_b64_tr_b16 v[160:161], v245 offset:128
    s_add_u32 s45, s45, 256
    v_mfma_f32_16x16x32_bf16 v[32:35], v[144:147], v[100:103], v[32:35]
    ds_read_b64_tr_b16 v[162:163], v245 offset:640
    ds_read_b64_tr_b16 v[164:165], v245 offset:160
    v_mfma_f32_16x16x32_bf16 v[4:7], v[148:151], v[96:99], v[4:7]
    ds_read_b64_tr_b16 v[166:167], v245 offset:672
    buffer_load_dwordx4 v247, s[8:11], s45 offen lds
    v_mfma_f32_16x16x32_bf16 v[36:39], v[148:151], v[100:103], v[36:39]
    ds_read_b64_tr_b16 v[168:169], v245 offset:192
    s_add_u32 m0, s59, 136960
    s_waitcnt lgkmcnt(5)
    v_mfma_f32_16x16x32_bf16 v[8:11], v[152:155], v[96:99], v[8:11]
    ds_read_b64_tr_b16 v[170:171], v245 offset:704
    ds_read_b64_tr_b16 v[172:173], v245 offset:224
    v_mfma_f32_16x16x32_bf16 v[40:43], v[152:155], v[100:103], v[40:43]
    ds_read_b64_tr_b16 v[174:175], v245 offset:736
    s_add_u32 s44, s45, 73728
    v_mfma_f32_16x16x32_bf16 v[12:15], v[156:159], v[96:99], v[12:15]
    buffer_load_dwordx4 v247, s[8:11], s44 offen lds
    s_add_u32 m0, s53, 128768
    v_mfma_f32_16x16x32_bf16 v[44:47], v[156:159], v[100:103], v[44:47]
    s_add_u32 s45, s45, s83
    buffer_load_dwordx4 v247, s[8:11], s45 offen lds
    s_waitcnt lgkmcnt(0)
    s_waitcnt vmcnt(12)
    s_barrier
    v_add_u32 v245, 112128, v242
    v_add_u32 v246, 25344, v244
    v_subrev_u32 v200, s34, v246
    v_mfma_f32_16x16x32_bf16 v[16:19], v[160:163], v[96:99], v[16:19]
    ds_read_b64_tr_b16 v[144:145], v245 offset:0
    ds_read_b64_tr_b16 v[146:147], v245 offset:512
    v_mfma_f32_16x16x32_bf16 v[48:51], v[160:163], v[100:103], v[48:51]
    ds_read_b128 v[108:111], v246 offset:0
    v_mfma_f32_16x16x32_bf16 v[20:23], v[164:167], v[96:99], v[20:23]
    ds_read_b128 v[112:115], v246 offset:2048
    ds_read_b128 v[116:119], v200
    v_mfma_f32_16x16x32_bf16 v[52:55], v[164:167], v[100:103], v[52:55]
    ds_read_b64_tr_b16 v[148:149], v245 offset:32
    v_mfma_f32_16x16x32_bf16 v[24:27], v[168:171], v[96:99], v[24:27]
    ds_read_b64_tr_b16 v[150:151], v245 offset:544
    ds_read_b64_tr_b16 v[152:153], v245 offset:64
    v_mfma_f32_16x16x32_bf16 v[56:59], v[168:171], v[100:103], v[56:59]
    ds_read_b64_tr_b16 v[154:155], v245 offset:576
    v_mfma_f32_16x16x32_bf16 v[88:91], v[168:171], v[104:107], v[88:91]
    ds_read_b64_tr_b16 v[156:157], v245 offset:96
    ds_read_b64_tr_b16 v[158:159], v245 offset:608
    v_mfma_f32_16x16x32_bf16 v[28:31], v[172:175], v[96:99], v[28:31]
    s_cmp_ge_u32 s52, 7
    v_mfma_f32_16x16x32_bf16 v[60:63], v[172:175], v[100:103], v[60:63]
    s_cselect_b32 s44, s49, s48
    v_mfma_f32_16x16x32_bf16 v[92:95], v[172:175], v[104:107], v[92:95]
    s_add_u32 m0, s58, 95488
    s_waitcnt lgkmcnt(4)
    v_mfma_f32_16x16x32_bf16 v[0:3], v[144:147], v[108:111], v[0:3]
    ds_read_b64_tr_b16 v[160:161], v245 offset:128
    s_add_u32 s44, s44, 1310720
    v_mfma_f32_16x16x32_bf16 v[32:35], v[144:147], v[112:115], v[32:35]
    ds_read_b64_tr_b16 v[162:163], v245 offset:640
    ds_read_b64_tr_b16 v[164:165], v245 offset:160
    v_mfma_f32_16x16x32_bf16 v[4:7], v[148:151], v[108:111], v[4:7]
    ds_read_b64_tr_b16 v[166:167], v245 offset:672
    v_mfma_f32_16x16x32_bf16 v[36:39], v[148:151], v[112:115], v[36:39]
    ds_read_b64_tr_b16 v[168:169], v245 offset:192
    s_waitcnt lgkmcnt(5)
    v_mfma_f32_16x16x32_bf16 v[8:11], v[152:155], v[108:111], v[8:11]
    ds_read_b64_tr_b16 v[170:171], v245 offset:704
    ds_read_b64_tr_b16 v[172:173], v245 offset:224
    v_mfma_f32_16x16x32_bf16 v[40:43], v[152:155], v[112:115], v[40:43]
    ds_read_b64_tr_b16 v[174:175], v245 offset:736
    v_mfma_f32_16x16x32_bf16 v[12:15], v[156:159], v[108:111], v[12:15]
    buffer_load_dwordx4 v248, s[12:15], s44 offen lds
    s_add_u32 s44, s44, 130048
    v_mfma_f32_16x16x32_bf16 v[44:47], v[156:159], v[112:115], v[44:47]
    buffer_load_dwordx4 v248, s[12:15], s44 offen offset:1024 lds
    s_waitcnt lgkmcnt(0)
    s_waitcnt vmcnt(9)
    s_barrier
    v_add_u32 v245, 147200, v242
    v_add_u32 v246, 77056, v243
    v_subrev_u32 v200, s34, v246
    v_mfma_f32_16x16x32_bf16 v[16:19], v[160:163], v[108:111], v[16:19]
    ds_read_b64_tr_b16 v[144:145], v245 offset:0
    ds_read_b64_tr_b16 v[146:147], v245 offset:512
    v_mfma_f32_16x16x32_bf16 v[48:51], v[160:163], v[112:115], v[48:51]
    ds_read_b128 v[96:99], v246 offset:0
    s_cmp_ge_u32 s52, 6
    v_mfma_f32_16x16x32_bf16 v[20:23], v[164:167], v[108:111], v[20:23]
    ds_read_b128 v[100:103], v246 offset:2048
    ds_read_b128 v[104:107], v200
    v_mfma_f32_16x16x32_bf16 v[52:55], v[164:167], v[112:115], v[52:55]
    ds_read_b64_tr_b16 v[148:149], v245 offset:32
    s_cselect_b32 s44, s49, s48
    v_mfma_f32_16x16x32_bf16 v[24:27], v[168:171], v[108:111], v[24:27]
    ds_read_b64_tr_b16 v[150:151], v245 offset:544
    ds_read_b64_tr_b16 v[152:153], v245 offset:64
    v_mfma_f32_16x16x32_bf16 v[56:59], v[168:171], v[112:115], v[56:59]
    ds_read_b64_tr_b16 v[154:155], v245 offset:576
    s_add_u32 m0, s58, 112128
    v_mfma_f32_16x16x32_bf16 v[88:91], v[168:171], v[116:119], v[88:91]
    ds_read_b64_tr_b16 v[156:157], v245 offset:96
    ds_read_b64_tr_b16 v[158:159], v245 offset:608
    v_mfma_f32_16x16x32_bf16 v[28:31], v[172:175], v[108:111], v[28:31]
    s_add_u32 s44, s44, 1572864
    buffer_load_dwordx4 v248, s[12:15], s44 offen lds
    v_mfma_f32_16x16x32_bf16 v[60:63], v[172:175], v[112:115], v[60:63]
    s_add_u32 s44, s44, 130048
    buffer_load_dwordx4 v248, s[12:15], s44 offen offset:1024 lds
    v_mfma_f32_16x16x32_bf16 v[92:95], v[172:175], v[116:119], v[92:95]
    s_cmp_ge_u32 s52, 6
    s_cselect_b32 s45, s51, s50
    s_add_u32 m0, s59, 25344
    s_waitcnt lgkmcnt(4)
    v_mfma_f32_16x16x32_bf16 v[0:3], v[144:147], v[96:99], v[0:3]
    ds_read_b64_tr_b16 v[160:161], v245 offset:128
    s_add_u32 s45, s45, 384
    v_mfma_f32_16x16x32_bf16 v[32:35], v[144:147], v[100:103], v[32:35]
    ds_read_b64_tr_b16 v[162:163], v245 offset:640
    ds_read_b64_tr_b16 v[164:165], v245 offset:160
    v_mfma_f32_16x16x32_bf16 v[4:7], v[148:151], v[96:99], v[4:7]
    ds_read_b64_tr_b16 v[166:167], v245 offset:672
    buffer_load_dwordx4 v247, s[8:11], s45 offen lds
    v_mfma_f32_16x16x32_bf16 v[36:39], v[148:151], v[100:103], v[36:39]
    ds_read_b64_tr_b16 v[168:169], v245 offset:192
    s_add_u32 m0, s59, 33536
    s_waitcnt lgkmcnt(5)
    v_mfma_f32_16x16x32_bf16 v[8:11], v[152:155], v[96:99], v[8:11]
    ds_read_b64_tr_b16 v[170:171], v245 offset:704
    ds_read_b64_tr_b16 v[172:173], v245 offset:224
    v_mfma_f32_16x16x32_bf16 v[40:43], v[152:155], v[100:103], v[40:43]
    ds_read_b64_tr_b16 v[174:175], v245 offset:736
    s_add_u32 s44, s45, 73728
    v_mfma_f32_16x16x32_bf16 v[12:15], v[156:159], v[96:99], v[12:15]
    buffer_load_dwordx4 v247, s[8:11], s44 offen lds
    s_add_u32 m0, s53, 25344
    v_mfma_f32_16x16x32_bf16 v[44:47], v[156:159], v[100:103], v[44:47]
    s_add_u32 s45, s45, s83
    buffer_load_dwordx4 v247, s[8:11], s45 offen lds
    s_waitcnt lgkmcnt(0)
    s_waitcnt vmcnt(12)
    s_barrier
    v_add_u32 v245, 43776, v242
    v_add_u32 v246, 77056, v244
    v_subrev_u32 v200, s34, v246
    v_mfma_f32_16x16x32_bf16 v[16:19], v[160:163], v[96:99], v[16:19]
    ds_read_b64_tr_b16 v[144:145], v245 offset:0
    ds_read_b64_tr_b16 v[146:147], v245 offset:512
    v_mfma_f32_16x16x32_bf16 v[48:51], v[160:163], v[100:103], v[48:51]
    ds_read_b128 v[108:111], v246 offset:0
    v_mfma_f32_16x16x32_bf16 v[20:23], v[164:167], v[96:99], v[20:23]
    ds_read_b128 v[112:115], v246 offset:2048
    ds_read_b128 v[116:119], v200
    v_mfma_f32_16x16x32_bf16 v[52:55], v[164:167], v[100:103], v[52:55]
    ds_read_b64_tr_b16 v[148:149], v245 offset:32
    v_mfma_f32_16x16x32_bf16 v[24:27], v[168:171], v[96:99], v[24:27]
    ds_read_b64_tr_b16 v[150:151], v245 offset:544
    ds_read_b64_tr_b16 v[152:153], v245 offset:64
    v_mfma_f32_16x16x32_bf16 v[56:59], v[168:171], v[100:103], v[56:59]
    ds_read_b64_tr_b16 v[154:155], v245 offset:576
    v_mfma_f32_16x16x32_bf16 v[88:91], v[168:171], v[104:107], v[88:91]
    ds_read_b64_tr_b16 v[156:157], v245 offset:96
    ds_read_b64_tr_b16 v[158:159], v245 offset:608
    v_mfma_f32_16x16x32_bf16 v[28:31], v[172:175], v[96:99], v[28:31]
    s_cmp_ge_u32 s52, 6
    v_mfma_f32_16x16x32_bf16 v[60:63], v[172:175], v[100:103], v[60:63]
    s_cselect_b32 s44, s49, s48
    v_mfma_f32_16x16x32_bf16 v[92:95], v[172:175], v[104:107], v[92:95]
    s_add_u32 m0, s58, 147200
    s_waitcnt lgkmcnt(4)
    v_mfma_f32_16x16x32_bf16 v[0:3], v[144:147], v[108:111], v[0:3]
    ds_read_b64_tr_b16 v[160:161], v245 offset:128
    s_add_u32 s44, s44, 1835008
    v_mfma_f32_16x16x32_bf16 v[32:35], v[144:147], v[112:115], v[32:35]
    ds_read_b64_tr_b16 v[162:163], v245 offset:640
    ds_read_b64_tr_b16 v[164:165], v245 offset:160
    v_mfma_f32_16x16x32_bf16 v[4:7], v[148:151], v[108:111], v[4:7]
    ds_read_b64_tr_b16 v[166:167], v245 offset:672
    v_mfma_f32_16x16x32_bf16 v[36:39], v[148:151], v[112:115], v[36:39]
    ds_read_b64_tr_b16 v[168:169], v245 offset:192
    s_waitcnt lgkmcnt(5)
    v_mfma_f32_16x16x32_bf16 v[8:11], v[152:155], v[108:111], v[8:11]
    ds_read_b64_tr_b16 v[170:171], v245 offset:704
    ds_read_b64_tr_b16 v[172:173], v245 offset:224
    v_mfma_f32_16x16x32_bf16 v[40:43], v[152:155], v[112:115], v[40:43]
    ds_read_b64_tr_b16 v[174:175], v245 offset:736
    v_mfma_f32_16x16x32_bf16 v[12:15], v[156:159], v[108:111], v[12:15]
    buffer_load_dwordx4 v248, s[12:15], s44 offen lds
    s_add_u32 s44, s44, 130048
    v_mfma_f32_16x16x32_bf16 v[44:47], v[156:159], v[112:115], v[44:47]
    buffer_load_dwordx4 v248, s[12:15], s44 offen offset:1024 lds
    s_waitcnt lgkmcnt(0)
    s_waitcnt vmcnt(9)
    s_barrier
    v_add_u32 v245, 60416, v242
    v_add_u32 v246, 128768, v243
    v_subrev_u32 v200, s34, v246
    v_mfma_f32_16x16x32_bf16 v[16:19], v[160:163], v[108:111], v[16:19]
    ds_read_b64_tr_b16 v[144:145], v245 offset:0
    ds_read_b64_tr_b16 v[146:147], v245 offset:512
    v_mfma_f32_16x16x32_bf16 v[48:51], v[160:163], v[112:115], v[48:51]
    ds_read_b128 v[96:99], v246 offset:0
    s_cmp_ge_u32 s52, 5
    v_mfma_f32_16x16x32_bf16 v[20:23], v[164:167], v[108:111], v[20:23]
    ds_read_b128 v[100:103], v246 offset:2048
    ds_read_b128 v[104:107], v200
    v_mfma_f32_16x16x32_bf16 v[52:55], v[164:167], v[112:115], v[52:55]
    ds_read_b64_tr_b16 v[148:149], v245 offset:32
    s_cselect_b32 s44, s49, s48
    v_mfma_f32_16x16x32_bf16 v[24:27], v[168:171], v[108:111], v[24:27]
    ds_read_b64_tr_b16 v[150:151], v245 offset:544
    ds_read_b64_tr_b16 v[152:153], v245 offset:64
    v_mfma_f32_16x16x32_bf16 v[56:59], v[168:171], v[112:115], v[56:59]
    ds_read_b64_tr_b16 v[154:155], v245 offset:576
    s_add_u32 m0, s58, 43776
    v_mfma_f32_16x16x32_bf16 v[88:91], v[168:171], v[116:119], v[88:91]
    ds_read_b64_tr_b16 v[156:157], v245 offset:96
    ds_read_b64_tr_b16 v[158:159], v245 offset:608
    v_mfma_f32_16x16x32_bf16 v[28:31], v[172:175], v[108:111], v[28:31]
    s_add_u32 s44, s44, 2097152
    buffer_load_dwordx4 v248, s[12:15], s44 offen lds
    v_mfma_f32_16x16x32_bf16 v[60:63], v[172:175], v[112:115], v[60:63]
    s_add_u32 s44, s44, 130048
    buffer_load_dwordx4 v248, s[12:15], s44 offen offset:1024 lds
    v_mfma_f32_16x16x32_bf16 v[92:95], v[172:175], v[116:119], v[92:95]
    s_cmp_ge_u32 s52, 5
    s_cselect_b32 s45, s51, s50
    s_add_u32 m0, s59, 77056
    s_waitcnt lgkmcnt(4)
    v_mfma_f32_16x16x32_bf16 v[0:3], v[144:147], v[96:99], v[0:3]
    ds_read_b64_tr_b16 v[160:161], v245 offset:128
    s_add_u32 s45, s45, 512
    v_mfma_f32_16x16x32_bf16 v[32:35], v[144:147], v[100:103], v[32:35]
    ds_read_b64_tr_b16 v[162:163], v245 offset:640
    ds_read_b64_tr_b16 v[164:165], v245 offset:160
    v_mfma_f32_16x16x32_bf16 v[4:7], v[148:151], v[96:99], v[4:7]
    ds_read_b64_tr_b16 v[166:167], v245 offset:672
    buffer_load_dwordx4 v247, s[8:11], s45 offen lds
    v_mfma_f32_16x16x32_bf16 v[36:39], v[148:151], v[100:103], v[36:39]
    ds_read_b64_tr_b16 v[168:169], v245 offset:192
    s_add_u32 m0, s59, 85248
    s_waitcnt lgkmcnt(5)
    v_mfma_f32_16x16x32_bf16 v[8:11], v[152:155], v[96:99], v[8:11]
    ds_read_b64_tr_b16 v[170:171], v245 offset:704
    ds_read_b64_tr_b16 v[172:173], v245 offset:224
    v_mfma_f32_16x16x32_bf16 v[40:43], v[152:155], v[100:103], v[40:43]
    ds_read_b64_tr_b16 v[174:175], v245 offset:736
    s_add_u32 s44, s45, 73728
    v_mfma_f32_16x16x32_bf16 v[12:15], v[156:159], v[96:99], v[12:15]
    buffer_load_dwordx4 v247, s[8:11], s44 offen lds
    s_add_u32 m0, s53, 77056
    v_mfma_f32_16x16x32_bf16 v[44:47], v[156:159], v[100:103], v[44:47]
    s_add_u32 s45, s45, s83
    buffer_load_dwordx4 v247, s[8:11], s45 offen lds
    s_waitcnt lgkmcnt(0)
    s_waitcnt vmcnt(12)
    s_barrier
    v_add_u32 v245, 95488, v242
    v_add_u32 v246, 128768, v244
    v_subrev_u32 v200, s34, v246
    v_mfma_f32_16x16x32_bf16 v[16:19], v[160:163], v[96:99], v[16:19]
    ds_read_b64_tr_b16 v[144:145], v245 offset:0
    ds_read_b64_tr_b16 v[146:147], v245 offset:512
    v_mfma_f32_16x16x32_bf16 v[48:51], v[160:163], v[100:103], v[48:51]
    ds_read_b128 v[108:111], v246 offset:0
    v_mfma_f32_16x16x32_bf16 v[20:23], v[164:167], v[96:99], v[20:23]
    ds_read_b128 v[112:115], v246 offset:2048
    ds_read_b128 v[116:119], v200
    v_mfma_f32_16x16x32_bf16 v[52:55], v[164:167], v[100:103], v[52:55]
    ds_read_b64_tr_b16 v[148:149], v245 offset:32
    v_mfma_f32_16x16x32_bf16 v[24:27], v[168:171], v[96:99], v[24:27]
    ds_read_b64_tr_b16 v[150:151], v245 offset:544
    ds_read_b64_tr_b16 v[152:153], v245 offset:64
    v_mfma_f32_16x16x32_bf16 v[56:59], v[168:171], v[100:103], v[56:59]
    ds_read_b64_tr_b16 v[154:155], v245 offset:576
    v_mfma_f32_16x16x32_bf16 v[88:91], v[168:171], v[104:107], v[88:91]
    ds_read_b64_tr_b16 v[156:157], v245 offset:96
    ds_read_b64_tr_b16 v[158:159], v245 offset:608
    v_mfma_f32_16x16x32_bf16 v[28:31], v[172:175], v[96:99], v[28:31]
    s_cmp_ge_u32 s52, 5
    v_mfma_f32_16x16x32_bf16 v[60:63], v[172:175], v[100:103], v[60:63]
    s_cselect_b32 s44, s49, s48
    v_mfma_f32_16x16x32_bf16 v[92:95], v[172:175], v[104:107], v[92:95]
    s_add_u32 m0, s58, 60416
    s_waitcnt lgkmcnt(4)
    v_mfma_f32_16x16x32_bf16 v[0:3], v[144:147], v[108:111], v[0:3]
    ds_read_b64_tr_b16 v[160:161], v245 offset:128
    s_add_u32 s44, s44, 2359296
    v_mfma_f32_16x16x32_bf16 v[32:35], v[144:147], v[112:115], v[32:35]
    ds_read_b64_tr_b16 v[162:163], v245 offset:640
    ds_read_b64_tr_b16 v[164:165], v245 offset:160
    v_mfma_f32_16x16x32_bf16 v[4:7], v[148:151], v[108:111], v[4:7]
    ds_read_b64_tr_b16 v[166:167], v245 offset:672
    v_mfma_f32_16x16x32_bf16 v[36:39], v[148:151], v[112:115], v[36:39]
    ds_read_b64_tr_b16 v[168:169], v245 offset:192
    s_waitcnt lgkmcnt(5)
    v_mfma_f32_16x16x32_bf16 v[8:11], v[152:155], v[108:111], v[8:11]
    ds_read_b64_tr_b16 v[170:171], v245 offset:704
    ds_read_b64_tr_b16 v[172:173], v245 offset:224
    v_mfma_f32_16x16x32_bf16 v[40:43], v[152:155], v[112:115], v[40:43]
    ds_read_b64_tr_b16 v[174:175], v245 offset:736
    v_mfma_f32_16x16x32_bf16 v[12:15], v[156:159], v[108:111], v[12:15]
    buffer_load_dwordx4 v248, s[12:15], s44 offen lds
    s_add_u32 s44, s44, 130048
    v_mfma_f32_16x16x32_bf16 v[44:47], v[156:159], v[112:115], v[44:47]
    buffer_load_dwordx4 v248, s[12:15], s44 offen offset:1024 lds
    s_waitcnt lgkmcnt(0)
    s_waitcnt vmcnt(9)
    s_barrier
    v_add_u32 v245, 112128, v242
    v_add_u32 v246, 25344, v243
    v_subrev_u32 v200, s34, v246
    v_mfma_f32_16x16x32_bf16 v[16:19], v[160:163], v[108:111], v[16:19]
    ds_read_b64_tr_b16 v[144:145], v245 offset:0
    ds_read_b64_tr_b16 v[146:147], v245 offset:512
    v_mfma_f32_16x16x32_bf16 v[48:51], v[160:163], v[112:115], v[48:51]
    ds_read_b128 v[96:99], v246 offset:0
    s_cmp_ge_u32 s52, 4
    v_mfma_f32_16x16x32_bf16 v[20:23], v[164:167], v[108:111], v[20:23]
    ds_read_b128 v[100:103], v246 offset:2048
    ds_read_b128 v[104:107], v200
    v_mfma_f32_16x16x32_bf16 v[52:55], v[164:167], v[112:115], v[52:55]
    ds_read_b64_tr_b16 v[148:149], v245 offset:32
    s_cselect_b32 s44, s49, s48
    v_mfma_f32_16x16x32_bf16 v[24:27], v[168:171], v[108:111], v[24:27]
    ds_read_b64_tr_b16 v[150:151], v245 offset:544
    ds_read_b64_tr_b16 v[152:153], v245 offset:64
    v_mfma_f32_16x16x32_bf16 v[56:59], v[168:171], v[112:115], v[56:59]
    ds_read_b64_tr_b16 v[154:155], v245 offset:576
    s_add_u32 m0, s58, 95488
    v_mfma_f32_16x16x32_bf16 v[88:91], v[168:171], v[116:119], v[88:91]
    ds_read_b64_tr_b16 v[156:157], v245 offset:96
    ds_read_b64_tr_b16 v[158:159], v245 offset:608
    v_mfma_f32_16x16x32_bf16 v[28:31], v[172:175], v[108:111], v[28:31]
    s_add_u32 s44, s44, 2621440
    buffer_load_dwordx4 v248, s[12:15], s44 offen lds
    v_mfma_f32_16x16x32_bf16 v[60:63], v[172:175], v[112:115], v[60:63]
    s_add_u32 s44, s44, 130048
    buffer_load_dwordx4 v248, s[12:15], s44 offen offset:1024 lds
    v_mfma_f32_16x16x32_bf16 v[92:95], v[172:175], v[116:119], v[92:95]
    s_cmp_ge_u32 s52, 4
    s_cselect_b32 s45, s51, s50
    s_add_u32 m0, s59, 128768
    s_waitcnt lgkmcnt(4)
    v_mfma_f32_16x16x32_bf16 v[0:3], v[144:147], v[96:99], v[0:3]
    ds_read_b64_tr_b16 v[160:161], v245 offset:128
    s_add_u32 s45, s45, 640
    v_mfma_f32_16x16x32_bf16 v[32:35], v[144:147], v[100:103], v[32:35]
    ds_read_b64_tr_b16 v[162:163], v245 offset:640
    ds_read_b64_tr_b16 v[164:165], v245 offset:160
    v_mfma_f32_16x16x32_bf16 v[4:7], v[148:151], v[96:99], v[4:7]
    ds_read_b64_tr_b16 v[166:167], v245 offset:672
    buffer_load_dwordx4 v247, s[8:11], s45 offen lds
    v_mfma_f32_16x16x32_bf16 v[36:39], v[148:151], v[100:103], v[36:39]
    ds_read_b64_tr_b16 v[168:169], v245 offset:192
    s_add_u32 m0, s59, 136960
    s_waitcnt lgkmcnt(5)
    v_mfma_f32_16x16x32_bf16 v[8:11], v[152:155], v[96:99], v[8:11]
    ds_read_b64_tr_b16 v[170:171], v245 offset:704
    ds_read_b64_tr_b16 v[172:173], v245 offset:224
    v_mfma_f32_16x16x32_bf16 v[40:43], v[152:155], v[100:103], v[40:43]
    ds_read_b64_tr_b16 v[174:175], v245 offset:736
    s_add_u32 s44, s45, 73728
    v_mfma_f32_16x16x32_bf16 v[12:15], v[156:159], v[96:99], v[12:15]
    buffer_load_dwordx4 v247, s[8:11], s44 offen lds
    s_add_u32 m0, s53, 128768
    v_mfma_f32_16x16x32_bf16 v[44:47], v[156:159], v[100:103], v[44:47]
    s_add_u32 s45, s45, s83
    buffer_load_dwordx4 v247, s[8:11], s45 offen lds
    s_waitcnt lgkmcnt(0)
    s_waitcnt vmcnt(12)
    s_barrier
    v_add_u32 v245, 147200, v242
    v_add_u32 v246, 25344, v244
    v_subrev_u32 v200, s34, v246
    v_mfma_f32_16x16x32_bf16 v[16:19], v[160:163], v[96:99], v[16:19]
    ds_read_b64_tr_b16 v[144:145], v245 offset:0
    ds_read_b64_tr_b16 v[146:147], v245 offset:512
    v_mfma_f32_16x16x32_bf16 v[48:51], v[160:163], v[100:103], v[48:51]
    ds_read_b128 v[108:111], v246 offset:0
    v_mfma_f32_16x16x32_bf16 v[20:23], v[164:167], v[96:99], v[20:23]
    ds_read_b128 v[112:115], v246 offset:2048
    ds_read_b128 v[116:119], v200
    v_mfma_f32_16x16x32_bf16 v[52:55], v[164:167], v[100:103], v[52:55]
    ds_read_b64_tr_b16 v[148:149], v245 offset:32
    v_mfma_f32_16x16x32_bf16 v[24:27], v[168:171], v[96:99], v[24:27]
    ds_read_b64_tr_b16 v[150:151], v245 offset:544
    ds_read_b64_tr_b16 v[152:153], v245 offset:64
    v_mfma_f32_16x16x32_bf16 v[56:59], v[168:171], v[100:103], v[56:59]
    ds_read_b64_tr_b16 v[154:155], v245 offset:576
    v_mfma_f32_16x16x32_bf16 v[88:91], v[168:171], v[104:107], v[88:91]
    ds_read_b64_tr_b16 v[156:157], v245 offset:96
    ds_read_b64_tr_b16 v[158:159], v245 offset:608
    v_mfma_f32_16x16x32_bf16 v[28:31], v[172:175], v[96:99], v[28:31]
    s_cmp_ge_u32 s52, 4
    v_mfma_f32_16x16x32_bf16 v[60:63], v[172:175], v[100:103], v[60:63]
    s_cselect_b32 s44, s49, s48
    v_mfma_f32_16x16x32_bf16 v[92:95], v[172:175], v[104:107], v[92:95]
    s_add_u32 m0, s58, 112128
    s_waitcnt lgkmcnt(4)
    v_mfma_f32_16x16x32_bf16 v[0:3], v[144:147], v[108:111], v[0:3]
    ds_read_b64_tr_b16 v[160:161], v245 offset:128
    s_add_u32 s44, s44, 2883584
    v_mfma_f32_16x16x32_bf16 v[32:35], v[144:147], v[112:115], v[32:35]
    ds_read_b64_tr_b16 v[162:163], v245 offset:640
    ds_read_b64_tr_b16 v[164:165], v245 offset:160
    v_mfma_f32_16x16x32_bf16 v[4:7], v[148:151], v[108:111], v[4:7]
    ds_read_b64_tr_b16 v[166:167], v245 offset:672
    v_mfma_f32_16x16x32_bf16 v[36:39], v[148:151], v[112:115], v[36:39]
    ds_read_b64_tr_b16 v[168:169], v245 offset:192
    s_waitcnt lgkmcnt(5)
    v_mfma_f32_16x16x32_bf16 v[8:11], v[152:155], v[108:111], v[8:11]
    ds_read_b64_tr_b16 v[170:171], v245 offset:704
    ds_read_b64_tr_b16 v[172:173], v245 offset:224
    v_mfma_f32_16x16x32_bf16 v[40:43], v[152:155], v[112:115], v[40:43]
    ds_read_b64_tr_b16 v[174:175], v245 offset:736
    v_mfma_f32_16x16x32_bf16 v[12:15], v[156:159], v[108:111], v[12:15]
    buffer_load_dwordx4 v248, s[12:15], s44 offen lds
    s_add_u32 s44, s44, 130048
    v_mfma_f32_16x16x32_bf16 v[44:47], v[156:159], v[112:115], v[44:47]
    buffer_load_dwordx4 v248, s[12:15], s44 offen offset:1024 lds
    s_waitcnt lgkmcnt(0)
    s_waitcnt vmcnt(9)
    s_barrier
    v_add_u32 v245, 43776, v242
    v_add_u32 v246, 77056, v243
    v_subrev_u32 v200, s34, v246
    v_mfma_f32_16x16x32_bf16 v[16:19], v[160:163], v[108:111], v[16:19]
    ds_read_b64_tr_b16 v[144:145], v245 offset:0
    ds_read_b64_tr_b16 v[146:147], v245 offset:512
    v_mfma_f32_16x16x32_bf16 v[48:51], v[160:163], v[112:115], v[48:51]
    ds_read_b128 v[96:99], v246 offset:0
    global_load_dword v255, v202, s[4:5]
    v_mfma_f32_16x16x32_bf16 v[20:23], v[164:167], v[108:111], v[20:23]
    ds_read_b128 v[100:103], v246 offset:2048
    ds_read_b128 v[104:107], v200
    v_mfma_f32_16x16x32_bf16 v[52:55], v[164:167], v[112:115], v[52:55]
    ds_read_b64_tr_b16 v[148:149], v245 offset:32
    s_cmp_ge_u32 s52, 3
    v_mfma_f32_16x16x32_bf16 v[24:27], v[168:171], v[108:111], v[24:27]
    ds_read_b64_tr_b16 v[150:151], v245 offset:544
    ds_read_b64_tr_b16 v[152:153], v245 offset:64
    s_cselect_b32 s44, s49, s48
    v_mfma_f32_16x16x32_bf16 v[56:59], v[168:171], v[112:115], v[56:59]
    ds_read_b64_tr_b16 v[154:155], v245 offset:576
    s_add_u32 m0, s58, 147200
    v_mfma_f32_16x16x32_bf16 v[88:91], v[168:171], v[116:119], v[88:91]
    ds_read_b64_tr_b16 v[156:157], v245 offset:96
    ds_read_b64_tr_b16 v[158:159], v245 offset:608
    v_mfma_f32_16x16x32_bf16 v[28:31], v[172:175], v[108:111], v[28:31]
    s_add_u32 s44, s44, 3145728
    buffer_load_dwordx4 v248, s[12:15], s44 offen lds
    v_mfma_f32_16x16x32_bf16 v[60:63], v[172:175], v[112:115], v[60:63]
    s_add_u32 s44, s44, 130048
    buffer_load_dwordx4 v248, s[12:15], s44 offen offset:1024 lds
    v_mfma_f32_16x16x32_bf16 v[92:95], v[172:175], v[116:119], v[92:95]
    s_cmp_ge_u32 s52, 3
    s_cselect_b32 s45, s51, s50
    s_waitcnt lgkmcnt(4)
    v_mfma_f32_16x16x32_bf16 v[0:3], v[144:147], v[96:99], v[0:3]
    ds_read_b64_tr_b16 v[160:161], v245 offset:128
    s_add_u32 m0, s59, 25344
    v_mfma_f32_16x16x32_bf16 v[32:35], v[144:147], v[100:103], v[32:35]
    ds_read_b64_tr_b16 v[162:163], v245 offset:640
    ds_read_b64_tr_b16 v[164:165], v245 offset:160
    v_mfma_f32_16x16x32_bf16 v[4:7], v[148:151], v[96:99], v[4:7]
    ds_read_b64_tr_b16 v[166:167], v245 offset:672
    s_add_u32 s45, s45, 768
    v_mfma_f32_16x16x32_bf16 v[36:39], v[148:151], v[100:103], v[36:39]
    ds_read_b64_tr_b16 v[168:169], v245 offset:192
    buffer_load_dwordx4 v247, s[8:11], s45 offen lds
    s_add_u32 m0, s59, 33536
    s_waitcnt lgkmcnt(5)
    v_mfma_f32_16x16x32_bf16 v[8:11], v[152:155], v[96:99], v[8:11]
    ds_read_b64_tr_b16 v[170:171], v245 offset:704
    ds_read_b64_tr_b16 v[172:173], v245 offset:224
    v_mfma_f32_16x16x32_bf16 v[40:43], v[152:155], v[100:103], v[40:43]
    ds_read_b64_tr_b16 v[174:175], v245 offset:736
    s_add_u32 s44, s45, 73728
    v_mfma_f32_16x16x32_bf16 v[12:15], v[156:159], v[96:99], v[12:15]
    buffer_load_dwordx4 v247, s[8:11], s44 offen lds
    s_add_u32 m0, s53, 25344
    v_mfma_f32_16x16x32_bf16 v[44:47], v[156:159], v[100:103], v[44:47]
    s_add_u32 s45, s45, s83
    buffer_load_dwordx4 v247, s[8:11], s45 offen lds
    s_waitcnt lgkmcnt(0)
    s_waitcnt vmcnt(13)
    s_barrier
    v_add_u32 v245, 60416, v242
    v_add_u32 v246, 77056, v244
    v_subrev_u32 v200, s34, v246
    v_mfma_f32_16x16x32_bf16 v[16:19], v[160:163], v[96:99], v[16:19]
    ds_read_b64_tr_b16 v[144:145], v245 offset:0
    ds_read_b64_tr_b16 v[146:147], v245 offset:512
    v_mfma_f32_16x16x32_bf16 v[48:51], v[160:163], v[100:103], v[48:51]
    ds_read_b128 v[108:111], v246 offset:0
    v_mfma_f32_16x16x32_bf16 v[20:23], v[164:167], v[96:99], v[20:23]
    ds_read_b128 v[112:115], v246 offset:2048
    ds_read_b128 v[116:119], v200
    v_mfma_f32_16x16x32_bf16 v[52:55], v[164:167], v[100:103], v[52:55]
    ds_read_b64_tr_b16 v[148:149], v245 offset:32
    v_mfma_f32_16x16x32_bf16 v[24:27], v[168:171], v[96:99], v[24:27]
    ds_read_b64_tr_b16 v[150:151], v245 offset:544
    ds_read_b64_tr_b16 v[152:153], v245 offset:64
    v_mfma_f32_16x16x32_bf16 v[56:59], v[168:171], v[100:103], v[56:59]
    ds_read_b64_tr_b16 v[154:155], v245 offset:576
    v_mfma_f32_16x16x32_bf16 v[88:91], v[168:171], v[104:107], v[88:91]
    ds_read_b64_tr_b16 v[156:157], v245 offset:96
    ds_read_b64_tr_b16 v[158:159], v245 offset:608
    v_mfma_f32_16x16x32_bf16 v[28:31], v[172:175], v[96:99], v[28:31]
    s_cmp_ge_u32 s52, 3
    v_mfma_f32_16x16x32_bf16 v[60:63], v[172:175], v[100:103], v[60:63]
    s_cselect_b32 s44, s49, s48
    v_mfma_f32_16x16x32_bf16 v[92:95], v[172:175], v[104:107], v[92:95]
    s_add_u32 m0, s58, 43776
    s_waitcnt lgkmcnt(4)
    v_mfma_f32_16x16x32_bf16 v[0:3], v[144:147], v[108:111], v[0:3]
    ds_read_b64_tr_b16 v[160:161], v245 offset:128
    s_add_u32 s44, s44, 3407872
    v_mfma_f32_16x16x32_bf16 v[32:35], v[144:147], v[112:115], v[32:35]
    ds_read_b64_tr_b16 v[162:163], v245 offset:640
    ds_read_b64_tr_b16 v[164:165], v245 offset:160
    v_mfma_f32_16x16x32_bf16 v[4:7], v[148:151], v[108:111], v[4:7]
    ds_read_b64_tr_b16 v[166:167], v245 offset:672
    v_mfma_f32_16x16x32_bf16 v[36:39], v[148:151], v[112:115], v[36:39]
    ds_read_b64_tr_b16 v[168:169], v245 offset:192
    s_waitcnt lgkmcnt(5)
    v_mfma_f32_16x16x32_bf16 v[8:11], v[152:155], v[108:111], v[8:11]
    ds_read_b64_tr_b16 v[170:171], v245 offset:704
    ds_read_b64_tr_b16 v[172:173], v245 offset:224
    v_mfma_f32_16x16x32_bf16 v[40:43], v[152:155], v[112:115], v[40:43]
    ds_read_b64_tr_b16 v[174:175], v245 offset:736
    v_mfma_f32_16x16x32_bf16 v[12:15], v[156:159], v[108:111], v[12:15]
    buffer_load_dwordx4 v248, s[12:15], s44 offen lds
    s_add_u32 s44, s44, 130048
    v_mfma_f32_16x16x32_bf16 v[44:47], v[156:159], v[112:115], v[44:47]
    buffer_load_dwordx4 v248, s[12:15], s44 offen offset:1024 lds
    s_waitcnt lgkmcnt(0)
    s_waitcnt vmcnt(10)
    s_barrier
    v_add_u32 v245, 95488, v242
    v_add_u32 v246, 128768, v243
    v_subrev_u32 v200, s34, v246
    v_mfma_f32_16x16x32_bf16 v[16:19], v[160:163], v[108:111], v[16:19]
    ds_read_b64_tr_b16 v[144:145], v245 offset:0
    ds_read_b64_tr_b16 v[146:147], v245 offset:512
    v_mfma_f32_16x16x32_bf16 v[48:51], v[160:163], v[112:115], v[48:51]
    ds_read_b128 v[96:99], v246 offset:0
    s_cmp_ge_u32 s52, 2
    v_mfma_f32_16x16x32_bf16 v[20:23], v[164:167], v[108:111], v[20:23]
    ds_read_b128 v[100:103], v246 offset:2048
    ds_read_b128 v[104:107], v200
    v_mfma_f32_16x16x32_bf16 v[52:55], v[164:167], v[112:115], v[52:55]
    ds_read_b64_tr_b16 v[148:149], v245 offset:32
    s_cselect_b32 s44, s49, s48
    v_mfma_f32_16x16x32_bf16 v[24:27], v[168:171], v[108:111], v[24:27]
    ds_read_b64_tr_b16 v[150:151], v245 offset:544
    ds_read_b64_tr_b16 v[152:153], v245 offset:64
    v_mfma_f32_16x16x32_bf16 v[56:59], v[168:171], v[112:115], v[56:59]
    ds_read_b64_tr_b16 v[154:155], v245 offset:576
    s_add_u32 m0, s58, 60416
    v_mfma_f32_16x16x32_bf16 v[88:91], v[168:171], v[116:119], v[88:91]
    ds_read_b64_tr_b16 v[156:157], v245 offset:96
    ds_read_b64_tr_b16 v[158:159], v245 offset:608
    v_mfma_f32_16x16x32_bf16 v[28:31], v[172:175], v[108:111], v[28:31]
    s_add_u32 s44, s44, 3670016
    buffer_load_dwordx4 v248, s[12:15], s44 offen lds
    v_mfma_f32_16x16x32_bf16 v[60:63], v[172:175], v[112:115], v[60:63]
    s_add_u32 s44, s44, 130048
    buffer_load_dwordx4 v248, s[12:15], s44 offen offset:1024 lds
    v_mfma_f32_16x16x32_bf16 v[92:95], v[172:175], v[116:119], v[92:95]
    s_cmp_ge_u32 s52, 2
    s_cselect_b32 s45, s51, s50
    s_add_u32 m0, s59, 77056
    s_waitcnt lgkmcnt(4)
    v_mfma_f32_16x16x32_bf16 v[0:3], v[144:147], v[96:99], v[0:3]
    ds_read_b64_tr_b16 v[160:161], v245 offset:128
    s_add_u32 s45, s45, 896
    v_mfma_f32_16x16x32_bf16 v[32:35], v[144:147], v[100:103], v[32:35]
    ds_read_b64_tr_b16 v[162:163], v245 offset:640
    ds_read_b64_tr_b16 v[164:165], v245 offset:160
    v_mfma_f32_16x16x32_bf16 v[4:7], v[148:151], v[96:99], v[4:7]
    ds_read_b64_tr_b16 v[166:167], v245 offset:672
    buffer_load_dwordx4 v247, s[8:11], s45 offen lds
    v_mfma_f32_16x16x32_bf16 v[36:39], v[148:151], v[100:103], v[36:39]
    ds_read_b64_tr_b16 v[168:169], v245 offset:192
    s_add_u32 m0, s59, 85248
    s_waitcnt lgkmcnt(5)
    v_mfma_f32_16x16x32_bf16 v[8:11], v[152:155], v[96:99], v[8:11]
    ds_read_b64_tr_b16 v[170:171], v245 offset:704
    ds_read_b64_tr_b16 v[172:173], v245 offset:224
    v_mfma_f32_16x16x32_bf16 v[40:43], v[152:155], v[100:103], v[40:43]
    ds_read_b64_tr_b16 v[174:175], v245 offset:736
    s_add_u32 s44, s45, 73728
    v_mfma_f32_16x16x32_bf16 v[12:15], v[156:159], v[96:99], v[12:15]
    buffer_load_dwordx4 v247, s[8:11], s44 offen lds
    s_add_u32 m0, s53, 77056
    v_mfma_f32_16x16x32_bf16 v[44:47], v[156:159], v[100:103], v[44:47]
    s_add_u32 s45, s45, s83
    buffer_load_dwordx4 v247, s[8:11], s45 offen lds
    s_waitcnt lgkmcnt(0)
    s_waitcnt vmcnt(13)
    s_barrier
    v_add_u32 v245, 112128, v242
    v_add_u32 v246, 128768, v244
    v_subrev_u32 v200, s34, v246
    v_mfma_f32_16x16x32_bf16 v[16:19], v[160:163], v[96:99], v[16:19]
    ds_read_b64_tr_b16 v[144:145], v245 offset:0
    ds_read_b64_tr_b16 v[146:147], v245 offset:512
    v_mfma_f32_16x16x32_bf16 v[48:51], v[160:163], v[100:103], v[48:51]
    ds_read_b128 v[108:111], v246 offset:0
    v_mfma_f32_16x16x32_bf16 v[20:23], v[164:167], v[96:99], v[20:23]
    ds_read_b128 v[112:115], v246 offset:2048
    ds_read_b128 v[116:119], v200
    v_mfma_f32_16x16x32_bf16 v[52:55], v[164:167], v[100:103], v[52:55]
    ds_read_b64_tr_b16 v[148:149], v245 offset:32
    v_mfma_f32_16x16x32_bf16 v[24:27], v[168:171], v[96:99], v[24:27]
    ds_read_b64_tr_b16 v[150:151], v245 offset:544
    ds_read_b64_tr_b16 v[152:153], v245 offset:64
    v_mfma_f32_16x16x32_bf16 v[56:59], v[168:171], v[100:103], v[56:59]
    ds_read_b64_tr_b16 v[154:155], v245 offset:576
    v_mfma_f32_16x16x32_bf16 v[88:91], v[168:171], v[104:107], v[88:91]
    ds_read_b64_tr_b16 v[156:157], v245 offset:96
    ds_read_b64_tr_b16 v[158:159], v245 offset:608
    v_mfma_f32_16x16x32_bf16 v[28:31], v[172:175], v[96:99], v[28:31]
    s_cmp_ge_u32 s52, 2
    v_mfma_f32_16x16x32_bf16 v[60:63], v[172:175], v[100:103], v[60:63]
    s_cselect_b32 s44, s49, s48
    v_mfma_f32_16x16x32_bf16 v[92:95], v[172:175], v[104:107], v[92:95]
    s_add_u32 m0, s58, 95488
    s_waitcnt lgkmcnt(4)
    v_mfma_f32_16x16x32_bf16 v[0:3], v[144:147], v[108:111], v[0:3]
    ds_read_b64_tr_b16 v[160:161], v245 offset:128
    s_add_u32 s44, s44, 3932160
    v_mfma_f32_16x16x32_bf16 v[32:35], v[144:147], v[112:115], v[32:35]
    ds_read_b64_tr_b16 v[162:163], v245 offset:640
    ds_read_b64_tr_b16 v[164:165], v245 offset:160
    v_mfma_f32_16x16x32_bf16 v[4:7], v[148:151], v[108:111], v[4:7]
    ds_read_b64_tr_b16 v[166:167], v245 offset:672
    v_mfma_f32_16x16x32_bf16 v[36:39], v[148:151], v[112:115], v[36:39]
    ds_read_b64_tr_b16 v[168:169], v245 offset:192
    s_waitcnt lgkmcnt(5)
    v_mfma_f32_16x16x32_bf16 v[8:11], v[152:155], v[108:111], v[8:11]
    ds_read_b64_tr_b16 v[170:171], v245 offset:704
    ds_read_b64_tr_b16 v[172:173], v245 offset:224
    v_mfma_f32_16x16x32_bf16 v[40:43], v[152:155], v[112:115], v[40:43]
    ds_read_b64_tr_b16 v[174:175], v245 offset:736
    v_mfma_f32_16x16x32_bf16 v[12:15], v[156:159], v[108:111], v[12:15]
    buffer_load_dwordx4 v248, s[12:15], s44 offen lds
    s_add_u32 s44, s44, 130048
    v_mfma_f32_16x16x32_bf16 v[44:47], v[156:159], v[112:115], v[44:47]
    buffer_load_dwordx4 v248, s[12:15], s44 offen offset:1024 lds
    s_waitcnt lgkmcnt(0)
    s_waitcnt vmcnt(9)
    s_barrier
    v_add_u32 v245, 147200, v242
    v_add_u32 v246, 25344, v243
    v_subrev_u32 v200, s34, v246
    v_mfma_f32_16x16x32_bf16 v[16:19], v[160:163], v[108:111], v[16:19]
    ds_read_b64_tr_b16 v[144:145], v245 offset:0
    ds_read_b64_tr_b16 v[146:147], v245 offset:512
    v_mfma_f32_16x16x32_bf16 v[48:51], v[160:163], v[112:115], v[48:51]
    ds_read_b128 v[96:99], v246 offset:0
    s_cmp_ge_u32 s52, 1
    v_mfma_f32_16x16x32_bf16 v[20:23], v[164:167], v[108:111], v[20:23]
    ds_read_b128 v[100:103], v246 offset:2048
    ds_read_b128 v[104:107], v200
    v_mfma_f32_16x16x32_bf16 v[52:55], v[164:167], v[112:115], v[52:55]
    ds_read_b64_tr_b16 v[148:149], v245 offset:32
    s_cselect_b32 s44, s49, s48
    v_mfma_f32_16x16x32_bf16 v[24:27], v[168:171], v[108:111], v[24:27]
    ds_read_b64_tr_b16 v[150:151], v245 offset:544
    ds_read_b64_tr_b16 v[152:153], v245 offset:64
    v_mfma_f32_16x16x32_bf16 v[56:59], v[168:171], v[112:115], v[56:59]
    ds_read_b64_tr_b16 v[154:155], v245 offset:576
    s_add_u32 m0, s58, 112128
    v_mfma_f32_16x16x32_bf16 v[88:91], v[168:171], v[116:119], v[88:91]
    ds_read_b64_tr_b16 v[156:157], v245 offset:96
    ds_read_b64_tr_b16 v[158:159], v245 offset:608
    v_mfma_f32_16x16x32_bf16 v[28:31], v[172:175], v[108:111], v[28:31]
    s_add_u32 s44, s44, 4194304
    buffer_load_dwordx4 v248, s[12:15], s44 offen lds
    v_mfma_f32_16x16x32_bf16 v[60:63], v[172:175], v[112:115], v[60:63]
    s_add_u32 s44, s44, 130048
    buffer_load_dwordx4 v248, s[12:15], s44 offen offset:1024 lds
    v_mfma_f32_16x16x32_bf16 v[92:95], v[172:175], v[116:119], v[92:95]
    s_cmp_ge_u32 s52, 1
    s_cselect_b32 s45, s51, s50
    s_add_u32 m0, s59, 128768
    s_waitcnt lgkmcnt(4)
    v_mfma_f32_16x16x32_bf16 v[0:3], v[144:147], v[96:99], v[0:3]
    ds_read_b64_tr_b16 v[160:161], v245 offset:128
    s_add_u32 s45, s45, 1024
    v_mfma_f32_16x16x32_bf16 v[32:35], v[144:147], v[100:103], v[32:35]
    ds_read_b64_tr_b16 v[162:163], v245 offset:640
    ds_read_b64_tr_b16 v[164:165], v245 offset:160
    v_mfma_f32_16x16x32_bf16 v[4:7], v[148:151], v[96:99], v[4:7]
    ds_read_b64_tr_b16 v[166:167], v245 offset:672
    buffer_load_dwordx4 v247, s[8:11], s45 offen lds
    v_mfma_f32_16x16x32_bf16 v[36:39], v[148:151], v[100:103], v[36:39]
    ds_read_b64_tr_b16 v[168:169], v245 offset:192
    s_add_u32 m0, s59, 136960
    s_waitcnt lgkmcnt(5)
    v_mfma_f32_16x16x32_bf16 v[8:11], v[152:155], v[96:99], v[8:11]
    ds_read_b64_tr_b16 v[170:171], v245 offset:704
    ds_read_b64_tr_b16 v[172:173], v245 offset:224
    v_mfma_f32_16x16x32_bf16 v[40:43], v[152:155], v[100:103], v[40:43]
    ds_read_b64_tr_b16 v[174:175], v245 offset:736
    s_add_u32 s44, s45, 73728
    v_mfma_f32_16x16x32_bf16 v[12:15], v[156:159], v[96:99], v[12:15]
    buffer_load_dwordx4 v247, s[8:11], s44 offen lds
    s_add_u32 m0, s53, 128768
    v_mfma_f32_16x16x32_bf16 v[44:47], v[156:159], v[100:103], v[44:47]
    s_add_u32 s45, s45, s83
    buffer_load_dwordx4 v247, s[8:11], s45 offen lds
    s_waitcnt lgkmcnt(0)
    s_waitcnt vmcnt(12)
    s_barrier
    v_add_u32 v245, 43776, v242
    v_add_u32 v246, 25344, v244
    v_subrev_u32 v200, s34, v246
    v_mfma_f32_16x16x32_bf16 v[16:19], v[160:163], v[96:99], v[16:19]
    ds_read_b64_tr_b16 v[144:145], v245 offset:0
    ds_read_b64_tr_b16 v[146:147], v245 offset:512
    v_mfma_f32_16x16x32_bf16 v[48:51], v[160:163], v[100:103], v[48:51]
    ds_read_b128 v[108:111], v246 offset:0
    v_mfma_f32_16x16x32_bf16 v[20:23], v[164:167], v[96:99], v[20:23]
    ds_read_b128 v[112:115], v246 offset:2048
    ds_read_b128 v[116:119], v200
    v_mfma_f32_16x16x32_bf16 v[52:55], v[164:167], v[100:103], v[52:55]
    ds_read_b64_tr_b16 v[148:149], v245 offset:32
    v_mfma_f32_16x16x32_bf16 v[24:27], v[168:171], v[96:99], v[24:27]
    ds_read_b64_tr_b16 v[150:151], v245 offset:544
    ds_read_b64_tr_b16 v[152:153], v245 offset:64
    v_mfma_f32_16x16x32_bf16 v[56:59], v[168:171], v[100:103], v[56:59]
    ds_read_b64_tr_b16 v[154:155], v245 offset:576
    v_mfma_f32_16x16x32_bf16 v[88:91], v[168:171], v[104:107], v[88:91]
    ds_read_b64_tr_b16 v[156:157], v245 offset:96
    ds_read_b64_tr_b16 v[158:159], v245 offset:608
    v_mfma_f32_16x16x32_bf16 v[28:31], v[172:175], v[96:99], v[28:31]
    s_cmp_ge_u32 s52, 1
    v_mfma_f32_16x16x32_bf16 v[60:63], v[172:175], v[100:103], v[60:63]
    s_cselect_b32 s44, s49, s48
    s_add_u32 m0, s58, 147200
    v_mfma_f32_16x16x32_bf16 v[92:95], v[172:175], v[104:107], v[92:95]
    s_add_u32 s44, s44, 4456448
    s_waitcnt lgkmcnt(4)
    v_mfma_f32_16x16x32_bf16 v[0:3], v[144:147], v[108:111], v[0:3]
    ds_read_b64_tr_b16 v[160:161], v245 offset:128
    buffer_load_dwordx4 v248, s[12:15], s44 offen lds
    v_mfma_f32_16x16x32_bf16 v[32:35], v[144:147], v[112:115], v[32:35]
    ds_read_b64_tr_b16 v[162:163], v245 offset:640
    ds_read_b64_tr_b16 v[164:165], v245 offset:160
    v_mfma_f32_16x16x32_bf16 v[4:7], v[148:151], v[108:111], v[4:7]
    ds_read_b64_tr_b16 v[166:167], v245 offset:672
    v_mfma_f32_16x16x32_bf16 v[36:39], v[148:151], v[112:115], v[36:39]
    ds_read_b64_tr_b16 v[168:169], v245 offset:192
    s_waitcnt lgkmcnt(5)
    v_mfma_f32_16x16x32_bf16 v[8:11], v[152:155], v[108:111], v[8:11]
    ds_read_b64_tr_b16 v[170:171], v245 offset:704
    ds_read_b64_tr_b16 v[172:173], v245 offset:224
    v_mfma_f32_16x16x32_bf16 v[40:43], v[152:155], v[112:115], v[40:43]
    ds_read_b64_tr_b16 v[174:175], v245 offset:736
    v_mfma_f32_16x16x32_bf16 v[12:15], v[156:159], v[108:111], v[12:15]
    s_add_u32 s44, s44, 130048
    buffer_load_dwordx4 v248, s[12:15], s44 offen offset:1024 lds
    v_mfma_f32_16x16x32_bf16 v[44:47], v[156:159], v[112:115], v[44:47]
    buffer_load_dword v184, off, s[88:91], s35 sc1
    s_waitcnt lgkmcnt(0)
    s_waitcnt vmcnt(10)
    s_barrier
    v_add_u32 v245, 60416, v242
    v_add_u32 v246, 77056, v243
    v_subrev_u32 v200, s34, v246
    v_mfma_f32_16x16x32_bf16 v[16:19], v[160:163], v[108:111], v[16:19]
    ds_read_b64_tr_b16 v[144:145], v245 offset:0
    ds_read_b64_tr_b16 v[146:147], v245 offset:512
    v_mfma_f32_16x16x32_bf16 v[48:51], v[160:163], v[112:115], v[48:51]
    ds_read_b128 v[96:99], v246 offset:0
    v_mfma_f32_16x16x32_bf16 v[20:23], v[164:167], v[108:111], v[20:23]
    ds_read_b128 v[100:103], v246 offset:2048
    ds_read_b128 v[104:107], v200
    v_mfma_f32_16x16x32_bf16 v[52:55], v[164:167], v[112:115], v[52:55]
    ds_read_b64_tr_b16 v[148:149], v245 offset:32
    v_mfma_f32_16x16x32_bf16 v[24:27], v[168:171], v[108:111], v[24:27]
    ds_read_b64_tr_b16 v[150:151], v245 offset:544
    ds_read_b64_tr_b16 v[152:153], v245 offset:64
    v_mfma_f32_16x16x32_bf16 v[56:59], v[168:171], v[112:115], v[56:59]
    ds_read_b64_tr_b16 v[154:155], v245 offset:576
    v_mfma_f32_16x16x32_bf16 v[88:91], v[168:171], v[116:119], v[88:91]
    ds_read_b64_tr_b16 v[156:157], v245 offset:96
    ds_read_b64_tr_b16 v[158:159], v245 offset:608
    v_mfma_f32_16x16x32_bf16 v[28:31], v[172:175], v[108:111], v[28:31]
    v_mfma_f32_16x16x32_bf16 v[60:63], v[172:175], v[112:115], v[60:63]
    v_mfma_f32_16x16x32_bf16 v[92:95], v[172:175], v[116:119], v[92:95]
    s_waitcnt lgkmcnt(4)
    v_mfma_f32_16x16x32_bf16 v[0:3], v[144:147], v[96:99], v[0:3]
    ds_read_b64_tr_b16 v[160:161], v245 offset:128
    v_mfma_f32_16x16x32_bf16 v[32:35], v[144:147], v[100:103], v[32:35]
    ds_read_b64_tr_b16 v[162:163], v245 offset:640
    ds_read_b64_tr_b16 v[164:165], v245 offset:160
    v_mfma_f32_16x16x32_bf16 v[4:7], v[148:151], v[96:99], v[4:7]
    ds_read_b64_tr_b16 v[166:167], v245 offset:672
    v_mfma_f32_16x16x32_bf16 v[36:39], v[148:151], v[100:103], v[36:39]
    ds_read_b64_tr_b16 v[168:169], v245 offset:192
    s_waitcnt lgkmcnt(5)
    v_mfma_f32_16x16x32_bf16 v[8:11], v[152:155], v[96:99], v[8:11]
    ds_read_b64_tr_b16 v[170:171], v245 offset:704
    ds_read_b64_tr_b16 v[172:173], v245 offset:224
    v_mfma_f32_16x16x32_bf16 v[40:43], v[152:155], v[100:103], v[40:43]
    ds_read_b64_tr_b16 v[174:175], v245 offset:736
    v_mfma_f32_16x16x32_bf16 v[12:15], v[156:159], v[96:99], v[12:15]
    v_mfma_f32_16x16x32_bf16 v[44:47], v[156:159], v[100:103], v[44:47]
    s_waitcnt lgkmcnt(0)
    s_waitcnt vmcnt(8)
    s_barrier
    v_add_u32 v245, 95488, v242
    v_add_u32 v246, 77056, v244
    v_subrev_u32 v200, s34, v246
    v_mfma_f32_16x16x32_bf16 v[16:19], v[160:163], v[96:99], v[16:19]
    ds_read_b64_tr_b16 v[144:145], v245 offset:0
    ds_read_b64_tr_b16 v[146:147], v245 offset:512
    v_mfma_f32_16x16x32_bf16 v[48:51], v[160:163], v[100:103], v[48:51]
    ds_read_b128 v[108:111], v246 offset:0
    v_mfma_f32_16x16x32_bf16 v[20:23], v[164:167], v[96:99], v[20:23]
    ds_read_b128 v[112:115], v246 offset:2048
    ds_read_b128 v[116:119], v200
    v_mfma_f32_16x16x32_bf16 v[52:55], v[164:167], v[100:103], v[52:55]
    ds_read_b64_tr_b16 v[148:149], v245 offset:32
    v_mfma_f32_16x16x32_bf16 v[24:27], v[168:171], v[96:99], v[24:27]
    ds_read_b64_tr_b16 v[150:151], v245 offset:544
    ds_read_b64_tr_b16 v[152:153], v245 offset:64
    v_mfma_f32_16x16x32_bf16 v[56:59], v[168:171], v[100:103], v[56:59]
    ds_read_b64_tr_b16 v[154:155], v245 offset:576
    v_mfma_f32_16x16x32_bf16 v[88:91], v[168:171], v[104:107], v[88:91]
    ds_read_b64_tr_b16 v[156:157], v245 offset:96
    ds_read_b64_tr_b16 v[158:159], v245 offset:608
    v_mfma_f32_16x16x32_bf16 v[28:31], v[172:175], v[96:99], v[28:31]
    v_mfma_f32_16x16x32_bf16 v[60:63], v[172:175], v[100:103], v[60:63]
    v_mfma_f32_16x16x32_bf16 v[92:95], v[172:175], v[104:107], v[92:95]
    s_waitcnt lgkmcnt(4)
    v_mfma_f32_16x16x32_bf16 v[0:3], v[144:147], v[108:111], v[0:3]
    ds_read_b64_tr_b16 v[160:161], v245 offset:128
    v_mfma_f32_16x16x32_bf16 v[32:35], v[144:147], v[112:115], v[32:35]
    ds_read_b64_tr_b16 v[162:163], v245 offset:640
    ds_read_b64_tr_b16 v[164:165], v245 offset:160
    v_mfma_f32_16x16x32_bf16 v[4:7], v[148:151], v[108:111], v[4:7]
    ds_read_b64_tr_b16 v[166:167], v245 offset:672
    v_mfma_f32_16x16x32_bf16 v[36:39], v[148:151], v[112:115], v[36:39]
    ds_read_b64_tr_b16 v[168:169], v245 offset:192
    s_waitcnt lgkmcnt(5)
    v_mfma_f32_16x16x32_bf16 v[8:11], v[152:155], v[108:111], v[8:11]
    ds_read_b64_tr_b16 v[170:171], v245 offset:704
    ds_read_b64_tr_b16 v[172:173], v245 offset:224
    v_mfma_f32_16x16x32_bf16 v[40:43], v[152:155], v[112:115], v[40:43]
    ds_read_b64_tr_b16 v[174:175], v245 offset:736
    v_mfma_f32_16x16x32_bf16 v[12:15], v[156:159], v[108:111], v[12:15]
    v_mfma_f32_16x16x32_bf16 v[44:47], v[156:159], v[112:115], v[44:47]
    s_waitcnt lgkmcnt(0)
    s_waitcnt vmcnt(3)
    s_barrier
    v_add_u32 v245, 112128, v242
    v_add_u32 v246, 128768, v243
    v_subrev_u32 v200, s34, v246
    v_mfma_f32_16x16x32_bf16 v[16:19], v[160:163], v[108:111], v[16:19]
    ds_read_b64_tr_b16 v[144:145], v245 offset:0
    ds_read_b64_tr_b16 v[146:147], v245 offset:512
    v_mfma_f32_16x16x32_bf16 v[48:51], v[160:163], v[112:115], v[48:51]
    ds_read_b128 v[96:99], v246 offset:0
    v_mfma_f32_16x16x32_bf16 v[20:23], v[164:167], v[108:111], v[20:23]
    ds_read_b128 v[100:103], v246 offset:2048
    ds_read_b128 v[104:107], v200
    v_mfma_f32_16x16x32_bf16 v[52:55], v[164:167], v[112:115], v[52:55]
    ds_read_b64_tr_b16 v[148:149], v245 offset:32
    v_mfma_f32_16x16x32_bf16 v[24:27], v[168:171], v[108:111], v[24:27]
    ds_read_b64_tr_b16 v[150:151], v245 offset:544
    ds_read_b64_tr_b16 v[152:153], v245 offset:64
    v_mfma_f32_16x16x32_bf16 v[56:59], v[168:171], v[112:115], v[56:59]
    ds_read_b64_tr_b16 v[154:155], v245 offset:576
    v_mfma_f32_16x16x32_bf16 v[88:91], v[168:171], v[116:119], v[88:91]
    ds_read_b64_tr_b16 v[156:157], v245 offset:96
    ds_read_b64_tr_b16 v[158:159], v245 offset:608
    v_mfma_f32_16x16x32_bf16 v[28:31], v[172:175], v[108:111], v[28:31]
    v_mfma_f32_16x16x32_bf16 v[60:63], v[172:175], v[112:115], v[60:63]
    v_mfma_f32_16x16x32_bf16 v[92:95], v[172:175], v[116:119], v[92:95]
    s_waitcnt lgkmcnt(4)
    v_mfma_f32_16x16x32_bf16 v[0:3], v[144:147], v[96:99], v[0:3]
    ds_read_b64_tr_b16 v[160:161], v245 offset:128
    v_mfma_f32_16x16x32_bf16 v[32:35], v[144:147], v[100:103], v[32:35]
    ds_read_b64_tr_b16 v[162:163], v245 offset:640
    ds_read_b64_tr_b16 v[164:165], v245 offset:160
    v_mfma_f32_16x16x32_bf16 v[4:7], v[148:151], v[96:99], v[4:7]
    ds_read_b64_tr_b16 v[166:167], v245 offset:672
    v_mfma_f32_16x16x32_bf16 v[36:39], v[148:151], v[100:103], v[36:39]
    ds_read_b64_tr_b16 v[168:169], v245 offset:192
    s_waitcnt lgkmcnt(5)
    v_mfma_f32_16x16x32_bf16 v[8:11], v[152:155], v[96:99], v[8:11]
    ds_read_b64_tr_b16 v[170:171], v245 offset:704
    ds_read_b64_tr_b16 v[172:173], v245 offset:224
    v_mfma_f32_16x16x32_bf16 v[40:43], v[152:155], v[100:103], v[40:43]
    ds_read_b64_tr_b16 v[174:175], v245 offset:736
    v_mfma_f32_16x16x32_bf16 v[12:15], v[156:159], v[96:99], v[12:15]
    v_mfma_f32_16x16x32_bf16 v[44:47], v[156:159], v[100:103], v[44:47]
    s_waitcnt lgkmcnt(0)
    s_waitcnt vmcnt(1)
    s_barrier
    v_add_u32 v245, 147200, v242
    v_add_u32 v246, 128768, v244
    v_subrev_u32 v200, s34, v246
    v_mfma_f32_16x16x32_bf16 v[16:19], v[160:163], v[96:99], v[16:19]
    ds_read_b64_tr_b16 v[144:145], v245 offset:0
    ds_read_b64_tr_b16 v[146:147], v245 offset:512
    v_mfma_f32_16x16x32_bf16 v[48:51], v[160:163], v[100:103], v[48:51]
    ds_read_b128 v[108:111], v246 offset:0
    v_mfma_f32_16x16x32_bf16 v[20:23], v[164:167], v[96:99], v[20:23]
    ds_read_b128 v[112:115], v246 offset:2048
    ds_read_b128 v[116:119], v200
    v_mfma_f32_16x16x32_bf16 v[52:55], v[164:167], v[100:103], v[52:55]
    ds_read_b64_tr_b16 v[148:149], v245 offset:32
    v_mfma_f32_16x16x32_bf16 v[24:27], v[168:171], v[96:99], v[24:27]
    ds_read_b64_tr_b16 v[150:151], v245 offset:544
    ds_read_b64_tr_b16 v[152:153], v245 offset:64
    v_mfma_f32_16x16x32_bf16 v[56:59], v[168:171], v[100:103], v[56:59]
    ds_read_b64_tr_b16 v[154:155], v245 offset:576
    v_mfma_f32_16x16x32_bf16 v[88:91], v[168:171], v[104:107], v[88:91]
    ds_read_b64_tr_b16 v[156:157], v245 offset:96
    ds_read_b64_tr_b16 v[158:159], v245 offset:608
    v_mfma_f32_16x16x32_bf16 v[28:31], v[172:175], v[96:99], v[28:31]
    v_mfma_f32_16x16x32_bf16 v[60:63], v[172:175], v[100:103], v[60:63]
    v_mfma_f32_16x16x32_bf16 v[92:95], v[172:175], v[104:107], v[92:95]
    s_waitcnt lgkmcnt(4)
    v_mfma_f32_16x16x32_bf16 v[0:3], v[144:147], v[108:111], v[0:3]
    ds_read_b64_tr_b16 v[160:161], v245 offset:128
    v_mfma_f32_16x16x32_bf16 v[32:35], v[144:147], v[112:115], v[32:35]
    ds_read_b64_tr_b16 v[162:163], v245 offset:640
    ds_read_b64_tr_b16 v[164:165], v245 offset:160
    v_mfma_f32_16x16x32_bf16 v[4:7], v[148:151], v[108:111], v[4:7]
    ds_read_b64_tr_b16 v[166:167], v245 offset:672
    v_mfma_f32_16x16x32_bf16 v[36:39], v[148:151], v[112:115], v[36:39]
    ds_read_b64_tr_b16 v[168:169], v245 offset:192
    s_waitcnt lgkmcnt(5)
    v_mfma_f32_16x16x32_bf16 v[8:11], v[152:155], v[108:111], v[8:11]
    ds_read_b64_tr_b16 v[170:171], v245 offset:704
    ds_read_b64_tr_b16 v[172:173], v245 offset:224
    v_mfma_f32_16x16x32_bf16 v[40:43], v[152:155], v[112:115], v[40:43]
    ds_read_b64_tr_b16 v[174:175], v245 offset:736
    v_mfma_f32_16x16x32_bf16 v[12:15], v[156:159], v[108:111], v[12:15]
    v_mfma_f32_16x16x32_bf16 v[44:47], v[156:159], v[112:115], v[44:47]
    s_waitcnt lgkmcnt(0)
    s_barrier
    v_mfma_f32_16x16x32_bf16 v[16:19], v[160:163], v[108:111], v[16:19]
    v_mfma_f32_16x16x32_bf16 v[48:51], v[160:163], v[112:115], v[48:51]
    v_mfma_f32_16x16x32_bf16 v[20:23], v[164:167], v[108:111], v[20:23]
    v_mfma_f32_16x16x32_bf16 v[52:55], v[164:167], v[112:115], v[52:55]
    v_mfma_f32_16x16x32_bf16 v[24:27], v[168:171], v[108:111], v[24:27]
    v_mfma_f32_16x16x32_bf16 v[56:59], v[168:171], v[112:115], v[56:59]
    v_mfma_f32_16x16x32_bf16 v[88:91], v[168:171], v[116:119], v[88:91]
    v_mfma_f32_16x16x32_bf16 v[28:31], v[172:175], v[108:111], v[28:31]
    v_mfma_f32_16x16x32_bf16 v[60:63], v[172:175], v[112:115], v[60:63]
    v_mfma_f32_16x16x32_bf16 v[92:95], v[172:175], v[116:119], v[92:95]
    v_mov_b32 v244, v220
    v_mov_b32 v245, v221
    v_mov_b32 v246, v222
    v_mov_b32 v248, v202
    s_mov_b32 s76, 0
    s_waitcnt vmcnt(0)
wx_rg:
    v_readfirstlane_b32 s44, v184
    s_nop 0
    s_cmp_eq_u32 s44, 16
    s_cbranch_scc1 wx_rg_ok
    s_sleep 16
    buffer_load_dword v184, off, s[88:91], s35 sc1
    s_waitcnt vmcnt(0)
    s_branch wx_rg
wx_rg_ok:
    v_pk_mul_f32 v[88:89], v[88:89], s[56:57]
    v_pk_mul_f32 v[90:91], v[90:91], s[56:57]
    v_pk_mul_f32 v[92:93], v[92:93], s[56:57]
    v_pk_mul_f32 v[94:95], v[94:95], s[56:57]
    v_cvt_pk_bf16_f32 v140, v88, v89
    v_cvt_pk_bf16_f32 v141, v90, v91
    v_cvt_pk_bf16_f32 v142, v92, v93
    v_cvt_pk_bf16_f32 v143, v94, v95
    s_nop 0
    v_permlane32_swap_b32 v140, v142
    s_nop 0
    v_permlane32_swap_b32 v141, v143
    s_nop 0
    v_permlane16_swap_b32 v140, v142
    s_nop 0
    v_permlane16_swap_b32 v141, v143
    ds_write_b128 v249, v[140:143]
    v_pk_mul_f32 v[0:1], v[0:1], s[56:57]
    v_pk_mul_f32 v[2:3], v[2:3], s[56:57]
    v_pk_mul_f32 v[4:5], v[4:5], s[56:57]
    v_pk_mul_f32 v[6:7], v[6:7], s[56:57]
    v_pk_mul_f32 v[8:9], v[8:9], s[56:57]
    v_pk_mul_f32 v[10:11], v[10:11], s[56:57]
    v_pk_mul_f32 v[12:13], v[12:13], s[56:57]
    v_pk_mul_f32 v[14:15], v[14:15], s[56:57]
    v_pk_mul_f32 v[16:17], v[16:17], s[56:57]
    v_pk_mul_f32 v[18:19], v[18:19], s[56:57]
    v_pk_mul_f32 v[20:21], v[20:21], s[56:57]
    v_pk_mul_f32 v[22:23], v[22:23], s[56:57]
    v_pk_mul_f32 v[24:25], v[24:25], s[56:57]
    v_pk_mul_f32 v[26:27], v[26:27], s[56:57]
    v_pk_mul_f32 v[28:29], v[28:29], s[56:57]
    v_pk_mul_f32 v[30:31], v[30:31], s[56:57]
    v_pk_mul_f32 v[32:33], v[32:33], s[56:57]
    v_pk_mul_f32 v[34:35], v[34:35], s[56:57]
    v_pk_mul_f32 v[36:37], v[36:37], s[56:57]
    v_pk_mul_f32 v[38:39], v[38:39], s[56:57]
    v_pk_mul_f32 v[40:41], v[40:41], s[56:57]
    v_pk_mul_f32 v[42:43], v[42:43], s[56:57]
    v_pk_mul_f32 v[44:45], v[44:45], s[56:57]
    v_pk_mul_f32 v[46:47], v[46:47], s[56:57]
    v_pk_mul_f32 v[48:49], v[48:49], s[56:57]
    v_pk_mul_f32 v[50:51], v[50:51], s[56:57]
    v_pk_mul_f32 v[52:53], v[52:53], s[56:57]
    v_pk_mul_f32 v[54:55], v[54:55], s[56:57]
    v_pk_mul_f32 v[56:57], v[56:57], s[56:57]
    v_pk_mul_f32 v[58:59], v[58:59], s[56:57]
    v_pk_mul_f32 v[60:61], v[60:61], s[56:57]
    v_pk_mul_f32 v[62:63], v[62:63], s[56:57]
    v_cvt_pk_bf16_f32 v96, v0, v1
    v_cvt_pk_bf16_f32 v97, v2, v3
    v_cvt_pk_bf16_f32 v98, v4, v5
    v_cvt_pk_bf16_f32 v99, v6, v7
    v_cvt_pk_bf16_f32 v100, v8, v9
    v_cvt_pk_bf16_f32 v101, v10, v11
    v_cvt_pk_bf16_f32 v102, v12, v13
    v_cvt_pk_bf16_f32 v103, v14, v15
    v_cvt_pk_bf16_f32 v104, v16, v17
    v_cvt_pk_bf16_f32 v105, v18, v19
    v_cvt_pk_bf16_f32 v106, v20, v21
    v_cvt_pk_bf16_f32 v107, v22, v23
    v_cvt_pk_bf16_f32 v108, v24, v25
    v_cvt_pk_bf16_f32 v109, v26, v27
    v_cvt_pk_bf16_f32 v110, v28, v29
    v_cvt_pk_bf16_f32 v111, v30, v31
    v_cvt_pk_bf16_f32 v112, v32, v33
    v_cvt_pk_bf16_f32 v113, v34, v35
    v_cvt_pk_bf16_f32 v114, v36, v37
    v_cvt_pk_bf16_f32 v115, v38, v39
    v_cvt_pk_bf16_f32 v116, v40, v41
    v_cvt_pk_bf16_f32 v117, v42, v43
    v_cvt_pk_bf16_f32 v118, v44, v45
    v_cvt_pk_bf16_f32 v119, v46, v47
    v_cvt_pk_bf16_f32 v120, v48, v49
    v_cvt_pk_bf16_f32 v121, v50, v51
    v_cvt_pk_bf16_f32 v122, v52, v53
    v_cvt_pk_bf16_f32 v123, v54, v55
    v_cvt_pk_bf16_f32 v124, v56, v57
    v_cvt_pk_bf16_f32 v125, v58, v59
    v_cvt_pk_bf16_f32 v126, v60, v61
    v_cvt_pk_bf16_f32 v127, v62, v63
    v_permlane32_swap_b32 v96, v98
    v_permlane32_swap_b32 v97, v99
    v_permlane32_swap_b32 v100, v102
    v_permlane32_swap_b32 v101, v103
    v_permlane32_swap_b32 v104, v106
    v_permlane32_swap_b32 v105, v107
    v_permlane32_swap_b32 v108, v110
    v_permlane32_swap_b32 v109, v111
    v_permlane32_swap_b32 v112, v114
    v_permlane32_swap_b32 v113, v115
    v_permlane32_swap_b32 v116, v118
    v_permlane32_swap_b32 v117, v119
    v_permlane32_swap_b32 v120, v122
    v_permlane32_swap_b32 v121, v123
    v_permlane32_swap_b32 v124, v126
    v_permlane32_swap_b32 v125, v127
    v_permlane16_swap_b32 v96, v98
    v_permlane16_swap_b32 v97, v99
    v_permlane16_swap_b32 v100, v102
    v_permlane16_swap_b32 v101, v103
    v_permlane16_swap_b32 v104, v106
    v_permlane16_swap_b32 v105, v107
    v_permlane16_swap_b32 v108, v110
    v_permlane16_swap_b32 v109, v111
    v_permlane16_swap_b32 v112, v114
    v_permlane16_swap_b32 v113, v115
    v_permlane16_swap_b32 v116, v118
    v_permlane16_swap_b32 v117, v119
    v_permlane16_swap_b32 v120, v122
    v_permlane16_swap_b32 v121, v123
    v_permlane16_swap_b32 v124, v126
    v_permlane16_swap_b32 v125, v127
    v_mov_b64 v[0:1], 0
    v_mov_b64 v[2:3], 0
    v_mov_b64 v[4:5], 0
    v_mov_b64 v[6:7], 0
    v_mov_b64 v[8:9], 0
    v_mov_b64 v[10:11], 0
    v_mov_b64 v[12:13], 0
    v_mov_b64 v[14:15], 0
    v_mov_b64 v[16:17], 0
    v_mov_b64 v[18:19], 0
    v_mov_b64 v[20:21], 0
    v_mov_b64 v[22:23], 0
    v_mov_b64 v[24:25], 0
    v_mov_b64 v[26:27], 0
    v_mov_b64 v[28:29], 0
    v_mov_b64 v[30:31], 0
    v_mov_b64 v[220:221], 0
    v_mov_b64 v[222:223], 0
    v_mov_b32 v232, 0
    v_mov_b64 v[32:33], 0
    v_mov_b64 v[34:35], 0
    v_mov_b64 v[36:37], 0
    v_mov_b64 v[38:39], 0
    v_mov_b64 v[40:41], 0
    v_mov_b64 v[42:43], 0
    v_mov_b64 v[44:45], 0
    v_mov_b64 v[46:47], 0
    v_mov_b64 v[48:49], 0
    v_mov_b64 v[50:51], 0
    v_mov_b64 v[52:53], 0
    v_mov_b64 v[54:55], 0
    v_mov_b64 v[56:57], 0
    v_mov_b64 v[58:59], 0
    v_mov_b64 v[60:61], 0
    v_mov_b64 v[62:63], 0
    v_mov_b64 v[224:225], 0
    v_mov_b64 v[226:227], 0
    v_mov_b32 v233, 0
    v_mov_b64 v[212:213], 0
    v_mov_b64 v[214:215], 0
    s_add_u32 s37, s37, 8192
    s_mov_b32 s39, 33792
    s_mov_b32 s54, 67584
    s_mov_b32 s41, 0
    s_mov_b32 s40, 0
    s_mov_b32 s42, 0xbf800000
    s_mov_b32 s43, 0xff800000
    s_waitcnt lgkmcnt(0)
    s_mov_b32 s12, s4
    s_mov_b32 s13, s5
    s_mov_b32 s8, s6
    s_mov_b32 s9, s7
    s_barrier
wx_loop:
    s_barrier
    v_add_u32 v237, s40, v239
    v_mfma_f32_16x16x32_bf16 v[32:35], v[144:147], v[212:215], v[32:35]
    ds_read_b128 v[144:147], v237 offset:0
    v_mfma_f32_16x16x32_bf16 v[36:39], v[148:151], v[212:215], v[36:39]
    ds_read_b128 v[148:151], v237 offset:64
    v_mfma_f32_16x16x32_bf16 v[40:43], v[152:155], v[212:215], v[40:43]
    ds_read_b128 v[152:155], v237 offset:128
    v_mfma_f32_16x16x32_bf16 v[44:47], v[156:159], v[212:215], v[44:47]
    ds_read_b128 v[156:159], v237 offset:192
    v_mfma_f32_16x16x32_bf16 v[48:51], v[160:163], v[212:215], v[48:51]
    ds_read_b128 v[160:163], v237 offset:512
    v_mfma_f32_16x16x32_bf16 v[52:55], v[164:167], v[212:215], v[52:55]
    ds_read_b128 v[164:167], v237 offset:576
    v_mfma_f32_16x16x32_bf16 v[56:59], v[168:171], v[212:215], v[56:59]
    ds_read_b128 v[168:171], v237 offset:640
    v_mfma_f32_16x16x32_bf16 v[60:63], v[172:175], v[212:215], v[60:63]
    ds_read_b128 v[172:175], v237 offset:704
    s_waitcnt lgkmcnt(6)
    v_mfma_f32_16x16x32_bf16 v[176:179], v[144:147], v[96:99], v[220:223]
    v_mfma_f32_16x16x32_bf16 v[176:179], v[148:151], v[100:103], v[176:179]
    s_waitcnt lgkmcnt(4)
    v_mfma_f32_16x16x32_bf16 v[176:179], v[152:155], v[104:107], v[176:179]
    v_add_u32 v238, s40, v240
    v_mfma_f32_16x16x32_bf16 v[176:179], v[156:159], v[108:111], v[176:179]
    s_add_u32 s41, s41, 1
    s_waitcnt lgkmcnt(2)
    v_mfma_f32_16x16x32_bf16 v[180:183], v[160:163], v[96:99], v[220:223]
    s_add_u32 s40, s40, 33792
    v_mfma_f32_16x16x32_bf16 v[180:183], v[164:167], v[100:103], v[180:183]
    s_waitcnt lgkmcnt(0)
    v_mfma_f32_16x16x32_bf16 v[180:183], v[168:171], v[104:107], v[180:183]
    s_cmp_ge_u32 s40, 135168
    v_mfma_f32_16x16x32_bf16 v[180:183], v[172:175], v[108:111], v[180:183]
    s_cselect_b32 s40, 0, s40
    v_mfma_f32_16x16x32_bf16 v[184:187], v[144:147], v[112:115], v[224:227]
    ds_read_b64_tr_b16 v[144:145], v238 offset:0
    ds_read_b64_tr_b16 v[146:147], v238 offset:512
    v_exp_f32 v200, v176
    v_exp_f32 v201, v177
    v_mfma_f32_16x16x32_bf16 v[184:187], v[148:151], v[116:119], v[184:187]
    ds_read_b64_tr_b16 v[148:149], v238 offset:32
    ds_read_b64_tr_b16 v[150:151], v238 offset:544
    v_exp_f32 v202, v178
    v_exp_f32 v203, v179
    v_mfma_f32_16x16x32_bf16 v[184:187], v[152:155], v[120:123], v[184:187]
    ds_read_b64_tr_b16 v[152:153], v238 offset:64
    ds_read_b64_tr_b16 v[154:155], v238 offset:576
    v_add_f32 v235, v200, v201
    v_add_f32 v236, v202, v203
    v_cvt_pk_bf16_f32 v208, v200, v201
    v_cvt_pk_bf16_f32 v209, v202, v203
    v_mfma_f32_16x16x32_bf16 v[184:187], v[156:159], v[124:127], v[184:187]
    ds_read_b64_tr_b16 v[156:157], v238 offset:96
    ds_read_b64_tr_b16 v[158:159], v238 offset:608
    v_exp_f32 v204, v180
    v_exp_f32 v205, v181
    v_mfma_f32_16x16x32_bf16 v[188:191], v[160:163], v[112:115], v[224:227]
    ds_read_b64_tr_b16 v[160:161], v238 offset:128
    ds_read_b64_tr_b16 v[162:163], v238 offset:640
    v_add_f32 v235, v235, v236
    v_exp_f32 v206, v182
    v_add_f32 v236, v204, v205
    v_mfma_f32_16x16x32_bf16 v[188:191], v[164:167], v[116:119], v[188:191]
    ds_read_b64_tr_b16 v[164:165], v238 offset:160
    ds_read_b64_tr_b16 v[166:167], v238 offset:672
    v_exp_f32 v207, v183
    v_add_f32 v235, v235, v206
    v_add_f32 v236, v236, v207
    v_mfma_f32_16x16x32_bf16 v[188:191], v[168:171], v[120:123], v[188:191]
    ds_read_b64_tr_b16 v[168:169], v238 offset:192
    ds_read_b64_tr_b16 v[170:171], v238 offset:704
    v_cvt_pk_bf16_f32 v210, v204, v205
    v_add_f32 v235, v235, v236
    v_cvt_pk_bf16_f32 v211, v206, v207
    v_cmp_nge_f32 vcc, s42, v235
    v_mfma_f32_16x16x32_bf16 v[188:191], v[172:175], v[124:127], v[188:191]
    ds_read_b64_tr_b16 v[172:173], v238 offset:224
    ds_read_b64_tr_b16 v[174:175], v238 offset:736
    s_cbranch_vccnz wx_rare0
wx_back0:
    v_add_f32 v232, v232, v235
    s_waitcnt lgkmcnt(12)
    v_mfma_f32_16x16x32_bf16 v[0:3], v[144:147], v[208:211], v[0:3]
    v_exp_f32 v200, v184
    v_exp_f32 v201, v185
    v_mfma_f32_16x16x32_bf16 v[4:7], v[148:151], v[208:211], v[4:7]
    v_exp_f32 v202, v186
    v_exp_f32 v203, v187
    s_waitcnt lgkmcnt(8)
    v_mfma_f32_16x16x32_bf16 v[8:11], v[152:155], v[208:211], v[8:11]
    v_add_f32 v242, v200, v201
    v_add_f32 v236, v202, v203
    v_cvt_pk_bf16_f32 v212, v200, v201
    v_cvt_pk_bf16_f32 v213, v202, v203
    v_mfma_f32_16x16x32_bf16 v[12:15], v[156:159], v[208:211], v[12:15]
    v_exp_f32 v204, v188
    v_exp_f32 v205, v189
    s_waitcnt lgkmcnt(4)
    v_mfma_f32_16x16x32_bf16 v[16:19], v[160:163], v[208:211], v[16:19]
    v_add_f32 v242, v242, v236
    v_exp_f32 v206, v190
    v_add_f32 v236, v204, v205
    v_mfma_f32_16x16x32_bf16 v[20:23], v[164:167], v[208:211], v[20:23]
    v_exp_f32 v207, v191
    v_add_f32 v242, v242, v206
    v_add_f32 v236, v236, v207
    s_waitcnt lgkmcnt(0)
    v_mfma_f32_16x16x32_bf16 v[24:27], v[168:171], v[208:211], v[24:27]
    v_cvt_pk_bf16_f32 v214, v204, v205
    v_add_f32 v242, v242, v236
    v_cvt_pk_bf16_f32 v215, v206, v207
    v_cmp_nge_f32 vcc, s42, v242
    v_mfma_f32_16x16x32_bf16 v[28:31], v[172:175], v[208:211], v[28:31]
    s_cbranch_vccnz wx_rare1
wx_back1:
    v_add_f32 v233, v233, v242
    s_cmp_lt_u32 s41, 30
    s_waitcnt lgkmcnt(0)
    s_cbranch_scc1 wx_loop
    s_cmp_lt_u32 s30, 2
    s_cbranch_scc1 wx_pa
    s_add_u32 m0, s76, s78
    s_nop 0
    buffer_load_dwordx4 v244, s[12:15], s77 offen lds
wx_pa:
    s_add_u32 m0, s76, s79
    s_nop 0
    buffer_load_dwordx4 v245, s[12:15], s77 offen lds
    s_add_u32 m0, s76, s80
    s_nop 0
    buffer_load_dwordx4 v246, s[12:15], s77 offen lds
    s_add_u32 s76, s76, 19456
    s_add_u32 s77, s77, 73728
    s_cmp_lg_u32 s41, 31
    s_cbranch_scc1 wx_pf1
    s_cmp_lt_u32 s30, 2
    s_cbranch_scc1 wx_pb
    s_add_u32 m0, s76, s78
    s_nop 0
    buffer_load_dwordx4 v244, s[12:15], s77 offen lds
wx_pb:
    s_add_u32 m0, s76, s79
    s_nop 0
    buffer_load_dwordx4 v245, s[12:15], s77 offen lds
    s_add_u32 m0, s76, s80
    s_nop 0
    buffer_load_dwordx4 v246, s[12:15], s77 offen lds
    s_add_u32 s76, s76, 19456
    s_add_u32 s77, s77, 73728
wx_pf1:
    s_cmp_lt_u32 s41, 32
    s_cbranch_scc1 wx_loop
    v_mfma_f32_16x16x32_bf16 v[32:35], v[144:147], v[212:215], v[32:35]
    v_mfma_f32_16x16x32_bf16 v[36:39], v[148:151], v[212:215], v[36:39]
    v_mfma_f32_16x16x32_bf16 v[40:43], v[152:155], v[212:215], v[40:43]
    v_mfma_f32_16x16x32_bf16 v[44:47], v[156:159], v[212:215], v[44:47]
    v_mfma_f32_16x16x32_bf16 v[48:51], v[160:163], v[212:215], v[48:51]
    v_mfma_f32_16x16x32_bf16 v[52:55], v[164:167], v[212:215], v[52:55]
    v_mfma_f32_16x16x32_bf16 v[56:59], v[168:171], v[212:215], v[56:59]
    v_mfma_f32_16x16x32_bf16 v[60:63], v[172:175], v[212:215], v[60:63]
    v_mov_b32 v252, v232
    s_nop 1
    v_permlane32_swap_b32 v232, v252
    v_add_f32 v232, v232, v252
    v_mov_b32 v252, v232
    s_nop 1
    v_permlane16_swap_b32 v232, v252
    v_add_f32 v232, v232, v252
    v_rcp_f32 v232, v232
    v_mov_b32 v252, v233
    s_nop 1
    v_permlane32_swap_b32 v233, v252
    v_add_f32 v233, v233, v252
    v_mov_b32 v252, v233
    s_nop 1
    v_permlane16_swap_b32 v233, v252
    v_add_f32 v233, v233, v252
    v_rcp_f32 v233, v233
    s_mul_i32 s44, s32, 38912
    s_add_u32 s44, s44, 77824
    s_lshl_b32 s45, s36, 11
    s_add_u32 s44, s44, s45
    v_add_u32 v253, s44, v254
    v_mov_b32 v176, v232
    v_pk_mul_f32 v[0:1], v[0:1], v[176:177] op_sel_hi:[1,0]
    v_pk_mul_f32 v[2:3], v[2:3], v[176:177] op_sel_hi:[1,0]
    v_pk_mul_f32 v[4:5], v[4:5], v[176:177] op_sel_hi:[1,0]
    v_pk_mul_f32 v[6:7], v[6:7], v[176:177] op_sel_hi:[1,0]
    v_pk_mul_f32 v[8:9], v[8:9], v[176:177] op_sel_hi:[1,0]
    v_pk_mul_f32 v[10:11], v[10:11], v[176:177] op_sel_hi:[1,0]
    v_pk_mul_f32 v[12:13], v[12:13], v[176:177] op_sel_hi:[1,0]
    v_pk_mul_f32 v[14:15], v[14:15], v[176:177] op_sel_hi:[1,0]
    v_pk_mul_f32 v[16:17], v[16:17], v[176:177] op_sel_hi:[1,0]
    v_pk_mul_f32 v[18:19], v[18:19], v[176:177] op_sel_hi:[1,0]
    v_pk_mul_f32 v[20:21], v[20:21], v[176:177] op_sel_hi:[1,0]
    v_pk_mul_f32 v[22:23], v[22:23], v[176:177] op_sel_hi:[1,0]
    v_pk_mul_f32 v[24:25], v[24:25], v[176:177] op_sel_hi:[1,0]
    v_pk_mul_f32 v[26:27], v[26:27], v[176:177] op_sel_hi:[1,0]
    v_pk_mul_f32 v[28:29], v[28:29], v[176:177] op_sel_hi:[1,0]
    v_pk_mul_f32 v[30:31], v[30:31], v[176:177] op_sel_hi:[1,0]
    v_cvt_pk_bf16_f32 v96, v0, v1
    v_cvt_pk_bf16_f32 v97, v2, v3
    v_cvt_pk_bf16_f32 v98, v4, v5
    v_cvt_pk_bf16_f32 v99, v6, v7
    v_cvt_pk_bf16_f32 v100, v8, v9
    v_cvt_pk_bf16_f32 v101, v10, v11
    v_cvt_pk_bf16_f32 v102, v12, v13
    v_cvt_pk_bf16_f32 v103, v14, v15
    v_cvt_pk_bf16_f32 v104, v16, v17
    v_cvt_pk_bf16_f32 v105, v18, v19
    v_cvt_pk_bf16_f32 v106, v20, v21
    v_cvt_pk_bf16_f32 v107, v22, v23
    v_cvt_pk_bf16_f32 v108, v24, v25
    v_cvt_pk_bf16_f32 v109, v26, v27
    v_cvt_pk_bf16_f32 v110, v28, v29
    v_cvt_pk_bf16_f32 v111, v30, v31
    s_add_u32 s44, s86, 18432
    buffer_store_dwordx4 v[96:99], v254, s[20:23], s86 offen offset:0 sc1
    buffer_store_dwordx4 v[100:103], v254, s[20:23], s86 offen offset:1024 sc1
    buffer_store_dwordx4 v[104:107], v254, s[20:23], s44 offen offset:0 sc1
    buffer_store_dwordx4 v[108:111], v254, s[20:23], s44 offen offset:1024 sc1
    s_add_u32 s86, s86, 2048
    v_mov_b32 v176, v233
    v_pk_mul_f32 v[32:33], v[32:33], v[176:177] op_sel_hi:[1,0]
    v_pk_mul_f32 v[34:35], v[34:35], v[176:177] op_sel_hi:[1,0]
    v_pk_mul_f32 v[36:37], v[36:37], v[176:177] op_sel_hi:[1,0]
    v_pk_mul_f32 v[38:39], v[38:39], v[176:177] op_sel_hi:[1,0]
    v_pk_mul_f32 v[40:41], v[40:41], v[176:177] op_sel_hi:[1,0]
    v_pk_mul_f32 v[42:43], v[42:43], v[176:177] op_sel_hi:[1,0]
    v_pk_mul_f32 v[44:45], v[44:45], v[176:177] op_sel_hi:[1,0]
    v_pk_mul_f32 v[46:47], v[46:47], v[176:177] op_sel_hi:[1,0]
    v_pk_mul_f32 v[48:49], v[48:49], v[176:177] op_sel_hi:[1,0]
    v_pk_mul_f32 v[50:51], v[50:51], v[176:177] op_sel_hi:[1,0]
    v_pk_mul_f32 v[52:53], v[52:53], v[176:177] op_sel_hi:[1,0]
    v_pk_mul_f32 v[54:55], v[54:55], v[176:177] op_sel_hi:[1,0]
    v_pk_mul_f32 v[56:57], v[56:57], v[176:177] op_sel_hi:[1,0]
    v_pk_mul_f32 v[58:59], v[58:59], v[176:177] op_sel_hi:[1,0]
    v_pk_mul_f32 v[60:61], v[60:61], v[176:177] op_sel_hi:[1,0]
    v_pk_mul_f32 v[62:63], v[62:63], v[176:177] op_sel_hi:[1,0]
    v_cvt_pk_bf16_f32 v112, v32, v33
    v_cvt_pk_bf16_f32 v113, v34, v35
    v_cvt_pk_bf16_f32 v114, v36, v37
    v_cvt_pk_bf16_f32 v115, v38, v39
    v_cvt_pk_bf16_f32 v116, v40, v41
    v_cvt_pk_bf16_f32 v117, v42, v43
    v_cvt_pk_bf16_f32 v118, v44, v45
    v_cvt_pk_bf16_f32 v119, v46, v47
    v_cvt_pk_bf16_f32 v120, v48, v49
    v_cvt_pk_bf16_f32 v121, v50, v51
    v_cvt_pk_bf16_f32 v122, v52, v53
    v_cvt_pk_bf16_f32 v123, v54, v55
    v_cvt_pk_bf16_f32 v124, v56, v57
    v_cvt_pk_bf16_f32 v125, v58, v59
    v_cvt_pk_bf16_f32 v126, v60, v61
    v_cvt_pk_bf16_f32 v127, v62, v63
    s_add_u32 s44, s86, 18432
    buffer_store_dwordx4 v[112:115], v254, s[20:23], s86 offen offset:0 sc1
    buffer_store_dwordx4 v[116:119], v254, s[20:23], s86 offen offset:1024 sc1
    buffer_store_dwordx4 v[120:123], v254, s[20:23], s44 offen offset:0 sc1
    buffer_store_dwordx4 v[124:127], v254, s[20:23], s44 offen offset:1024 sc1
    s_barrier
    ds_write_b128 v253, v[96:99] offset:0
    ds_write_b128 v253, v[100:103] offset:1024
    ds_write_b128 v253, v[104:107] offset:19456
    ds_write_b128 v253, v[108:111] offset:20480
    ds_write_b128 v253, v[112:115] offset:2048
    ds_write_b128 v253, v[116:119] offset:3072
    ds_write_b128 v253, v[120:123] offset:21504
    ds_write_b128 v253, v[124:127] offset:22528
    s_waitcnt vmcnt(8)
    s_branch op_entry
wx_rare0:
    s_nop 7
    v_max3_f32 v251, v176, v177, v178
    v_max3_f32 v251, v251, v179, v180
    v_max3_f32 v251, v251, v181, v182
    v_max_f32 v251, v251, v183
    v_mov_b32 v252, v251
    s_nop 1
    v_permlane32_swap_b32 v251, v252
    v_max_f32 v251, v251, v252
    v_mov_b32 v252, v251
    s_nop 1
    v_permlane16_swap_b32 v251, v252
    v_max_f32 v251, v251, v252
    v_max_f32 v251, s43, v251
    v_max_f32 v252, 0, v251
    v_exp_f32_e64 v252, -v252
    v_sub_f32 v220, v220, v251
    v_sub_f32 v221, v221, v251
    v_sub_f32 v222, v222, v251
    v_sub_f32 v223, v223, v251
    v_mul_f32 v232, v232, v252
    v_mul_f32 v0, v0, v252
    v_mul_f32 v1, v1, v252
    v_mul_f32 v2, v2, v252
    v_mul_f32 v3, v3, v252
    v_mul_f32 v4, v4, v252
    v_mul_f32 v5, v5, v252
    v_mul_f32 v6, v6, v252
    v_mul_f32 v7, v7, v252
    v_mul_f32 v8, v8, v252
    v_mul_f32 v9, v9, v252
    v_mul_f32 v10, v10, v252
    v_mul_f32 v11, v11, v252
    v_mul_f32 v12, v12, v252
    v_mul_f32 v13, v13, v252
    v_mul_f32 v14, v14, v252
    v_mul_f32 v15, v15, v252
    v_mul_f32 v16, v16, v252
    v_mul_f32 v17, v17, v252
    v_mul_f32 v18, v18, v252
    v_mul_f32 v19, v19, v252
    v_mul_f32 v20, v20, v252
    v_mul_f32 v21, v21, v252
    v_mul_f32 v22, v22, v252
    v_mul_f32 v23, v23, v252
    v_mul_f32 v24, v24, v252
    v_mul_f32 v25, v25, v252
    v_mul_f32 v26, v26, v252
    v_mul_f32 v27, v27, v252
    v_mul_f32 v28, v28, v252
    v_mul_f32 v29, v29, v252
    v_mul_f32 v30, v30, v252
    v_mul_f32 v31, v31, v252
    v_sub_f32 v176, v176, v251
    v_sub_f32 v177, v177, v251
    v_sub_f32 v178, v178, v251
    v_sub_f32 v179, v179, v251
    v_sub_f32 v180, v180, v251
    v_sub_f32 v181, v181, v251
    v_sub_f32 v182, v182, v251
    v_sub_f32 v183, v183, v251
    v_exp_f32 v176, v176
    v_exp_f32 v177, v177
    v_exp_f32 v178, v178
    v_exp_f32 v179, v179
    v_exp_f32 v180, v180
    v_exp_f32 v181, v181
    v_exp_f32 v182, v182
    v_exp_f32 v183, v183
    v_add_f32 v235, v176, v177
    v_add_f32 v235, v235, v178
    v_add_f32 v235, v235, v179
    v_add_f32 v235, v235, v180
    v_add_f32 v235, v235, v181
    v_add_f32 v235, v235, v182
    v_add_f32 v235, v235, v183
    v_cvt_pk_bf16_f32 v208, v176, v177
    v_cvt_pk_bf16_f32 v209, v178, v179
    v_cvt_pk_bf16_f32 v210, v180, v181
    v_cvt_pk_bf16_f32 v211, v182, v183
    s_nop 1
    s_branch wx_back0
wx_rare1:
    s_nop 7
    v_max3_f32 v251, v184, v185, v186
    v_max3_f32 v251, v251, v187, v188
    v_max3_f32 v251, v251, v189, v190
    v_max_f32 v251, v251, v191
    v_mov_b32 v252, v251
    s_nop 1
    v_permlane32_swap_b32 v251, v252
    v_max_f32 v251, v251, v252
    v_mov_b32 v252, v251
    s_nop 1
    v_permlane16_swap_b32 v251, v252
    v_max_f32 v251, v251, v252
    v_max_f32 v251, s43, v251
    v_max_f32 v252, 0, v251
    v_exp_f32_e64 v252, -v252
    v_sub_f32 v224, v224, v251
    v_sub_f32 v225, v225, v251
    v_sub_f32 v226, v226, v251
    v_sub_f32 v227, v227, v251
    v_mul_f32 v233, v233, v252
    v_mul_f32 v32, v32, v252
    v_mul_f32 v33, v33, v252
    v_mul_f32 v34, v34, v252
    v_mul_f32 v35, v35, v252
    v_mul_f32 v36, v36, v252
    v_mul_f32 v37, v37, v252
    v_mul_f32 v38, v38, v252
    v_mul_f32 v39, v39, v252
    v_mul_f32 v40, v40, v252
    v_mul_f32 v41, v41, v252
    v_mul_f32 v42, v42, v252
    v_mul_f32 v43, v43, v252
    v_mul_f32 v44, v44, v252
    v_mul_f32 v45, v45, v252
    v_mul_f32 v46, v46, v252
    v_mul_f32 v47, v47, v252
    v_mul_f32 v48, v48, v252
    v_mul_f32 v49, v49, v252
    v_mul_f32 v50, v50, v252
    v_mul_f32 v51, v51, v252
    v_mul_f32 v52, v52, v252
    v_mul_f32 v53, v53, v252
    v_mul_f32 v54, v54, v252
    v_mul_f32 v55, v55, v252
    v_mul_f32 v56, v56, v252
    v_mul_f32 v57, v57, v252
    v_mul_f32 v58, v58, v252
    v_mul_f32 v59, v59, v252
    v_mul_f32 v60, v60, v252
    v_mul_f32 v61, v61, v252
    v_mul_f32 v62, v62, v252
    v_mul_f32 v63, v63, v252
    v_sub_f32 v184, v184, v251
    v_sub_f32 v185, v185, v251
    v_sub_f32 v186, v186, v251
    v_sub_f32 v187, v187, v251
    v_sub_f32 v188, v188, v251
    v_sub_f32 v189, v189, v251
    v_sub_f32 v190, v190, v251
    v_sub_f32 v191, v191, v251
    v_exp_f32 v184, v184
    v_exp_f32 v185, v185
    v_exp_f32 v186, v186
    v_exp_f32 v187, v187
    v_exp_f32 v188, v188
    v_exp_f32 v189, v189
    v_exp_f32 v190, v190
    v_exp_f32 v191, v191
    v_add_f32 v242, v184, v185
    v_add_f32 v242, v242, v186
    v_add_f32 v242, v242, v187
    v_add_f32 v242, v242, v188
    v_add_f32 v242, v242, v189
    v_add_f32 v242, v242, v190
    v_add_f32 v242, v242, v191
    v_cvt_pk_bf16_f32 v212, v184, v185
    v_cvt_pk_bf16_f32 v213, v186, v187
    v_cvt_pk_bf16_f32 v214, v188, v189
    v_cvt_pk_bf16_f32 v215, v190, v191
    s_mov_b32 s42, 0x43800000
    s_mov_b32 s43, 0
    s_nop 1
    s_branch wx_back1
attn_wl:
    s_waitcnt vmcnt(9)
    s_barrier
    v_add_u32 v245, 95488, v242
    v_add_u32 v246, 25344, v243
    v_subrev_u32 v200, s34, v246
    v_mfma_f32_16x16x32_bf16 v[16:19], v[160:163], v[108:111], v[16:19]
    ds_read_b64_tr_b16 v[144:145], v245 offset:0
    ds_read_b64_tr_b16 v[146:147], v245 offset:512
    v_mfma_f32_16x16x32_bf16 v[48:51], v[160:163], v[112:115], v[48:51]
    ds_read_b128 v[96:99], v246 offset:0
    s_cmp_ge_u32 s52, 7
    v_mfma_f32_16x16x32_bf16 v[20:23], v[164:167], v[108:111], v[20:23]
    ds_read_b128 v[100:103], v246 offset:2048
    ds_read_b128 v[104:107], v200
    v_mfma_f32_16x16x32_bf16 v[52:55], v[164:167], v[112:115], v[52:55]
    ds_read_b64_tr_b16 v[148:149], v245 offset:32
    s_cselect_b32 s44, s49, s48
    v_mfma_f32_16x16x32_bf16 v[24:27], v[168:171], v[108:111], v[24:27]
    ds_read_b64_tr_b16 v[150:151], v245 offset:544
    ds_read_b64_tr_b16 v[152:153], v245 offset:64
    v_mfma_f32_16x16x32_bf16 v[56:59], v[168:171], v[112:115], v[56:59]
    ds_read_b64_tr_b16 v[154:155], v245 offset:576
    s_add_u32 m0, s58, 60416
    v_mfma_f32_16x16x32_bf16 v[88:91], v[168:171], v[116:119], v[88:91]
    ds_read_b64_tr_b16 v[156:157], v245 offset:96
    ds_read_b64_tr_b16 v[158:159], v245 offset:608
    v_mfma_f32_16x16x32_bf16 v[28:31], v[172:175], v[108:111], v[28:31]
    s_add_u32 s44, s44, 1048576
    buffer_load_dwordx4 v248, s[12:15], s44 offen lds
    v_mfma_f32_16x16x32_bf16 v[60:63], v[172:175], v[112:115], v[60:63]
    s_add_u32 s44, s44, 130048
    buffer_load_dwordx4 v248, s[12:15], s44 offen offset:1024 lds
    v_mfma_f32_16x16x32_bf16 v[92:95], v[172:175], v[116:119], v[92:95]
    s_cmp_ge_u32 s52, 7
    s_cselect_b32 s45, s51, s50
    s_waitcnt lgkmcnt(4)
    v_mfma_f32_16x16x32_bf16 v[0:3], v[144:147], v[96:99], v[0:3]
    ds_read_b64_tr_b16 v[160:161], v245 offset:128
    s_add_u32 m0, s59, 128768
    v_mfma_f32_16x16x32_bf16 v[32:35], v[144:147], v[100:103], v[32:35]
    ds_read_b64_tr_b16 v[162:163], v245 offset:640
    ds_read_b64_tr_b16 v[164:165], v245 offset:160
    v_mfma_f32_16x16x32_bf16 v[4:7], v[148:151], v[96:99], v[4:7]
    ds_read_b64_tr_b16 v[166:167], v245 offset:672
    s_add_u32 s45, s45, 256
    v_mfma_f32_16x16x32_bf16 v[36:39], v[148:151], v[100:103], v[36:39]
    ds_read_b64_tr_b16 v[168:169], v245 offset:192
    buffer_load_dwordx4 v247, s[8:11], s45 offen lds
    s_waitcnt lgkmcnt(5)
    v_mfma_f32_16x16x32_bf16 v[8:11], v[152:155], v[96:99], v[8:11]
    ds_read_b64_tr_b16 v[170:171], v245 offset:704
    ds_read_b64_tr_b16 v[172:173], v245 offset:224
    v_mfma_f32_16x16x32_bf16 v[40:43], v[152:155], v[100:103], v[40:43]
    ds_read_b64_tr_b16 v[174:175], v245 offset:736
    s_add_u32 m0, s59, 136960
    v_mfma_f32_16x16x32_bf16 v[12:15], v[156:159], v[96:99], v[12:15]
    s_add_u32 s44, s45, 73728
    buffer_load_dwordx4 v247, s[8:11], s44 offen lds
    v_mfma_f32_16x16x32_bf16 v[44:47], v[156:159], v[100:103], v[44:47]
    s_add_u32 m0, s53, 128768
    s_add_u32 s45, s45, s83
    s_waitcnt lgkmcnt(0)
    s_waitcnt vmcnt(11)
    s_barrier
    v_add_u32 v245, 112128, v242
    v_add_u32 v246, 25344, v244
    v_subrev_u32 v200, s34, v246
    v_mfma_f32_16x16x32_bf16 v[16:19], v[160:163], v[96:99], v[16:19]
    ds_read_b64_tr_b16 v[144:145], v245 offset:0
    ds_read_b64_tr_b16 v[146:147], v245 offset:512
    v_mfma_f32_16x16x32_bf16 v[48:51], v[160:163], v[100:103], v[48:51]
    ds_read_b128 v[108:111], v246 offset:0
    v_mfma_f32_16x16x32_bf16 v[20:23], v[164:167], v[96:99], v[20:23]
    ds_read_b128 v[112:115], v246 offset:2048
    ds_read_b128 v[116:119], v200
    v_mfma_f32_16x16x32_bf16 v[52:55], v[164:167], v[100:103], v[52:55]
    ds_read_b64_tr_b16 v[148:149], v245 offset:32
    v_mfma_f32_16x16x32_bf16 v[24:27], v[168:171], v[96:99], v[24:27]
    ds_read_b64_tr_b16 v[150:151], v245 offset:544
    ds_read_b64_tr_b16 v[152:153], v245 offset:64
    v_mfma_f32_16x16x32_bf16 v[56:59], v[168:171], v[100:103], v[56:59]
    ds_read_b64_tr_b16 v[154:155], v245 offset:576
    v_mfma_f32_16x16x32_bf16 v[88:91], v[168:171], v[104:107], v[88:91]
    ds_read_b64_tr_b16 v[156:157], v245 offset:96
    ds_read_b64_tr_b16 v[158:159], v245 offset:608
    v_mfma_f32_16x16x32_bf16 v[28:31], v[172:175], v[96:99], v[28:31]
    s_cmp_ge_u32 s52, 7
    v_mfma_f32_16x16x32_bf16 v[60:63], v[172:175], v[100:103], v[60:63]
    s_cselect_b32 s44, s49, s48
    v_mfma_f32_16x16x32_bf16 v[92:95], v[172:175], v[104:107], v[92:95]
    s_add_u32 m0, s58, 95488
    s_waitcnt lgkmcnt(4)
    v_mfma_f32_16x16x32_bf16 v[0:3], v[144:147], v[108:111], v[0:3]
    ds_read_b64_tr_b16 v[160:161], v245 offset:128
    s_add_u32 s44, s44, 1310720
    v_mfma_f32_16x16x32_bf16 v[32:35], v[144:147], v[112:115], v[32:35]
    ds_read_b64_tr_b16 v[162:163], v245 offset:640
    ds_read_b64_tr_b16 v[164:165], v245 offset:160
    v_mfma_f32_16x16x32_bf16 v[4:7], v[148:151], v[108:111], v[4:7]
    ds_read_b64_tr_b16 v[166:167], v245 offset:672
    v_mfma_f32_16x16x32_bf16 v[36:39], v[148:151], v[112:115], v[36:39]
    ds_read_b64_tr_b16 v[168:169], v245 offset:192
    s_waitcnt lgkmcnt(5)
    v_mfma_f32_16x16x32_bf16 v[8:11], v[152:155], v[108:111], v[8:11]
    ds_read_b64_tr_b16 v[170:171], v245 offset:704
    ds_read_b64_tr_b16 v[172:173], v245 offset:224
    v_mfma_f32_16x16x32_bf16 v[40:43], v[152:155], v[112:115], v[40:43]
    ds_read_b64_tr_b16 v[174:175], v245 offset:736
    v_mfma_f32_16x16x32_bf16 v[12:15], v[156:159], v[108:111], v[12:15]
    buffer_load_dwordx4 v248, s[12:15], s44 offen lds
    s_add_u32 s44, s44, 130048
    v_mfma_f32_16x16x32_bf16 v[44:47], v[156:159], v[112:115], v[44:47]
    buffer_load_dwordx4 v248, s[12:15], s44 offen offset:1024 lds
    s_waitcnt lgkmcnt(0)
    s_waitcnt vmcnt(8)
    s_barrier
    v_add_u32 v245, 147200, v242
    v_add_u32 v246, 77056, v243
    v_subrev_u32 v200, s34, v246
    v_mfma_f32_16x16x32_bf16 v[16:19], v[160:163], v[108:111], v[16:19]
    ds_read_b64_tr_b16 v[144:145], v245 offset:0
    ds_read_b64_tr_b16 v[146:147], v245 offset:512
    v_mfma_f32_16x16x32_bf16 v[48:51], v[160:163], v[112:115], v[48:51]
    ds_read_b128 v[96:99], v246 offset:0
    s_cmp_ge_u32 s52, 6
    v_mfma_f32_16x16x32_bf16 v[20:23], v[164:167], v[108:111], v[20:23]
    ds_read_b128 v[100:103], v246 offset:2048
    ds_read_b128 v[104:107], v200
    v_mfma_f32_16x16x32_bf16 v[52:55], v[164:167], v[112:115], v[52:55]
    ds_read_b64_tr_b16 v[148:149], v245 offset:32
    s_cselect_b32 s44, s49, s48
    v_mfma_f32_16x16x32_bf16 v[24:27], v[168:171], v[108:111], v[24:27]
    ds_read_b64_tr_b16 v[150:151], v245 offset:544
    ds_read_b64_tr_b16 v[152:153], v245 offset:64
    v_mfma_f32_16x16x32_bf16 v[56:59], v[168:171], v[112:115], v[56:59]
    ds_read_b64_tr_b16 v[154:155], v245 offset:576
    s_add_u32 m0, s58, 112128
    v_mfma_f32_16x16x32_bf16 v[88:91], v[168:171], v[116:119], v[88:91]
    ds_read_b64_tr_b16 v[156:157], v245 offset:96
    ds_read_b64_tr_b16 v[158:159], v245 offset:608
    v_mfma_f32_16x16x32_bf16 v[28:31], v[172:175], v[108:111], v[28:31]
    s_add_u32 s44, s44, 1572864
    buffer_load_dwordx4 v248, s[12:15], s44 offen lds
    v_mfma_f32_16x16x32_bf16 v[60:63], v[172:175], v[112:115], v[60:63]
    s_add_u32 s44, s44, 130048
    buffer_load_dwordx4 v248, s[12:15], s44 offen offset:1024 lds
    v_mfma_f32_16x16x32_bf16 v[92:95], v[172:175], v[116:119], v[92:95]
    s_cmp_ge_u32 s52, 6
    s_cselect_b32 s45, s51, s50
    s_waitcnt lgkmcnt(4)
    v_mfma_f32_16x16x32_bf16 v[0:3], v[144:147], v[96:99], v[0:3]
    ds_read_b64_tr_b16 v[160:161], v245 offset:128
    s_add_u32 m0, s59, 25344
    v_mfma_f32_16x16x32_bf16 v[32:35], v[144:147], v[100:103], v[32:35]
    ds_read_b64_tr_b16 v[162:163], v245 offset:640
    ds_read_b64_tr_b16 v[164:165], v245 offset:160
    v_mfma_f32_16x16x32_bf16 v[4:7], v[148:151], v[96:99], v[4:7]
    ds_read_b64_tr_b16 v[166:167], v245 offset:672
    s_add_u32 s45, s45, 384
    v_mfma_f32_16x16x32_bf16 v[36:39], v[148:151], v[100:103], v[36:39]
    ds_read_b64_tr_b16 v[168:169], v245 offset:192
    buffer_load_dwordx4 v247, s[8:11], s45 offen lds
    s_waitcnt lgkmcnt(5)
    v_mfma_f32_16x16x32_bf16 v[8:11], v[152:155], v[96:99], v[8:11]
    ds_read_b64_tr_b16 v[170:171], v245 offset:704
    ds_read_b64_tr_b16 v[172:173], v245 offset:224
    v_mfma_f32_16x16x32_bf16 v[40:43], v[152:155], v[100:103], v[40:43]
    ds_read_b64_tr_b16 v[174:175], v245 offset:736
    s_add_u32 m0, s59, 33536
    v_mfma_f32_16x16x32_bf16 v[12:15], v[156:159], v[96:99], v[12:15]
    s_add_u32 s44, s45, 73728
    buffer_load_dwordx4 v247, s[8:11], s44 offen lds
    v_mfma_f32_16x16x32_bf16 v[44:47], v[156:159], v[100:103], v[44:47]
    s_add_u32 m0, s53, 25344
    s_add_u32 s45, s45, s83
    s_waitcnt lgkmcnt(0)
    s_waitcnt vmcnt(10)
    s_barrier
    v_add_u32 v245, 43776, v242
    v_add_u32 v246, 77056, v244
    v_subrev_u32 v200, s34, v246
    v_mfma_f32_16x16x32_bf16 v[16:19], v[160:163], v[96:99], v[16:19]
    ds_read_b64_tr_b16 v[144:145], v245 offset:0
    ds_read_b64_tr_b16 v[146:147], v245 offset:512
    v_mfma_f32_16x16x32_bf16 v[48:51], v[160:163], v[100:103], v[48:51]
    ds_read_b128 v[108:111], v246 offset:0
    v_mfma_f32_16x16x32_bf16 v[20:23], v[164:167], v[96:99], v[20:23]
    ds_read_b128 v[112:115], v246 offset:2048
    ds_read_b128 v[116:119], v200
    v_mfma_f32_16x16x32_bf16 v[52:55], v[164:167], v[100:103], v[52:55]
    ds_read_b64_tr_b16 v[148:149], v245 offset:32
    v_mfma_f32_16x16x32_bf16 v[24:27], v[168:171], v[96:99], v[24:27]
    ds_read_b64_tr_b16 v[150:151], v245 offset:544
    ds_read_b64_tr_b16 v[152:153], v245 offset:64
    v_mfma_f32_16x16x32_bf16 v[56:59], v[168:171], v[100:103], v[56:59]
    ds_read_b64_tr_b16 v[154:155], v245 offset:576
    v_mfma_f32_16x16x32_bf16 v[88:91], v[168:171], v[104:107], v[88:91]
    ds_read_b64_tr_b16 v[156:157], v245 offset:96
    ds_read_b64_tr_b16 v[158:159], v245 offset:608
    v_mfma_f32_16x16x32_bf16 v[28:31], v[172:175], v[96:99], v[28:31]
    s_cmp_ge_u32 s52, 6
    v_mfma_f32_16x16x32_bf16 v[60:63], v[172:175], v[100:103], v[60:63]
    s_cselect_b32 s44, s49, s48
    v_mfma_f32_16x16x32_bf16 v[92:95], v[172:175], v[104:107], v[92:95]
    s_add_u32 m0, s58, 147200
    s_waitcnt lgkmcnt(4)
    v_mfma_f32_16x16x32_bf16 v[0:3], v[144:147], v[108:111], v[0:3]
    ds_read_b64_tr_b16 v[160:161], v245 offset:128
    s_add_u32 s44, s44, 1835008
    v_mfma_f32_16x16x32_bf16 v[32:35], v[144:147], v[112:115], v[32:35]
    ds_read_b64_tr_b16 v[162:163], v245 offset:640
    ds_read_b64_tr_b16 v[164:165], v245 offset:160
    v_mfma_f32_16x16x32_bf16 v[4:7], v[148:151], v[108:111], v[4:7]
    ds_read_b64_tr_b16 v[166:167], v245 offset:672
    v_mfma_f32_16x16x32_bf16 v[36:39], v[148:151], v[112:115], v[36:39]
    ds_read_b64_tr_b16 v[168:169], v245 offset:192
    s_waitcnt lgkmcnt(5)
    v_mfma_f32_16x16x32_bf16 v[8:11], v[152:155], v[108:111], v[8:11]
    ds_read_b64_tr_b16 v[170:171], v245 offset:704
    ds_read_b64_tr_b16 v[172:173], v245 offset:224
    v_mfma_f32_16x16x32_bf16 v[40:43], v[152:155], v[112:115], v[40:43]
    ds_read_b64_tr_b16 v[174:175], v245 offset:736
    v_mfma_f32_16x16x32_bf16 v[12:15], v[156:159], v[108:111], v[12:15]
    buffer_load_dwordx4 v248, s[12:15], s44 offen lds
    s_add_u32 s44, s44, 130048
    v_mfma_f32_16x16x32_bf16 v[44:47], v[156:159], v[112:115], v[44:47]
    buffer_load_dwordx4 v248, s[12:15], s44 offen offset:1024 lds
    s_waitcnt lgkmcnt(0)
    s_waitcnt vmcnt(8)
    s_barrier
    v_add_u32 v245, 60416, v242
    v_add_u32 v246, 128768, v243
    v_subrev_u32 v200, s34, v246
    v_mfma_f32_16x16x32_bf16 v[16:19], v[160:163], v[108:111], v[16:19]
    ds_read_b64_tr_b16 v[144:145], v245 offset:0
    ds_read_b64_tr_b16 v[146:147], v245 offset:512
    v_mfma_f32_16x16x32_bf16 v[48:51], v[160:163], v[112:115], v[48:51]
    ds_read_b128 v[96:99], v246 offset:0
    s_cmp_ge_u32 s52, 5
    v_mfma_f32_16x16x32_bf16 v[20:23], v[164:167], v[108:111], v[20:23]
    ds_read_b128 v[100:103], v246 offset:2048
    ds_read_b128 v[104:107], v200
    v_mfma_f32_16x16x32_bf16 v[52:55], v[164:167], v[112:115], v[52:55]
    ds_read_b64_tr_b16 v[148:149], v245 offset:32
    s_cselect_b32 s44, s49, s48
    v_mfma_f32_16x16x32_bf16 v[24:27], v[168:171], v[108:111], v[24:27]
    ds_read_b64_tr_b16 v[150:151], v245 offset:544
    ds_read_b64_tr_b16 v[152:153], v245 offset:64
    v_mfma_f32_16x16x32_bf16 v[56:59], v[168:171], v[112:115], v[56:59]
    ds_read_b64_tr_b16 v[154:155], v245 offset:576
    s_add_u32 m0, s58, 43776
    v_mfma_f32_16x16x32_bf16 v[88:91], v[168:171], v[116:119], v[88:91]
    ds_read_b64_tr_b16 v[156:157], v245 offset:96
    ds_read_b64_tr_b16 v[158:159], v245 offset:608
    v_mfma_f32_16x16x32_bf16 v[28:31], v[172:175], v[108:111], v[28:31]
    s_add_u32 s44, s44, 2097152
    buffer_load_dwordx4 v248, s[12:15], s44 offen lds
    v_mfma_f32_16x16x32_bf16 v[60:63], v[172:175], v[112:115], v[60:63]
    s_add_u32 s44, s44, 130048
    buffer_load_dwordx4 v248, s[12:15], s44 offen offset:1024 lds
    v_mfma_f32_16x16x32_bf16 v[92:95], v[172:175], v[116:119], v[92:95]
    s_cmp_ge_u32 s52, 5
    s_cselect_b32 s45, s51, s50
    s_waitcnt lgkmcnt(4)
    v_mfma_f32_16x16x32_bf16 v[0:3], v[144:147], v[96:99], v[0:3]
    ds_read_b64_tr_b16 v[160:161], v245 offset:128
    s_add_u32 m0, s59, 77056
    v_mfma_f32_16x16x32_bf16 v[32:35], v[144:147], v[100:103], v[32:35]
    ds_read_b64_tr_b16 v[162:163], v245 offset:640
    ds_read_b64_tr_b16 v[164:165], v245 offset:160
    v_mfma_f32_16x16x32_bf16 v[4:7], v[148:151], v[96:99], v[4:7]
    ds_read_b64_tr_b16 v[166:167], v245 offset:672
    s_add_u32 s45, s45, 512
    v_mfma_f32_16x16x32_bf16 v[36:39], v[148:151], v[100:103], v[36:39]
    ds_read_b64_tr_b16 v[168:169], v245 offset:192
    buffer_load_dwordx4 v247, s[8:11], s45 offen lds
    s_waitcnt lgkmcnt(5)
    v_mfma_f32_16x16x32_bf16 v[8:11], v[152:155], v[96:99], v[8:11]
    ds_read_b64_tr_b16 v[170:171], v245 offset:704
    ds_read_b64_tr_b16 v[172:173], v245 offset:224
    v_mfma_f32_16x16x32_bf16 v[40:43], v[152:155], v[100:103], v[40:43]
    ds_read_b64_tr_b16 v[174:175], v245 offset:736
    s_add_u32 m0, s59, 85248
    v_mfma_f32_16x16x32_bf16 v[12:15], v[156:159], v[96:99], v[12:15]
    s_add_u32 s44, s45, 73728
    buffer_load_dwordx4 v247, s[8:11], s44 offen lds
    v_mfma_f32_16x16x32_bf16 v[44:47], v[156:159], v[100:103], v[44:47]
    s_add_u32 m0, s53, 77056
    s_add_u32 s45, s45, s83
    s_waitcnt lgkmcnt(0)
    s_waitcnt vmcnt(10)
    s_barrier
    v_add_u32 v245, 95488, v242
    v_add_u32 v246, 128768, v244
    v_subrev_u32 v200, s34, v246
    v_mfma_f32_16x16x32_bf16 v[16:19], v[160:163], v[96:99], v[16:19]
    ds_read_b64_tr_b16 v[144:145], v245 offset:0
    ds_read_b64_tr_b16 v[146:147], v245 offset:512
    v_mfma_f32_16x16x32_bf16 v[48:51], v[160:163], v[100:103], v[48:51]
    ds_read_b128 v[108:111], v246 offset:0
    v_mfma_f32_16x16x32_bf16 v[20:23], v[164:167], v[96:99], v[20:23]
    ds_read_b128 v[112:115], v246 offset:2048
    ds_read_b128 v[116:119], v200
    v_mfma_f32_16x16x32_bf16 v[52:55], v[164:167], v[100:103], v[52:55]
    ds_read_b64_tr_b16 v[148:149], v245 offset:32
    v_mfma_f32_16x16x32_bf16 v[24:27], v[168:171], v[96:99], v[24:27]
    ds_read_b64_tr_b16 v[150:151], v245 offset:544
    ds_read_b64_tr_b16 v[152:153], v245 offset:64
    v_mfma_f32_16x16x32_bf16 v[56:59], v[168:171], v[100:103], v[56:59]
    ds_read_b64_tr_b16 v[154:155], v245 offset:576
    v_mfma_f32_16x16x32_bf16 v[88:91], v[168:171], v[104:107], v[88:91]
    ds_read_b64_tr_b16 v[156:157], v245 offset:96
    ds_read_b64_tr_b16 v[158:159], v245 offset:608
    v_mfma_f32_16x16x32_bf16 v[28:31], v[172:175], v[96:99], v[28:31]
    s_cmp_ge_u32 s52, 5
    v_mfma_f32_16x16x32_bf16 v[60:63], v[172:175], v[100:103], v[60:63]
    s_cselect_b32 s44, s49, s48
    v_mfma_f32_16x16x32_bf16 v[92:95], v[172:175], v[104:107], v[92:95]
    s_add_u32 m0, s58, 60416
    s_waitcnt lgkmcnt(4)
    v_mfma_f32_16x16x32_bf16 v[0:3], v[144:147], v[108:111], v[0:3]
    ds_read_b64_tr_b16 v[160:161], v245 offset:128
    s_add_u32 s44, s44, 2359296
    v_mfma_f32_16x16x32_bf16 v[32:35], v[144:147], v[112:115], v[32:35]
    ds_read_b64_tr_b16 v[162:163], v245 offset:640
    ds_read_b64_tr_b16 v[164:165], v245 offset:160
    v_mfma_f32_16x16x32_bf16 v[4:7], v[148:151], v[108:111], v[4:7]
    ds_read_b64_tr_b16 v[166:167], v245 offset:672
    v_mfma_f32_16x16x32_bf16 v[36:39], v[148:151], v[112:115], v[36:39]
    ds_read_b64_tr_b16 v[168:169], v245 offset:192
    s_waitcnt lgkmcnt(5)
    v_mfma_f32_16x16x32_bf16 v[8:11], v[152:155], v[108:111], v[8:11]
    ds_read_b64_tr_b16 v[170:171], v245 offset:704
    ds_read_b64_tr_b16 v[172:173], v245 offset:224
    v_mfma_f32_16x16x32_bf16 v[40:43], v[152:155], v[112:115], v[40:43]
    ds_read_b64_tr_b16 v[174:175], v245 offset:736
    v_mfma_f32_16x16x32_bf16 v[12:15], v[156:159], v[108:111], v[12:15]
    buffer_load_dwordx4 v248, s[12:15], s44 offen lds
    s_add_u32 s44, s44, 130048
    v_mfma_f32_16x16x32_bf16 v[44:47], v[156:159], v[112:115], v[44:47]
    buffer_load_dwordx4 v248, s[12:15], s44 offen offset:1024 lds
    s_waitcnt lgkmcnt(0)
    s_waitcnt vmcnt(8)
    s_barrier
    v_add_u32 v245, 112128, v242
    v_add_u32 v246, 25344, v243
    v_subrev_u32 v200, s34, v246
    v_mfma_f32_16x16x32_bf16 v[16:19], v[160:163], v[108:111], v[16:19]
    ds_read_b64_tr_b16 v[144:145], v245 offset:0
    ds_read_b64_tr_b16 v[146:147], v245 offset:512
    v_mfma_f32_16x16x32_bf16 v[48:51], v[160:163], v[112:115], v[48:51]
    ds_read_b128 v[96:99], v246 offset:0
    s_cmp_ge_u32 s52, 4
    v_mfma_f32_16x16x32_bf16 v[20:23], v[164:167], v[108:111], v[20:23]
    ds_read_b128 v[100:103], v246 offset:2048
    ds_read_b128 v[104:107], v200
    v_mfma_f32_16x16x32_bf16 v[52:55], v[164:167], v[112:115], v[52:55]
    ds_read_b64_tr_b16 v[148:149], v245 offset:32
    s_cselect_b32 s44, s49, s48
    v_mfma_f32_16x16x32_bf16 v[24:27], v[168:171], v[108:111], v[24:27]
    ds_read_b64_tr_b16 v[150:151], v245 offset:544
    ds_read_b64_tr_b16 v[152:153], v245 offset:64
    v_mfma_f32_16x16x32_bf16 v[56:59], v[168:171], v[112:115], v[56:59]
    ds_read_b64_tr_b16 v[154:155], v245 offset:576
    s_add_u32 m0, s58, 95488
    v_mfma_f32_16x16x32_bf16 v[88:91], v[168:171], v[116:119], v[88:91]
    ds_read_b64_tr_b16 v[156:157], v245 offset:96
    ds_read_b64_tr_b16 v[158:159], v245 offset:608
    v_mfma_f32_16x16x32_bf16 v[28:31], v[172:175], v[108:111], v[28:31]
    s_add_u32 s44, s44, 2621440
    buffer_load_dwordx4 v248, s[12:15], s44 offen lds
    v_mfma_f32_16x16x32_bf16 v[60:63], v[172:175], v[112:115], v[60:63]
    s_add_u32 s44, s44, 130048
    buffer_load_dwordx4 v248, s[12:15], s44 offen offset:1024 lds
    v_mfma_f32_16x16x32_bf16 v[92:95], v[172:175], v[116:119], v[92:95]
    s_cmp_ge_u32 s52, 4
    s_cselect_b32 s45, s51, s50
    s_waitcnt lgkmcnt(4)
    v_mfma_f32_16x16x32_bf16 v[0:3], v[144:147], v[96:99], v[0:3]
    ds_read_b64_tr_b16 v[160:161], v245 offset:128
    s_add_u32 m0, s59, 128768
    v_mfma_f32_16x16x32_bf16 v[32:35], v[144:147], v[100:103], v[32:35]
    ds_read_b64_tr_b16 v[162:163], v245 offset:640
    ds_read_b64_tr_b16 v[164:165], v245 offset:160
    v_mfma_f32_16x16x32_bf16 v[4:7], v[148:151], v[96:99], v[4:7]
    ds_read_b64_tr_b16 v[166:167], v245 offset:672
    s_add_u32 s45, s45, 640
    v_mfma_f32_16x16x32_bf16 v[36:39], v[148:151], v[100:103], v[36:39]
    ds_read_b64_tr_b16 v[168:169], v245 offset:192
    buffer_load_dwordx4 v247, s[8:11], s45 offen lds
    s_waitcnt lgkmcnt(5)
    v_mfma_f32_16x16x32_bf16 v[8:11], v[152:155], v[96:99], v[8:11]
    ds_read_b64_tr_b16 v[170:171], v245 offset:704
    ds_read_b64_tr_b16 v[172:173], v245 offset:224
    v_mfma_f32_16x16x32_bf16 v[40:43], v[152:155], v[100:103], v[40:43]
    ds_read_b64_tr_b16 v[174:175], v245 offset:736
    s_add_u32 m0, s59, 136960
    v_mfma_f32_16x16x32_bf16 v[12:15], v[156:159], v[96:99], v[12:15]
    s_add_u32 s44, s45, 73728
    buffer_load_dwordx4 v247, s[8:11], s44 offen lds
    v_mfma_f32_16x16x32_bf16 v[44:47], v[156:159], v[100:103], v[44:47]
    s_add_u32 m0, s53, 128768
    s_add_u32 s45, s45, s83
    s_waitcnt lgkmcnt(0)
    s_waitcnt vmcnt(10)
    s_barrier
    v_add_u32 v245, 147200, v242
    v_add_u32 v246, 25344, v244
    v_subrev_u32 v200, s34, v246
    v_mfma_f32_16x16x32_bf16 v[16:19], v[160:163], v[96:99], v[16:19]
    ds_read_b64_tr_b16 v[144:145], v245 offset:0
    ds_read_b64_tr_b16 v[146:147], v245 offset:512
    v_mfma_f32_16x16x32_bf16 v[48:51], v[160:163], v[100:103], v[48:51]
    ds_read_b128 v[108:111], v246 offset:0
    v_mfma_f32_16x16x32_bf16 v[20:23], v[164:167], v[96:99], v[20:23]
    ds_read_b128 v[112:115], v246 offset:2048
    ds_read_b128 v[116:119], v200
    v_mfma_f32_16x16x32_bf16 v[52:55], v[164:167], v[100:103], v[52:55]
    ds_read_b64_tr_b16 v[148:149], v245 offset:32
    v_mfma_f32_16x16x32_bf16 v[24:27], v[168:171], v[96:99], v[24:27]
    ds_read_b64_tr_b16 v[150:151], v245 offset:544
    ds_read_b64_tr_b16 v[152:153], v245 offset:64
    v_mfma_f32_16x16x32_bf16 v[56:59], v[168:171], v[100:103], v[56:59]
    ds_read_b64_tr_b16 v[154:155], v245 offset:576
    v_mfma_f32_16x16x32_bf16 v[88:91], v[168:171], v[104:107], v[88:91]
    ds_read_b64_tr_b16 v[156:157], v245 offset:96
    ds_read_b64_tr_b16 v[158:159], v245 offset:608
    v_mfma_f32_16x16x32_bf16 v[28:31], v[172:175], v[96:99], v[28:31]
    s_cmp_ge_u32 s52, 4
    v_mfma_f32_16x16x32_bf16 v[60:63], v[172:175], v[100:103], v[60:63]
    s_cselect_b32 s44, s49, s48
    v_mfma_f32_16x16x32_bf16 v[92:95], v[172:175], v[104:107], v[92:95]
    s_add_u32 m0, s58, 112128
    s_waitcnt lgkmcnt(4)
    v_mfma_f32_16x16x32_bf16 v[0:3], v[144:147], v[108:111], v[0:3]
    ds_read_b64_tr_b16 v[160:161], v245 offset:128
    s_add_u32 s44, s44, 2883584
    v_mfma_f32_16x16x32_bf16 v[32:35], v[144:147], v[112:115], v[32:35]
    ds_read_b64_tr_b16 v[162:163], v245 offset:640
    ds_read_b64_tr_b16 v[164:165], v245 offset:160
    v_mfma_f32_16x16x32_bf16 v[4:7], v[148:151], v[108:111], v[4:7]
    ds_read_b64_tr_b16 v[166:167], v245 offset:672
    v_mfma_f32_16x16x32_bf16 v[36:39], v[148:151], v[112:115], v[36:39]
    ds_read_b64_tr_b16 v[168:169], v245 offset:192
    s_waitcnt lgkmcnt(5)
    v_mfma_f32_16x16x32_bf16 v[8:11], v[152:155], v[108:111], v[8:11]
    ds_read_b64_tr_b16 v[170:171], v245 offset:704
    ds_read_b64_tr_b16 v[172:173], v245 offset:224
    v_mfma_f32_16x16x32_bf16 v[40:43], v[152:155], v[112:115], v[40:43]
    ds_read_b64_tr_b16 v[174:175], v245 offset:736
    v_mfma_f32_16x16x32_bf16 v[12:15], v[156:159], v[108:111], v[12:15]
    buffer_load_dwordx4 v248, s[12:15], s44 offen lds
    s_add_u32 s44, s44, 130048
    v_mfma_f32_16x16x32_bf16 v[44:47], v[156:159], v[112:115], v[44:47]
    buffer_load_dwordx4 v248, s[12:15], s44 offen offset:1024 lds
    s_waitcnt lgkmcnt(0)
    s_waitcnt vmcnt(8)
    s_barrier
    v_add_u32 v245, 43776, v242
    v_add_u32 v246, 77056, v243
    v_subrev_u32 v200, s34, v246
    v_mfma_f32_16x16x32_bf16 v[16:19], v[160:163], v[108:111], v[16:19]
    ds_read_b64_tr_b16 v[144:145], v245 offset:0
    ds_read_b64_tr_b16 v[146:147], v245 offset:512
    v_mfma_f32_16x16x32_bf16 v[48:51], v[160:163], v[112:115], v[48:51]
    ds_read_b128 v[96:99], v246 offset:0
    global_load_dword v255, v202, s[4:5]
    v_mfma_f32_16x16x32_bf16 v[20:23], v[164:167], v[108:111], v[20:23]
    ds_read_b128 v[100:103], v246 offset:2048
    ds_read_b128 v[104:107], v200
    v_mfma_f32_16x16x32_bf16 v[52:55], v[164:167], v[112:115], v[52:55]
    ds_read_b64_tr_b16 v[148:149], v245 offset:32
    s_cmp_ge_u32 s52, 3
    v_mfma_f32_16x16x32_bf16 v[24:27], v[168:171], v[108:111], v[24:27]
    ds_read_b64_tr_b16 v[150:151], v245 offset:544
    ds_read_b64_tr_b16 v[152:153], v245 offset:64
    v_mfma_f32_16x16x32_bf16 v[56:59], v[168:171], v[112:115], v[56:59]
    ds_read_b64_tr_b16 v[154:155], v245 offset:576
    s_cselect_b32 s44, s49, s48
    v_mfma_f32_16x16x32_bf16 v[88:91], v[168:171], v[116:119], v[88:91]
    ds_read_b64_tr_b16 v[156:157], v245 offset:96
    ds_read_b64_tr_b16 v[158:159], v245 offset:608
    v_mfma_f32_16x16x32_bf16 v[28:31], v[172:175], v[108:111], v[28:31]
    s_add_u32 m0, s58, 147200
    s_add_u32 s44, s44, 3145728
    v_mfma_f32_16x16x32_bf16 v[60:63], v[172:175], v[112:115], v[60:63]
    buffer_load_dwordx4 v248, s[12:15], s44 offen lds
    s_add_u32 s44, s44, 130048
    v_mfma_f32_16x16x32_bf16 v[92:95], v[172:175], v[116:119], v[92:95]
    buffer_load_dwordx4 v248, s[12:15], s44 offen offset:1024 lds
    s_cmp_ge_u32 s52, 3
    s_cselect_b32 s45, s51, s50
    s_waitcnt lgkmcnt(4)
    v_mfma_f32_16x16x32_bf16 v[0:3], v[144:147], v[96:99], v[0:3]
    ds_read_b64_tr_b16 v[160:161], v245 offset:128
    s_add_u32 m0, s59, 25344
    v_mfma_f32_16x16x32_bf16 v[32:35], v[144:147], v[100:103], v[32:35]
    ds_read_b64_tr_b16 v[162:163], v245 offset:640
    ds_read_b64_tr_b16 v[164:165], v245 offset:160
    v_mfma_f32_16x16x32_bf16 v[4:7], v[148:151], v[96:99], v[4:7]
    ds_read_b64_tr_b16 v[166:167], v245 offset:672
    s_add_u32 s45, s45, 768
    v_mfma_f32_16x16x32_bf16 v[36:39], v[148:151], v[100:103], v[36:39]
    ds_read_b64_tr_b16 v[168:169], v245 offset:192
    buffer_load_dwordx4 v247, s[8:11], s45 offen lds
    s_waitcnt lgkmcnt(5)
    v_mfma_f32_16x16x32_bf16 v[8:11], v[152:155], v[96:99], v[8:11]
    ds_read_b64_tr_b16 v[170:171], v245 offset:704
    ds_read_b64_tr_b16 v[172:173], v245 offset:224
    v_mfma_f32_16x16x32_bf16 v[40:43], v[152:155], v[100:103], v[40:43]
    ds_read_b64_tr_b16 v[174:175], v245 offset:736
    s_add_u32 m0, s59, 33536
    v_mfma_f32_16x16x32_bf16 v[12:15], v[156:159], v[96:99], v[12:15]
    s_add_u32 s44, s45, 73728
    buffer_load_dwordx4 v247, s[8:11], s44 offen lds
    v_mfma_f32_16x16x32_bf16 v[44:47], v[156:159], v[100:103], v[44:47]
    s_add_u32 m0, s53, 25344
    s_add_u32 s45, s45, s83
    s_waitcnt lgkmcnt(0)
    s_waitcnt vmcnt(11)
    s_barrier
    v_add_u32 v245, 60416, v242
    v_add_u32 v246, 77056, v244
    v_subrev_u32 v200, s34, v246
    v_mfma_f32_16x16x32_bf16 v[16:19], v[160:163], v[96:99], v[16:19]
    ds_read_b64_tr_b16 v[144:145], v245 offset:0
    ds_read_b64_tr_b16 v[146:147], v245 offset:512
    v_mfma_f32_16x16x32_bf16 v[48:51], v[160:163], v[100:103], v[48:51]
    ds_read_b128 v[108:111], v246 offset:0
    v_mfma_f32_16x16x32_bf16 v[20:23], v[164:167], v[96:99], v[20:23]
    ds_read_b128 v[112:115], v246 offset:2048
    ds_read_b128 v[116:119], v200
    v_mfma_f32_16x16x32_bf16 v[52:55], v[164:167], v[100:103], v[52:55]
    ds_read_b64_tr_b16 v[148:149], v245 offset:32
    v_mfma_f32_16x16x32_bf16 v[24:27], v[168:171], v[96:99], v[24:27]
    ds_read_b64_tr_b16 v[150:151], v245 offset:544
    ds_read_b64_tr_b16 v[152:153], v245 offset:64
    v_mfma_f32_16x16x32_bf16 v[56:59], v[168:171], v[100:103], v[56:59]
    ds_read_b64_tr_b16 v[154:155], v245 offset:576
    v_mfma_f32_16x16x32_bf16 v[88:91], v[168:171], v[104:107], v[88:91]
    ds_read_b64_tr_b16 v[156:157], v245 offset:96
    ds_read_b64_tr_b16 v[158:159], v245 offset:608
    v_mfma_f32_16x16x32_bf16 v[28:31], v[172:175], v[96:99], v[28:31]
    s_cmp_ge_u32 s52, 3
    v_mfma_f32_16x16x32_bf16 v[60:63], v[172:175], v[100:103], v[60:63]
    s_cselect_b32 s44, s49, s48
    v_mfma_f32_16x16x32_bf16 v[92:95], v[172:175], v[104:107], v[92:95]
    s_add_u32 m0, s58, 43776
    s_waitcnt lgkmcnt(4)
    v_mfma_f32_16x16x32_bf16 v[0:3], v[144:147], v[108:111], v[0:3]
    ds_read_b64_tr_b16 v[160:161], v245 offset:128
    s_add_u32 s44, s44, 3407872
    v_mfma_f32_16x16x32_bf16 v[32:35], v[144:147], v[112:115], v[32:35]
    ds_read_b64_tr_b16 v[162:163], v245 offset:640
    ds_read_b64_tr_b16 v[164:165], v245 offset:160
    v_mfma_f32_16x16x32_bf16 v[4:7], v[148:151], v[108:111], v[4:7]
    ds_read_b64_tr_b16 v[166:167], v245 offset:672
    v_mfma_f32_16x16x32_bf16 v[36:39], v[148:151], v[112:115], v[36:39]
    ds_read_b64_tr_b16 v[168:169], v245 offset:192
    s_waitcnt lgkmcnt(5)
    v_mfma_f32_16x16x32_bf16 v[8:11], v[152:155], v[108:111], v[8:11]
    ds_read_b64_tr_b16 v[170:171], v245 offset:704
    ds_read_b64_tr_b16 v[172:173], v245 offset:224
    v_mfma_f32_16x16x32_bf16 v[40:43], v[152:155], v[112:115], v[40:43]
    ds_read_b64_tr_b16 v[174:175], v245 offset:736
    v_mfma_f32_16x16x32_bf16 v[12:15], v[156:159], v[108:111], v[12:15]
    buffer_load_dwordx4 v248, s[12:15], s44 offen lds
    s_add_u32 s44, s44, 130048
    v_mfma_f32_16x16x32_bf16 v[44:47], v[156:159], v[112:115], v[44:47]
    buffer_load_dwordx4 v248, s[12:15], s44 offen offset:1024 lds
    s_waitcnt lgkmcnt(0)
    s_waitcnt vmcnt(9)
    s_barrier
    v_add_u32 v245, 95488, v242
    v_add_u32 v246, 128768, v243
    v_subrev_u32 v200, s34, v246
    v_mfma_f32_16x16x32_bf16 v[16:19], v[160:163], v[108:111], v[16:19]
    ds_read_b64_tr_b16 v[144:145], v245 offset:0
    ds_read_b64_tr_b16 v[146:147], v245 offset:512
    v_mfma_f32_16x16x32_bf16 v[48:51], v[160:163], v[112:115], v[48:51]
    ds_read_b128 v[96:99], v246 offset:0
    s_cmp_ge_u32 s52, 2
    v_mfma_f32_16x16x32_bf16 v[20:23], v[164:167], v[108:111], v[20:23]
    ds_read_b128 v[100:103], v246 offset:2048
    ds_read_b128 v[104:107], v200
    v_mfma_f32_16x16x32_bf16 v[52:55], v[164:167], v[112:115], v[52:55]
    ds_read_b64_tr_b16 v[148:149], v245 offset:32
    s_cselect_b32 s44, s49, s48
    v_mfma_f32_16x16x32_bf16 v[24:27], v[168:171], v[108:111], v[24:27]
    ds_read_b64_tr_b16 v[150:151], v245 offset:544
    ds_read_b64_tr_b16 v[152:153], v245 offset:64
    v_mfma_f32_16x16x32_bf16 v[56:59], v[168:171], v[112:115], v[56:59]
    ds_read_b64_tr_b16 v[154:155], v245 offset:576
    s_add_u32 m0, s58, 60416
    v_mfma_f32_16x16x32_bf16 v[88:91], v[168:171], v[116:119], v[88:91]
    ds_read_b64_tr_b16 v[156:157], v245 offset:96
    ds_read_b64_tr_b16 v[158:159], v245 offset:608
    v_mfma_f32_16x16x32_bf16 v[28:31], v[172:175], v[108:111], v[28:31]
    s_add_u32 s44, s44, 3670016
    buffer_load_dwordx4 v248, s[12:15], s44 offen lds
    v_mfma_f32_16x16x32_bf16 v[60:63], v[172:175], v[112:115], v[60:63]
    s_add_u32 s44, s44, 130048
    buffer_load_dwordx4 v248, s[12:15], s44 offen offset:1024 lds
    v_mfma_f32_16x16x32_bf16 v[92:95], v[172:175], v[116:119], v[92:95]
    s_cmp_ge_u32 s52, 2
    s_cselect_b32 s45, s51, s50
    s_waitcnt lgkmcnt(4)
    v_mfma_f32_16x16x32_bf16 v[0:3], v[144:147], v[96:99], v[0:3]
    ds_read_b64_tr_b16 v[160:161], v245 offset:128
    s_add_u32 m0, s59, 77056
    v_mfma_f32_16x16x32_bf16 v[32:35], v[144:147], v[100:103], v[32:35]
    ds_read_b64_tr_b16 v[162:163], v245 offset:640
    ds_read_b64_tr_b16 v[164:165], v245 offset:160
    v_mfma_f32_16x16x32_bf16 v[4:7], v[148:151], v[96:99], v[4:7]
    ds_read_b64_tr_b16 v[166:167], v245 offset:672
    s_add_u32 s45, s45, 896
    v_mfma_f32_16x16x32_bf16 v[36:39], v[148:151], v[100:103], v[36:39]
    ds_read_b64_tr_b16 v[168:169], v245 offset:192
    buffer_load_dwordx4 v247, s[8:11], s45 offen lds
    s_waitcnt lgkmcnt(5)
    v_mfma_f32_16x16x32_bf16 v[8:11], v[152:155], v[96:99], v[8:11]
    ds_read_b64_tr_b16 v[170:171], v245 offset:704
    ds_read_b64_tr_b16 v[172:173], v245 offset:224
    v_mfma_f32_16x16x32_bf16 v[40:43], v[152:155], v[100:103], v[40:43]
    ds_read_b64_tr_b16 v[174:175], v245 offset:736
    s_add_u32 m0, s59, 85248
    v_mfma_f32_16x16x32_bf16 v[12:15], v[156:159], v[96:99], v[12:15]
    s_add_u32 s44, s45, 73728
    buffer_load_dwordx4 v247, s[8:11], s44 offen lds
    v_mfma_f32_16x16x32_bf16 v[44:47], v[156:159], v[100:103], v[44:47]
    s_add_u32 m0, s53, 77056
    s_add_u32 s45, s45, s83
    s_waitcnt lgkmcnt(0)
    s_waitcnt vmcnt(11)
    s_barrier
    v_add_u32 v245, 112128, v242
    v_add_u32 v246, 128768, v244
    v_subrev_u32 v200, s34, v246
    v_mfma_f32_16x16x32_bf16 v[16:19], v[160:163], v[96:99], v[16:19]
    ds_read_b64_tr_b16 v[144:145], v245 offset:0
    ds_read_b64_tr_b16 v[146:147], v245 offset:512
    v_mfma_f32_16x16x32_bf16 v[48:51], v[160:163], v[100:103], v[48:51]
    ds_read_b128 v[108:111], v246 offset:0
    v_mfma_f32_16x16x32_bf16 v[20:23], v[164:167], v[96:99], v[20:23]
    ds_read_b128 v[112:115], v246 offset:2048
    ds_read_b128 v[116:119], v200
    v_mfma_f32_16x16x32_bf16 v[52:55], v[164:167], v[100:103], v[52:55]
    ds_read_b64_tr_b16 v[148:149], v245 offset:32
    v_mfma_f32_16x16x32_bf16 v[24:27], v[168:171], v[96:99], v[24:27]
    ds_read_b64_tr_b16 v[150:151], v245 offset:544
    ds_read_b64_tr_b16 v[152:153], v245 offset:64
    v_mfma_f32_16x16x32_bf16 v[56:59], v[168:171], v[100:103], v[56:59]
    ds_read_b64_tr_b16 v[154:155], v245 offset:576
    v_mfma_f32_16x16x32_bf16 v[88:91], v[168:171], v[104:107], v[88:91]
    ds_read_b64_tr_b16 v[156:157], v245 offset:96
    ds_read_b64_tr_b16 v[158:159], v245 offset:608
    v_mfma_f32_16x16x32_bf16 v[28:31], v[172:175], v[96:99], v[28:31]
    s_cmp_ge_u32 s52, 2
    v_mfma_f32_16x16x32_bf16 v[60:63], v[172:175], v[100:103], v[60:63]
    s_cselect_b32 s44, s49, s48
    v_mfma_f32_16x16x32_bf16 v[92:95], v[172:175], v[104:107], v[92:95]
    s_add_u32 m0, s58, 95488
    s_waitcnt lgkmcnt(4)
    v_mfma_f32_16x16x32_bf16 v[0:3], v[144:147], v[108:111], v[0:3]
    ds_read_b64_tr_b16 v[160:161], v245 offset:128
    s_add_u32 s44, s44, 3932160
    v_mfma_f32_16x16x32_bf16 v[32:35], v[144:147], v[112:115], v[32:35]
    ds_read_b64_tr_b16 v[162:163], v245 offset:640
    ds_read_b64_tr_b16 v[164:165], v245 offset:160
    v_mfma_f32_16x16x32_bf16 v[4:7], v[148:151], v[108:111], v[4:7]
    ds_read_b64_tr_b16 v[166:167], v245 offset:672
    v_mfma_f32_16x16x32_bf16 v[36:39], v[148:151], v[112:115], v[36:39]
    ds_read_b64_tr_b16 v[168:169], v245 offset:192
    s_waitcnt lgkmcnt(5)
    v_mfma_f32_16x16x32_bf16 v[8:11], v[152:155], v[108:111], v[8:11]
    ds_read_b64_tr_b16 v[170:171], v245 offset:704
    ds_read_b64_tr_b16 v[172:173], v245 offset:224
    v_mfma_f32_16x16x32_bf16 v[40:43], v[152:155], v[112:115], v[40:43]
    ds_read_b64_tr_b16 v[174:175], v245 offset:736
    v_mfma_f32_16x16x32_bf16 v[12:15], v[156:159], v[108:111], v[12:15]
    buffer_load_dwordx4 v248, s[12:15], s44 offen lds
    s_add_u32 s44, s44, 130048
    v_mfma_f32_16x16x32_bf16 v[44:47], v[156:159], v[112:115], v[44:47]
    buffer_load_dwordx4 v248, s[12:15], s44 offen offset:1024 lds
    s_waitcnt lgkmcnt(0)
    s_waitcnt vmcnt(8)
    s_barrier
    v_add_u32 v245, 147200, v242
    v_add_u32 v246, 25344, v243
    v_subrev_u32 v200, s34, v246
    v_mfma_f32_16x16x32_bf16 v[16:19], v[160:163], v[108:111], v[16:19]
    ds_read_b64_tr_b16 v[144:145], v245 offset:0
    ds_read_b64_tr_b16 v[146:147], v245 offset:512
    v_mfma_f32_16x16x32_bf16 v[48:51], v[160:163], v[112:115], v[48:51]
    ds_read_b128 v[96:99], v246 offset:0
    s_cmp_ge_u32 s52, 1
    v_mfma_f32_16x16x32_bf16 v[20:23], v[164:167], v[108:111], v[20:23]
    ds_read_b128 v[100:103], v246 offset:2048
    ds_read_b128 v[104:107], v200
    v_mfma_f32_16x16x32_bf16 v[52:55], v[164:167], v[112:115], v[52:55]
    ds_read_b64_tr_b16 v[148:149], v245 offset:32
    s_cselect_b32 s44, s49, s48
    v_mfma_f32_16x16x32_bf16 v[24:27], v[168:171], v[108:111], v[24:27]
    ds_read_b64_tr_b16 v[150:151], v245 offset:544
    ds_read_b64_tr_b16 v[152:153], v245 offset:64
    v_mfma_f32_16x16x32_bf16 v[56:59], v[168:171], v[112:115], v[56:59]
    ds_read_b64_tr_b16 v[154:155], v245 offset:576
    s_add_u32 m0, s58, 112128
    v_mfma_f32_16x16x32_bf16 v[88:91], v[168:171], v[116:119], v[88:91]
    ds_read_b64_tr_b16 v[156:157], v245 offset:96
    ds_read_b64_tr_b16 v[158:159], v245 offset:608
    v_mfma_f32_16x16x32_bf16 v[28:31], v[172:175], v[108:111], v[28:31]
    s_add_u32 s44, s44, 4194304
    buffer_load_dwordx4 v248, s[12:15], s44 offen lds
    v_mfma_f32_16x16x32_bf16 v[60:63], v[172:175], v[112:115], v[60:63]
    s_add_u32 s44, s44, 130048
    buffer_load_dwordx4 v248, s[12:15], s44 offen offset:1024 lds
    v_mfma_f32_16x16x32_bf16 v[92:95], v[172:175], v[116:119], v[92:95]
    s_cmp_ge_u32 s52, 1
    s_cselect_b32 s45, s51, s50
    s_waitcnt lgkmcnt(4)
    v_mfma_f32_16x16x32_bf16 v[0:3], v[144:147], v[96:99], v[0:3]
    ds_read_b64_tr_b16 v[160:161], v245 offset:128
    s_add_u32 m0, s59, 128768
    v_mfma_f32_16x16x32_bf16 v[32:35], v[144:147], v[100:103], v[32:35]
    ds_read_b64_tr_b16 v[162:163], v245 offset:640
    ds_read_b64_tr_b16 v[164:165], v245 offset:160
    v_mfma_f32_16x16x32_bf16 v[4:7], v[148:151], v[96:99], v[4:7]
    ds_read_b64_tr_b16 v[166:167], v245 offset:672
    s_add_u32 s45, s45, 1024
    v_mfma_f32_16x16x32_bf16 v[36:39], v[148:151], v[100:103], v[36:39]
    ds_read_b64_tr_b16 v[168:169], v245 offset:192
    buffer_load_dwordx4 v247, s[8:11], s45 offen lds
    s_waitcnt lgkmcnt(5)
    v_mfma_f32_16x16x32_bf16 v[8:11], v[152:155], v[96:99], v[8:11]
    ds_read_b64_tr_b16 v[170:171], v245 offset:704
    ds_read_b64_tr_b16 v[172:173], v245 offset:224
    v_mfma_f32_16x16x32_bf16 v[40:43], v[152:155], v[100:103], v[40:43]
    ds_read_b64_tr_b16 v[174:175], v245 offset:736
    s_add_u32 m0, s59, 136960
    v_mfma_f32_16x16x32_bf16 v[12:15], v[156:159], v[96:99], v[12:15]
    s_add_u32 s44, s45, 73728
    buffer_load_dwordx4 v247, s[8:11], s44 offen lds
    v_mfma_f32_16x16x32_bf16 v[44:47], v[156:159], v[100:103], v[44:47]
    s_add_u32 m0, s53, 128768
    s_add_u32 s45, s45, s83
    s_waitcnt lgkmcnt(0)
    s_waitcnt vmcnt(10)
    s_barrier
    v_add_u32 v245, 43776, v242
    v_add_u32 v246, 25344, v244
    v_subrev_u32 v200, s34, v246
    v_mfma_f32_16x16x32_bf16 v[16:19], v[160:163], v[96:99], v[16:19]
    ds_read_b64_tr_b16 v[144:145], v245 offset:0
    ds_read_b64_tr_b16 v[146:147], v245 offset:512
    v_mfma_f32_16x16x32_bf16 v[48:51], v[160:163], v[100:103], v[48:51]
    ds_read_b128 v[108:111], v246 offset:0
    v_mfma_f32_16x16x32_bf16 v[20:23], v[164:167], v[96:99], v[20:23]
    ds_read_b128 v[112:115], v246 offset:2048
    ds_read_b128 v[116:119], v200
    v_mfma_f32_16x16x32_bf16 v[52:55], v[164:167], v[100:103], v[52:55]
    ds_read_b64_tr_b16 v[148:149], v245 offset:32
    v_mfma_f32_16x16x32_bf16 v[24:27], v[168:171], v[96:99], v[24:27]
    ds_read_b64_tr_b16 v[150:151], v245 offset:544
    ds_read_b64_tr_b16 v[152:153], v245 offset:64
    v_mfma_f32_16x16x32_bf16 v[56:59], v[168:171], v[100:103], v[56:59]
    ds_read_b64_tr_b16 v[154:155], v245 offset:576
    v_mfma_f32_16x16x32_bf16 v[88:91], v[168:171], v[104:107], v[88:91]
    ds_read_b64_tr_b16 v[156:157], v245 offset:96
    ds_read_b64_tr_b16 v[158:159], v245 offset:608
    v_mfma_f32_16x16x32_bf16 v[28:31], v[172:175], v[96:99], v[28:31]
    s_cmp_ge_u32 s52, 1
    v_mfma_f32_16x16x32_bf16 v[60:63], v[172:175], v[100:103], v[60:63]
    s_cselect_b32 s44, s49, s48
    s_add_u32 m0, s58, 147200
    v_mfma_f32_16x16x32_bf16 v[92:95], v[172:175], v[104:107], v[92:95]
    s_add_u32 s44, s44, 4456448
    s_waitcnt lgkmcnt(4)
    v_mfma_f32_16x16x32_bf16 v[0:3], v[144:147], v[108:111], v[0:3]
    ds_read_b64_tr_b16 v[160:161], v245 offset:128
    buffer_load_dwordx4 v248, s[12:15], s44 offen lds
    v_mfma_f32_16x16x32_bf16 v[32:35], v[144:147], v[112:115], v[32:35]
    ds_read_b64_tr_b16 v[162:163], v245 offset:640
    ds_read_b64_tr_b16 v[164:165], v245 offset:160
    v_mfma_f32_16x16x32_bf16 v[4:7], v[148:151], v[108:111], v[4:7]
    ds_read_b64_tr_b16 v[166:167], v245 offset:672
    v_mfma_f32_16x16x32_bf16 v[36:39], v[148:151], v[112:115], v[36:39]
    ds_read_b64_tr_b16 v[168:169], v245 offset:192
    s_waitcnt lgkmcnt(5)
    v_mfma_f32_16x16x32_bf16 v[8:11], v[152:155], v[108:111], v[8:11]
    ds_read_b64_tr_b16 v[170:171], v245 offset:704
    ds_read_b64_tr_b16 v[172:173], v245 offset:224
    v_mfma_f32_16x16x32_bf16 v[40:43], v[152:155], v[112:115], v[40:43]
    ds_read_b64_tr_b16 v[174:175], v245 offset:736
    v_mfma_f32_16x16x32_bf16 v[12:15], v[156:159], v[108:111], v[12:15]
    s_add_u32 s44, s44, 130048
    buffer_load_dwordx4 v248, s[12:15], s44 offen offset:1024 lds
    v_mfma_f32_16x16x32_bf16 v[44:47], v[156:159], v[112:115], v[44:47]
    buffer_load_dword v184, off, s[88:91], s35 sc1
    s_add_u32 s44, s37, 0
    s_add_u32 m0, s38, 0
    s_nop 0
    buffer_load_dwordx4 v241, s[16:19], s44 offen nt lds
    s_add_u32 m0, m0, 800
    s_nop 0
    buffer_load_dwordx4 v241, s[16:19], s44 offen offset:256 nt lds
    s_add_u32 s44, s37, 0
    s_add_u32 m0, s38, 8448
    s_nop 0
    buffer_load_dwordx4 v241, s[24:27], s44 offen nt lds
    s_add_u32 m0, m0, 800
    s_nop 0
    buffer_load_dwordx4 v241, s[24:27], s44 offen offset:256 nt lds
    s_add_u32 s44, s37, 262144
    s_add_u32 m0, s38, 16896
    s_nop 0
    buffer_load_dwordx4 v241, s[16:19], s44 offen nt lds
    s_add_u32 m0, m0, 800
    s_nop 0
    buffer_load_dwordx4 v241, s[16:19], s44 offen offset:256 nt lds
    s_waitcnt lgkmcnt(0)
    s_waitcnt vmcnt(15)
    s_barrier
    v_add_u32 v245, 60416, v242
    v_add_u32 v246, 77056, v243
    v_subrev_u32 v200, s34, v246
    v_mfma_f32_16x16x32_bf16 v[16:19], v[160:163], v[108:111], v[16:19]
    ds_read_b64_tr_b16 v[144:145], v245 offset:0
    ds_read_b64_tr_b16 v[146:147], v245 offset:512
    v_mfma_f32_16x16x32_bf16 v[48:51], v[160:163], v[112:115], v[48:51]
    ds_read_b128 v[96:99], v246 offset:0
    v_mfma_f32_16x16x32_bf16 v[20:23], v[164:167], v[108:111], v[20:23]
    ds_read_b128 v[100:103], v246 offset:2048
    ds_read_b128 v[104:107], v200
    v_mfma_f32_16x16x32_bf16 v[52:55], v[164:167], v[112:115], v[52:55]
    ds_read_b64_tr_b16 v[148:149], v245 offset:32
    v_mfma_f32_16x16x32_bf16 v[24:27], v[168:171], v[108:111], v[24:27]
    ds_read_b64_tr_b16 v[150:151], v245 offset:544
    ds_read_b64_tr_b16 v[152:153], v245 offset:64
    v_mfma_f32_16x16x32_bf16 v[56:59], v[168:171], v[112:115], v[56:59]
    ds_read_b64_tr_b16 v[154:155], v245 offset:576
    v_mfma_f32_16x16x32_bf16 v[88:91], v[168:171], v[116:119], v[88:91]
    ds_read_b64_tr_b16 v[156:157], v245 offset:96
    ds_read_b64_tr_b16 v[158:159], v245 offset:608
    v_mfma_f32_16x16x32_bf16 v[28:31], v[172:175], v[108:111], v[28:31]
    v_mfma_f32_16x16x32_bf16 v[60:63], v[172:175], v[112:115], v[60:63]
    v_mfma_f32_16x16x32_bf16 v[92:95], v[172:175], v[116:119], v[92:95]
    s_waitcnt lgkmcnt(4)
    v_mfma_f32_16x16x32_bf16 v[0:3], v[144:147], v[96:99], v[0:3]
    ds_read_b64_tr_b16 v[160:161], v245 offset:128
    v_mfma_f32_16x16x32_bf16 v[32:35], v[144:147], v[100:103], v[32:35]
    ds_read_b64_tr_b16 v[162:163], v245 offset:640
    ds_read_b64_tr_b16 v[164:165], v245 offset:160
    v_mfma_f32_16x16x32_bf16 v[4:7], v[148:151], v[96:99], v[4:7]
    ds_read_b64_tr_b16 v[166:167], v245 offset:672
    v_mfma_f32_16x16x32_bf16 v[36:39], v[148:151], v[100:103], v[36:39]
    ds_read_b64_tr_b16 v[168:169], v245 offset:192
    s_waitcnt lgkmcnt(5)
    v_mfma_f32_16x16x32_bf16 v[8:11], v[152:155], v[96:99], v[8:11]
    ds_read_b64_tr_b16 v[170:171], v245 offset:704
    ds_read_b64_tr_b16 v[172:173], v245 offset:224
    v_mfma_f32_16x16x32_bf16 v[40:43], v[152:155], v[100:103], v[40:43]
    ds_read_b64_tr_b16 v[174:175], v245 offset:736
    v_mfma_f32_16x16x32_bf16 v[12:15], v[156:159], v[96:99], v[12:15]
    v_mfma_f32_16x16x32_bf16 v[44:47], v[156:159], v[100:103], v[44:47]
    s_add_u32 s44, s37, 262144
    s_add_u32 m0, s38, 25344
    s_nop 0
    buffer_load_dwordx4 v241, s[24:27], s44 offen nt lds
    s_add_u32 m0, m0, 800
    s_nop 0
    buffer_load_dwordx4 v241, s[24:27], s44 offen offset:256 nt lds
    s_waitcnt lgkmcnt(0)
    s_waitcnt vmcnt(15)
    s_barrier
    v_add_u32 v245, 95488, v242
    v_add_u32 v246, 77056, v244
    v_subrev_u32 v200, s34, v246
    v_mfma_f32_16x16x32_bf16 v[16:19], v[160:163], v[96:99], v[16:19]
    ds_read_b64_tr_b16 v[144:145], v245 offset:0
    ds_read_b64_tr_b16 v[146:147], v245 offset:512
    v_mfma_f32_16x16x32_bf16 v[48:51], v[160:163], v[100:103], v[48:51]
    ds_read_b128 v[108:111], v246 offset:0
    v_mfma_f32_16x16x32_bf16 v[20:23], v[164:167], v[96:99], v[20:23]
    ds_read_b128 v[112:115], v246 offset:2048
    ds_read_b128 v[116:119], v200
    v_mfma_f32_16x16x32_bf16 v[52:55], v[164:167], v[100:103], v[52:55]
    ds_read_b64_tr_b16 v[148:149], v245 offset:32
    v_mfma_f32_16x16x32_bf16 v[24:27], v[168:171], v[96:99], v[24:27]
    ds_read_b64_tr_b16 v[150:151], v245 offset:544
    ds_read_b64_tr_b16 v[152:153], v245 offset:64
    v_mfma_f32_16x16x32_bf16 v[56:59], v[168:171], v[100:103], v[56:59]
    ds_read_b64_tr_b16 v[154:155], v245 offset:576
    v_mfma_f32_16x16x32_bf16 v[88:91], v[168:171], v[104:107], v[88:91]
    ds_read_b64_tr_b16 v[156:157], v245 offset:96
    ds_read_b64_tr_b16 v[158:159], v245 offset:608
    v_mfma_f32_16x16x32_bf16 v[28:31], v[172:175], v[96:99], v[28:31]
    v_mfma_f32_16x16x32_bf16 v[60:63], v[172:175], v[100:103], v[60:63]
    v_mfma_f32_16x16x32_bf16 v[92:95], v[172:175], v[104:107], v[92:95]
    s_waitcnt lgkmcnt(4)
    v_mfma_f32_16x16x32_bf16 v[0:3], v[144:147], v[108:111], v[0:3]
    ds_read_b64_tr_b16 v[160:161], v245 offset:128
    v_mfma_f32_16x16x32_bf16 v[32:35], v[144:147], v[112:115], v[32:35]
    ds_read_b64_tr_b16 v[162:163], v245 offset:640
    ds_read_b64_tr_b16 v[164:165], v245 offset:160
    v_mfma_f32_16x16x32_bf16 v[4:7], v[148:151], v[108:111], v[4:7]
    ds_read_b64_tr_b16 v[166:167], v245 offset:672
    v_mfma_f32_16x16x32_bf16 v[36:39], v[148:151], v[112:115], v[36:39]
    ds_read_b64_tr_b16 v[168:169], v245 offset:192
    s_waitcnt lgkmcnt(5)
    v_mfma_f32_16x16x32_bf16 v[8:11], v[152:155], v[108:111], v[8:11]
    ds_read_b64_tr_b16 v[170:171], v245 offset:704
    ds_read_b64_tr_b16 v[172:173], v245 offset:224
    v_mfma_f32_16x16x32_bf16 v[40:43], v[152:155], v[112:115], v[40:43]
    ds_read_b64_tr_b16 v[174:175], v245 offset:736
    v_mfma_f32_16x16x32_bf16 v[12:15], v[156:159], v[108:111], v[12:15]
    v_mfma_f32_16x16x32_bf16 v[44:47], v[156:159], v[112:115], v[44:47]
    s_add_u32 s44, s37, 8192
    s_add_u32 m0, s38, 33792
    s_nop 0
    buffer_load_dwordx4 v241, s[16:19], s44 offen nt lds
    s_add_u32 m0, m0, 800
    s_nop 0
    buffer_load_dwordx4 v241, s[16:19], s44 offen offset:256 nt lds
    s_add_u32 s44, s37, 8192
    s_add_u32 m0, s38, 42240
    s_nop 0
    buffer_load_dwordx4 v241, s[24:27], s44 offen nt lds
    s_add_u32 m0, m0, 800
    s_nop 0
    buffer_load_dwordx4 v241, s[24:27], s44 offen offset:256 nt lds
    s_waitcnt lgkmcnt(0)
    s_waitcnt vmcnt(15)
    s_barrier
    v_add_u32 v245, 112128, v242
    v_add_u32 v246, 128768, v243
    v_subrev_u32 v200, s34, v246
    v_mfma_f32_16x16x32_bf16 v[16:19], v[160:163], v[108:111], v[16:19]
    ds_read_b64_tr_b16 v[144:145], v245 offset:0
    ds_read_b64_tr_b16 v[146:147], v245 offset:512
    v_mfma_f32_16x16x32_bf16 v[48:51], v[160:163], v[112:115], v[48:51]
    ds_read_b128 v[96:99], v246 offset:0
    v_mfma_f32_16x16x32_bf16 v[20:23], v[164:167], v[108:111], v[20:23]
    ds_read_b128 v[100:103], v246 offset:2048
    ds_read_b128 v[104:107], v200
    v_mfma_f32_16x16x32_bf16 v[52:55], v[164:167], v[112:115], v[52:55]
    ds_read_b64_tr_b16 v[148:149], v245 offset:32
    v_mfma_f32_16x16x32_bf16 v[24:27], v[168:171], v[108:111], v[24:27]
    ds_read_b64_tr_b16 v[150:151], v245 offset:544
    ds_read_b64_tr_b16 v[152:153], v245 offset:64
    v_mfma_f32_16x16x32_bf16 v[56:59], v[168:171], v[112:115], v[56:59]
    ds_read_b64_tr_b16 v[154:155], v245 offset:576
    v_mfma_f32_16x16x32_bf16 v[88:91], v[168:171], v[116:119], v[88:91]
    ds_read_b64_tr_b16 v[156:157], v245 offset:96
    ds_read_b64_tr_b16 v[158:159], v245 offset:608
    v_mfma_f32_16x16x32_bf16 v[28:31], v[172:175], v[108:111], v[28:31]
    v_mfma_f32_16x16x32_bf16 v[60:63], v[172:175], v[112:115], v[60:63]
    v_mfma_f32_16x16x32_bf16 v[92:95], v[172:175], v[116:119], v[92:95]
    s_waitcnt lgkmcnt(4)
    v_mfma_f32_16x16x32_bf16 v[0:3], v[144:147], v[96:99], v[0:3]
    ds_read_b64_tr_b16 v[160:161], v245 offset:128
    v_mfma_f32_16x16x32_bf16 v[32:35], v[144:147], v[100:103], v[32:35]
    ds_read_b64_tr_b16 v[162:163], v245 offset:640
    ds_read_b64_tr_b16 v[164:165], v245 offset:160
    v_mfma_f32_16x16x32_bf16 v[4:7], v[148:151], v[96:99], v[4:7]
    ds_read_b64_tr_b16 v[166:167], v245 offset:672
    v_mfma_f32_16x16x32_bf16 v[36:39], v[148:151], v[100:103], v[36:39]
    ds_read_b64_tr_b16 v[168:169], v245 offset:192
    s_waitcnt lgkmcnt(5)
    v_mfma_f32_16x16x32_bf16 v[8:11], v[152:155], v[96:99], v[8:11]
    ds_read_b64_tr_b16 v[170:171], v245 offset:704
    ds_read_b64_tr_b16 v[172:173], v245 offset:224
    v_mfma_f32_16x16x32_bf16 v[40:43], v[152:155], v[100:103], v[40:43]
    ds_read_b64_tr_b16 v[174:175], v245 offset:736
    v_mfma_f32_16x16x32_bf16 v[12:15], v[156:159], v[96:99], v[12:15]
    v_mfma_f32_16x16x32_bf16 v[44:47], v[156:159], v[100:103], v[44:47]
    s_add_u32 s44, s37, 270336
    s_add_u32 m0, s38, 50688
    s_nop 0
    buffer_load_dwordx4 v241, s[16:19], s44 offen nt lds
    s_add_u32 m0, m0, 800
    s_nop 0
    buffer_load_dwordx4 v241, s[16:19], s44 offen offset:256 nt lds
    s_waitcnt lgkmcnt(0)
    s_waitcnt vmcnt(15)
    s_barrier
    v_add_u32 v245, 147200, v242
    v_add_u32 v246, 128768, v244
    v_subrev_u32 v200, s34, v246
    v_mfma_f32_16x16x32_bf16 v[16:19], v[160:163], v[96:99], v[16:19]
    ds_read_b64_tr_b16 v[144:145], v245 offset:0
    ds_read_b64_tr_b16 v[146:147], v245 offset:512
    v_mfma_f32_16x16x32_bf16 v[48:51], v[160:163], v[100:103], v[48:51]
    ds_read_b128 v[108:111], v246 offset:0
    v_mfma_f32_16x16x32_bf16 v[20:23], v[164:167], v[96:99], v[20:23]
    ds_read_b128 v[112:115], v246 offset:2048
    ds_read_b128 v[116:119], v200
    v_mfma_f32_16x16x32_bf16 v[52:55], v[164:167], v[100:103], v[52:55]
    ds_read_b64_tr_b16 v[148:149], v245 offset:32
    v_mfma_f32_16x16x32_bf16 v[24:27], v[168:171], v[96:99], v[24:27]
    ds_read_b64_tr_b16 v[150:151], v245 offset:544
    ds_read_b64_tr_b16 v[152:153], v245 offset:64
    v_mfma_f32_16x16x32_bf16 v[56:59], v[168:171], v[100:103], v[56:59]
    ds_read_b64_tr_b16 v[154:155], v245 offset:576
    v_mfma_f32_16x16x32_bf16 v[88:91], v[168:171], v[104:107], v[88:91]
    ds_read_b64_tr_b16 v[156:157], v245 offset:96
    ds_read_b64_tr_b16 v[158:159], v245 offset:608
    v_mfma_f32_16x16x32_bf16 v[28:31], v[172:175], v[96:99], v[28:31]
    v_mfma_f32_16x16x32_bf16 v[60:63], v[172:175], v[100:103], v[60:63]
    v_mfma_f32_16x16x32_bf16 v[92:95], v[172:175], v[104:107], v[92:95]
    s_waitcnt lgkmcnt(4)
    v_mfma_f32_16x16x32_bf16 v[0:3], v[144:147], v[108:111], v[0:3]
    ds_read_b64_tr_b16 v[160:161], v245 offset:128
    v_mfma_f32_16x16x32_bf16 v[32:35], v[144:147], v[112:115], v[32:35]
    ds_read_b64_tr_b16 v[162:163], v245 offset:640
    ds_read_b64_tr_b16 v[164:165], v245 offset:160
    v_mfma_f32_16x16x32_bf16 v[4:7], v[148:151], v[108:111], v[4:7]
    ds_read_b64_tr_b16 v[166:167], v245 offset:672
    v_mfma_f32_16x16x32_bf16 v[36:39], v[148:151], v[112:115], v[36:39]
    ds_read_b64_tr_b16 v[168:169], v245 offset:192
    s_waitcnt lgkmcnt(5)
    v_mfma_f32_16x16x32_bf16 v[8:11], v[152:155], v[108:111], v[8:11]
    ds_read_b64_tr_b16 v[170:171], v245 offset:704
    ds_read_b64_tr_b16 v[172:173], v245 offset:224
    v_mfma_f32_16x16x32_bf16 v[40:43], v[152:155], v[112:115], v[40:43]
    ds_read_b64_tr_b16 v[174:175], v245 offset:736
    v_mfma_f32_16x16x32_bf16 v[12:15], v[156:159], v[108:111], v[12:15]
    v_mfma_f32_16x16x32_bf16 v[44:47], v[156:159], v[112:115], v[44:47]
    s_add_u32 s44, s37, 270336
    s_add_u32 m0, s38, 59136
    s_nop 0
    buffer_load_dwordx4 v241, s[24:27], s44 offen nt lds
    s_add_u32 m0, m0, 800
    s_nop 0
    buffer_load_dwordx4 v241, s[24:27], s44 offen offset:256 nt lds
    s_add_u32 s44, s37, 16384
    s_add_u32 m0, s38, 67584
    s_nop 0
    buffer_load_dwordx4 v241, s[16:19], s44 offen nt lds
    s_add_u32 m0, m0, 800
    s_nop 0
    buffer_load_dwordx4 v241, s[16:19], s44 offen offset:256 nt lds
    s_waitcnt lgkmcnt(0)
    s_barrier
    v_mfma_f32_16x16x32_bf16 v[16:19], v[160:163], v[108:111], v[16:19]
    v_mfma_f32_16x16x32_bf16 v[48:51], v[160:163], v[112:115], v[48:51]
    v_mfma_f32_16x16x32_bf16 v[20:23], v[164:167], v[108:111], v[20:23]
    v_mfma_f32_16x16x32_bf16 v[52:55], v[164:167], v[112:115], v[52:55]
    v_mfma_f32_16x16x32_bf16 v[24:27], v[168:171], v[108:111], v[24:27]
    v_mfma_f32_16x16x32_bf16 v[56:59], v[168:171], v[112:115], v[56:59]
    v_mfma_f32_16x16x32_bf16 v[88:91], v[168:171], v[116:119], v[88:91]
    v_mfma_f32_16x16x32_bf16 v[28:31], v[172:175], v[108:111], v[28:31]
    v_mfma_f32_16x16x32_bf16 v[60:63], v[172:175], v[112:115], v[60:63]
    v_mfma_f32_16x16x32_bf16 v[92:95], v[172:175], v[116:119], v[92:95]
    v_mov_b32 v244, v220
    v_mov_b32 v245, v221
    v_mov_b32 v246, v222
    v_mov_b32 v248, v202
    s_mov_b32 s76, 0
    s_waitcnt vmcnt(18)
wl_rg:
    v_readfirstlane_b32 s44, v184
    s_nop 0
    s_cmp_eq_u32 s44, 16
    s_cbranch_scc1 wl_rg_ok
    s_sleep 16
    buffer_load_dword v184, off, s[88:91], s35 sc1
    s_waitcnt vmcnt(0)
    s_branch wl_rg
wl_rg_ok:
    v_pk_mul_f32 v[88:89], v[88:89], s[56:57]
    v_pk_mul_f32 v[90:91], v[90:91], s[56:57]
    v_pk_mul_f32 v[92:93], v[92:93], s[56:57]
    v_pk_mul_f32 v[94:95], v[94:95], s[56:57]
    v_cvt_pk_bf16_f32 v140, v88, v89
    v_cvt_pk_bf16_f32 v141, v90, v91
    v_cvt_pk_bf16_f32 v142, v92, v93
    v_cvt_pk_bf16_f32 v143, v94, v95
    s_nop 0
    v_permlane32_swap_b32 v140, v142
    s_nop 0
    v_permlane32_swap_b32 v141, v143
    s_nop 0
    v_permlane16_swap_b32 v140, v142
    s_nop 0
    v_permlane16_swap_b32 v141, v143
    ds_write_b128 v249, v[140:143]
    v_pk_mul_f32 v[0:1], v[0:1], s[56:57]
    v_pk_mul_f32 v[2:3], v[2:3], s[56:57]
    v_pk_mul_f32 v[4:5], v[4:5], s[56:57]
    v_pk_mul_f32 v[6:7], v[6:7], s[56:57]
    v_pk_mul_f32 v[8:9], v[8:9], s[56:57]
    v_pk_mul_f32 v[10:11], v[10:11], s[56:57]
    v_pk_mul_f32 v[12:13], v[12:13], s[56:57]
    v_pk_mul_f32 v[14:15], v[14:15], s[56:57]
    v_pk_mul_f32 v[16:17], v[16:17], s[56:57]
    v_pk_mul_f32 v[18:19], v[18:19], s[56:57]
    v_pk_mul_f32 v[20:21], v[20:21], s[56:57]
    v_pk_mul_f32 v[22:23], v[22:23], s[56:57]
    v_pk_mul_f32 v[24:25], v[24:25], s[56:57]
    v_pk_mul_f32 v[26:27], v[26:27], s[56:57]
    v_pk_mul_f32 v[28:29], v[28:29], s[56:57]
    v_pk_mul_f32 v[30:31], v[30:31], s[56:57]
    v_pk_mul_f32 v[32:33], v[32:33], s[56:57]
    v_pk_mul_f32 v[34:35], v[34:35], s[56:57]
    v_pk_mul_f32 v[36:37], v[36:37], s[56:57]
    v_pk_mul_f32 v[38:39], v[38:39], s[56:57]
    v_pk_mul_f32 v[40:41], v[40:41], s[56:57]
    v_pk_mul_f32 v[42:43], v[42:43], s[56:57]
    v_pk_mul_f32 v[44:45], v[44:45], s[56:57]
    v_pk_mul_f32 v[46:47], v[46:47], s[56:57]
    v_pk_mul_f32 v[48:49], v[48:49], s[56:57]
    v_pk_mul_f32 v[50:51], v[50:51], s[56:57]
    v_pk_mul_f32 v[52:53], v[52:53], s[56:57]
    v_pk_mul_f32 v[54:55], v[54:55], s[56:57]
    v_pk_mul_f32 v[56:57], v[56:57], s[56:57]
    v_pk_mul_f32 v[58:59], v[58:59], s[56:57]
    v_pk_mul_f32 v[60:61], v[60:61], s[56:57]
    v_pk_mul_f32 v[62:63], v[62:63], s[56:57]
    v_cvt_pk_bf16_f32 v96, v0, v1
    v_cvt_pk_bf16_f32 v97, v2, v3
    v_cvt_pk_bf16_f32 v98, v4, v5
    v_cvt_pk_bf16_f32 v99, v6, v7
    v_cvt_pk_bf16_f32 v100, v8, v9
    v_cvt_pk_bf16_f32 v101, v10, v11
    v_cvt_pk_bf16_f32 v102, v12, v13
    v_cvt_pk_bf16_f32 v103, v14, v15
    v_cvt_pk_bf16_f32 v104, v16, v17
    v_cvt_pk_bf16_f32 v105, v18, v19
    v_cvt_pk_bf16_f32 v106, v20, v21
    v_cvt_pk_bf16_f32 v107, v22, v23
    v_cvt_pk_bf16_f32 v108, v24, v25
    v_cvt_pk_bf16_f32 v109, v26, v27
    v_cvt_pk_bf16_f32 v110, v28, v29
    v_cvt_pk_bf16_f32 v111, v30, v31
    v_cvt_pk_bf16_f32 v112, v32, v33
    v_cvt_pk_bf16_f32 v113, v34, v35
    v_cvt_pk_bf16_f32 v114, v36, v37
    v_cvt_pk_bf16_f32 v115, v38, v39
    v_cvt_pk_bf16_f32 v116, v40, v41
    v_cvt_pk_bf16_f32 v117, v42, v43
    v_cvt_pk_bf16_f32 v118, v44, v45
    v_cvt_pk_bf16_f32 v119, v46, v47
    v_cvt_pk_bf16_f32 v120, v48, v49
    v_cvt_pk_bf16_f32 v121, v50, v51
    v_cvt_pk_bf16_f32 v122, v52, v53
    v_cvt_pk_bf16_f32 v123, v54, v55
    v_cvt_pk_bf16_f32 v124, v56, v57
    v_cvt_pk_bf16_f32 v125, v58, v59
    v_cvt_pk_bf16_f32 v126, v60, v61
    v_cvt_pk_bf16_f32 v127, v62, v63
    v_permlane32_swap_b32 v96, v98
    v_permlane32_swap_b32 v97, v99
    v_permlane32_swap_b32 v100, v102
    v_permlane32_swap_b32 v101, v103
    v_permlane32_swap_b32 v104, v106
    v_permlane32_swap_b32 v105, v107
    v_permlane32_swap_b32 v108, v110
    v_permlane32_swap_b32 v109, v111
    v_permlane32_swap_b32 v112, v114
    v_permlane32_swap_b32 v113, v115
    v_permlane32_swap_b32 v116, v118
    v_permlane32_swap_b32 v117, v119
    v_permlane32_swap_b32 v120, v122
    v_permlane32_swap_b32 v121, v123
    v_permlane32_swap_b32 v124, v126
    v_permlane32_swap_b32 v125, v127
    v_permlane16_swap_b32 v96, v98
    v_permlane16_swap_b32 v97, v99
    v_permlane16_swap_b32 v100, v102
    v_permlane16_swap_b32 v101, v103
    v_permlane16_swap_b32 v104, v106
    v_permlane16_swap_b32 v105, v107
    v_permlane16_swap_b32 v108, v110
    v_permlane16_swap_b32 v109, v111
    v_permlane16_swap_b32 v112, v114
    v_permlane16_swap_b32 v113, v115
    v_permlane16_swap_b32 v116, v118
    v_permlane16_swap_b32 v117, v119
    v_permlane16_swap_b32 v120, v122
    v_permlane16_swap_b32 v121, v123
    v_permlane16_swap_b32 v124, v126
    v_permlane16_swap_b32 v125, v127
    v_mov_b64 v[0:1], 0
    v_mov_b64 v[2:3], 0
    v_mov_b64 v[4:5], 0
    v_mov_b64 v[6:7], 0
    v_mov_b64 v[8:9], 0
    v_mov_b64 v[10:11], 0
    v_mov_b64 v[12:13], 0
    v_mov_b64 v[14:15], 0
    v_mov_b64 v[16:17], 0
    v_mov_b64 v[18:19], 0
    v_mov_b64 v[20:21], 0
    v_mov_b64 v[22:23], 0
    v_mov_b64 v[24:25], 0
    v_mov_b64 v[26:27], 0
    v_mov_b64 v[28:29], 0
    v_mov_b64 v[30:31], 0
    v_mov_b64 v[220:221], 0
    v_mov_b64 v[222:223], 0
    v_mov_b32 v232, 0
    v_mov_b64 v[32:33], 0
    v_mov_b64 v[34:35], 0
    v_mov_b64 v[36:37], 0
    v_mov_b64 v[38:39], 0
    v_mov_b64 v[40:41], 0
    v_mov_b64 v[42:43], 0
    v_mov_b64 v[44:45], 0
    v_mov_b64 v[46:47], 0
    v_mov_b64 v[48:49], 0
    v_mov_b64 v[50:51], 0
    v_mov_b64 v[52:53], 0
    v_mov_b64 v[54:55], 0
    v_mov_b64 v[56:57], 0
    v_mov_b64 v[58:59], 0
    v_mov_b64 v[60:61], 0
    v_mov_b64 v[62:63], 0
    v_mov_b64 v[224:225], 0
    v_mov_b64 v[226:227], 0
    v_mov_b32 v233, 0
    v_mov_b64 v[212:213], 0
    v_mov_b64 v[214:215], 0
    s_add_u32 s44, s37, 16384
    s_add_u32 m0, s38, 76032
    s_nop 0
    buffer_load_dwordx4 v241, s[24:27], s44 offen nt lds
    s_add_u32 m0, m0, 800
    s_nop 0
    buffer_load_dwordx4 v241, s[24:27], s44 offen offset:256 nt lds
    s_add_u32 s44, s37, 278528
    s_add_u32 m0, s38, 84480
    s_nop 0
    buffer_load_dwordx4 v241, s[16:19], s44 offen nt lds
    s_add_u32 m0, m0, 800
    s_nop 0
    buffer_load_dwordx4 v241, s[16:19], s44 offen offset:256 nt lds
    s_add_u32 s44, s37, 278528
    s_add_u32 m0, s38, 92928
    s_nop 0
    buffer_load_dwordx4 v241, s[24:27], s44 offen nt lds
    s_add_u32 m0, m0, 800
    s_nop 0
    buffer_load_dwordx4 v241, s[24:27], s44 offen offset:256 nt lds
    s_add_u32 s37, s37, 8192
    s_mov_b32 s39, 33792
    s_mov_b32 s54, 67584
    s_mov_b32 s41, 0
    s_mov_b32 s40, 0
    s_mov_b32 s42, 0xbf800000
    s_mov_b32 s43, 0xff800000
    s_waitcnt lgkmcnt(0)
    s_mov_b32 s12, s4
    s_mov_b32 s13, s5
    s_mov_b32 s8, s6
    s_mov_b32 s9, s7
    s_barrier
wl_loop:
    s_cmp_lt_u32 s41, 2
    s_cbranch_scc1 wl_lw
    s_waitcnt vmcnt(4)
wl_lw:
    s_waitcnt vmcnt(16)
    s_barrier
    v_add_u32 v237, s40, v239
    v_mfma_f32_16x16x32_bf16 v[32:35], v[144:147], v[212:215], v[32:35]
    ds_read_b128 v[144:147], v237 offset:0
    v_add_u32 v238, s40, v240
    s_sub_u32 s44, s41, 2
    v_mfma_f32_16x16x32_bf16 v[36:39], v[148:151], v[212:215], v[36:39]
    ds_read_b128 v[148:151], v237 offset:64
    s_cmp_ge_u32 s44, 29
    s_cselect_b32 s44, 0x10000000, s37
    v_mfma_f32_16x16x32_bf16 v[40:43], v[152:155], v[212:215], v[40:43]
    ds_read_b128 v[152:155], v237 offset:128
    s_cselect_b32 s99, 163840, s39
    v_mfma_f32_16x16x32_bf16 v[44:47], v[156:159], v[212:215], v[44:47]
    ds_read_b128 v[156:159], v237 offset:192
    s_add_u32 s99, s99, s38
    s_add_u32 s45, s44, 262144
    v_mfma_f32_16x16x32_bf16 v[48:51], v[160:163], v[212:215], v[48:51]
    ds_read_b128 v[160:163], v237 offset:512
    s_add_u32 s37, s37, 8192
    s_sub_u32 s55, s41, 1
    v_mfma_f32_16x16x32_bf16 v[52:55], v[164:167], v[212:215], v[52:55]
    ds_read_b128 v[164:167], v237 offset:576
    s_cmp_ge_u32 s55, 29
    s_cselect_b32 s55, 0x10000000, s37
    v_mfma_f32_16x16x32_bf16 v[56:59], v[168:171], v[212:215], v[56:59]
    ds_read_b128 v[168:171], v237 offset:640
    s_cselect_b32 s81, 163840, s54
    s_add_u32 s81, s81, s38
    v_mfma_f32_16x16x32_bf16 v[60:63], v[172:175], v[212:215], v[60:63]
    ds_read_b128 v[172:175], v237 offset:704
    s_add_u32 m0, s99, 16896
    s_nop 0
    buffer_load_dwordx4 v241, s[16:19], s45 offen nt lds
    s_waitcnt lgkmcnt(6)
    v_mfma_f32_16x16x32_bf16 v[176:179], v[144:147], v[96:99], v[220:223]
    s_add_u32 m0, m0, 800
    s_nop 0
    buffer_load_dwordx4 v241, s[16:19], s45 offen offset:256 nt lds
    v_mfma_f32_16x16x32_bf16 v[176:179], v[148:151], v[100:103], v[176:179]
    s_add_u32 m0, s99, 25344
    s_nop 0
    buffer_load_dwordx4 v241, s[24:27], s45 offen nt lds
    s_add_u32 m0, m0, 800
    s_waitcnt lgkmcnt(4)
    v_mfma_f32_16x16x32_bf16 v[176:179], v[152:155], v[104:107], v[176:179]
    buffer_load_dwordx4 v241, s[24:27], s45 offen offset:256 nt lds
    s_add_u32 m0, s81, 0
    s_nop 0
    buffer_load_dwordx4 v241, s[16:19], s55 offen nt lds
    v_mfma_f32_16x16x32_bf16 v[176:179], v[156:159], v[108:111], v[176:179]
    s_add_u32 m0, m0, 800
    s_nop 0
    buffer_load_dwordx4 v241, s[16:19], s55 offen offset:256 nt lds
    s_add_u32 m0, s81, 8448
    s_waitcnt lgkmcnt(2)
    v_mfma_f32_16x16x32_bf16 v[180:183], v[160:163], v[96:99], v[220:223]
    buffer_load_dwordx4 v241, s[24:27], s55 offen nt lds
    s_add_u32 m0, m0, 800
    s_nop 0
    buffer_load_dwordx4 v241, s[24:27], s55 offen offset:256 nt lds
    v_mfma_f32_16x16x32_bf16 v[180:183], v[164:167], v[100:103], v[180:183]
    s_mov_b32 s39, s54
    s_add_u32 s54, s54, 33792
    s_waitcnt lgkmcnt(0)
    v_mfma_f32_16x16x32_bf16 v[180:183], v[168:171], v[104:107], v[180:183]
    s_cmp_ge_u32 s54, 135168
    s_cselect_b32 s54, 0, s54
    s_add_u32 s41, s41, 1
    v_mfma_f32_16x16x32_bf16 v[180:183], v[172:175], v[108:111], v[180:183]
    s_add_u32 s40, s40, 33792
    s_cmp_ge_u32 s40, 135168
    s_cselect_b32 s40, 0, s40
    v_mfma_f32_16x16x32_bf16 v[184:187], v[144:147], v[112:115], v[224:227]
    ds_read_b64_tr_b16 v[144:145], v238 offset:0
    ds_read_b64_tr_b16 v[146:147], v238 offset:512
    v_exp_f32 v200, v176
    v_exp_f32 v201, v177
    v_mfma_f32_16x16x32_bf16 v[184:187], v[148:151], v[116:119], v[184:187]
    ds_read_b64_tr_b16 v[148:149], v238 offset:32
    ds_read_b64_tr_b16 v[150:151], v238 offset:544
    v_exp_f32 v202, v178
    v_exp_f32 v203, v179
    v_mfma_f32_16x16x32_bf16 v[184:187], v[152:155], v[120:123], v[184:187]
    ds_read_b64_tr_b16 v[152:153], v238 offset:64
    ds_read_b64_tr_b16 v[154:155], v238 offset:576
    v_add_f32 v235, v200, v201
    v_add_f32 v236, v202, v203
    v_cvt_pk_bf16_f32 v208, v200, v201
    v_cvt_pk_bf16_f32 v209, v202, v203
    v_mfma_f32_16x16x32_bf16 v[184:187], v[156:159], v[124:127], v[184:187]
    ds_read_b64_tr_b16 v[156:157], v238 offset:96
    ds_read_b64_tr_b16 v[158:159], v238 offset:608
    v_exp_f32 v204, v180
    v_exp_f32 v205, v181
    v_mfma_f32_16x16x32_bf16 v[188:191], v[160:163], v[112:115], v[224:227]
    ds_read_b64_tr_b16 v[160:161], v238 offset:128
    ds_read_b64_tr_b16 v[162:163], v238 offset:640
    v_add_f32 v235, v235, v236
    v_exp_f32 v206, v182
    v_add_f32 v236, v204, v205
    v_mfma_f32_16x16x32_bf16 v[188:191], v[164:167], v[116:119], v[188:191]
    ds_read_b64_tr_b16 v[164:165], v238 offset:160
    ds_read_b64_tr_b16 v[166:167], v238 offset:672
    v_exp_f32 v207, v183
    v_add_f32 v235, v235, v206
    v_add_f32 v236, v236, v207
    v_mfma_f32_16x16x32_bf16 v[188:191], v[168:171], v[120:123], v[188:191]
    ds_read_b64_tr_b16 v[168:169], v238 offset:192
    ds_read_b64_tr_b16 v[170:171], v238 offset:704
    v_cvt_pk_bf16_f32 v210, v204, v205
    v_add_f32 v235, v235, v236
    v_cvt_pk_bf16_f32 v211, v206, v207
    v_cmp_nge_f32 vcc, s42, v235
    v_mfma_f32_16x16x32_bf16 v[188:191], v[172:175], v[124:127], v[188:191]
    ds_read_b64_tr_b16 v[172:173], v238 offset:224
    ds_read_b64_tr_b16 v[174:175], v238 offset:736
    s_cbranch_vccnz wl_rare0
wl_back0:
    v_add_f32 v232, v232, v235
    s_waitcnt lgkmcnt(12)
    v_mfma_f32_16x16x32_bf16 v[0:3], v[144:147], v[208:211], v[0:3]
    v_exp_f32 v200, v184
    v_exp_f32 v201, v185
    v_mfma_f32_16x16x32_bf16 v[4:7], v[148:151], v[208:211], v[4:7]
    v_exp_f32 v202, v186
    v_exp_f32 v203, v187
    s_waitcnt lgkmcnt(8)
    v_mfma_f32_16x16x32_bf16 v[8:11], v[152:155], v[208:211], v[8:11]
    v_add_f32 v242, v200, v201
    v_add_f32 v236, v202, v203
    v_cvt_pk_bf16_f32 v212, v200, v201
    v_cvt_pk_bf16_f32 v213, v202, v203
    v_mfma_f32_16x16x32_bf16 v[12:15], v[156:159], v[208:211], v[12:15]
    v_exp_f32 v204, v188
    v_exp_f32 v205, v189
    s_waitcnt lgkmcnt(4)
    v_mfma_f32_16x16x32_bf16 v[16:19], v[160:163], v[208:211], v[16:19]
    v_add_f32 v242, v242, v236
    v_exp_f32 v206, v190
    v_add_f32 v236, v204, v205
    v_mfma_f32_16x16x32_bf16 v[20:23], v[164:167], v[208:211], v[20:23]
    v_exp_f32 v207, v191
    v_add_f32 v242, v242, v206
    v_add_f32 v236, v236, v207
    s_waitcnt lgkmcnt(0)
    v_mfma_f32_16x16x32_bf16 v[24:27], v[168:171], v[208:211], v[24:27]
    v_cvt_pk_bf16_f32 v214, v204, v205
    v_add_f32 v242, v242, v236
    v_cvt_pk_bf16_f32 v215, v206, v207
    v_cmp_nge_f32 vcc, s42, v242
    v_mfma_f32_16x16x32_bf16 v[28:31], v[172:175], v[208:211], v[28:31]
    s_cbranch_vccnz wl_rare1
wl_back1:
    v_add_f32 v233, v233, v242
    s_cmp_lt_u32 s41, 30
    s_waitcnt lgkmcnt(0)
    s_cbranch_scc1 wl_loop
    s_cmp_lt_u32 s30, 2
    s_cbranch_scc1 wl_pa
    s_add_u32 m0, s76, s78
    s_nop 0
    buffer_load_dwordx4 v244, s[12:15], s77 offen lds
wl_pa:
    s_add_u32 m0, s76, s79
    s_nop 0
    buffer_load_dwordx4 v245, s[12:15], s77 offen lds
    s_add_u32 m0, s76, s80
    s_nop 0
    buffer_load_dwordx4 v246, s[12:15], s77 offen lds
    s_add_u32 s76, s76, 19456
    s_add_u32 s77, s77, 73728
    s_cmp_lg_u32 s41, 31
    s_cbranch_scc1 wl_pf1
    s_cmp_lt_u32 s30, 2
    s_cbranch_scc1 wl_pb
    s_add_u32 m0, s76, s78
    s_nop 0
    buffer_load_dwordx4 v244, s[12:15], s77 offen lds
wl_pb:
    s_add_u32 m0, s76, s79
    s_nop 0
    buffer_load_dwordx4 v245, s[12:15], s77 offen lds
    s_add_u32 m0, s76, s80
    s_nop 0
    buffer_load_dwordx4 v246, s[12:15], s77 offen lds
    s_add_u32 s76, s76, 19456
    s_add_u32 s77, s77, 73728
wl_pf1:
    s_cmp_lt_u32 s41, 32
    s_cbranch_scc1 wl_loop
    v_mfma_f32_16x16x32_bf16 v[32:35], v[144:147], v[212:215], v[32:35]
    v_mfma_f32_16x16x32_bf16 v[36:39], v[148:151], v[212:215], v[36:39]
    v_mfma_f32_16x16x32_bf16 v[40:43], v[152:155], v[212:215], v[40:43]
    v_mfma_f32_16x16x32_bf16 v[44:47], v[156:159], v[212:215], v[44:47]
    v_mfma_f32_16x16x32_bf16 v[48:51], v[160:163], v[212:215], v[48:51]
    v_mfma_f32_16x16x32_bf16 v[52:55], v[164:167], v[212:215], v[52:55]
    v_mfma_f32_16x16x32_bf16 v[56:59], v[168:171], v[212:215], v[56:59]
    v_mfma_f32_16x16x32_bf16 v[60:63], v[172:175], v[212:215], v[60:63]
    v_mov_b32 v252, v232
    s_nop 1
    v_permlane32_swap_b32 v232, v252
    v_add_f32 v232, v232, v252
    v_mov_b32 v252, v232
    s_nop 1
    v_permlane16_swap_b32 v232, v252
    v_add_f32 v232, v232, v252
    v_rcp_f32 v232, v232
    v_mov_b32 v252, v233
    s_nop 1
    v_permlane32_swap_b32 v233, v252
    v_add_f32 v233, v233, v252
    v_mov_b32 v252, v233
    s_nop 1
    v_permlane16_swap_b32 v233, v252
    v_add_f32 v233, v233, v252
    v_rcp_f32 v233, v233
    s_mul_i32 s44, s32, 38912
    s_add_u32 s44, s44, 77824
    s_lshl_b32 s45, s36, 11
    s_add_u32 s44, s44, s45
    v_add_u32 v253, s44, v254
    v_mov_b32 v176, v232
    v_pk_mul_f32 v[0:1], v[0:1], v[176:177] op_sel_hi:[1,0]
    v_pk_mul_f32 v[2:3], v[2:3], v[176:177] op_sel_hi:[1,0]
    v_pk_mul_f32 v[4:5], v[4:5], v[176:177] op_sel_hi:[1,0]
    v_pk_mul_f32 v[6:7], v[6:7], v[176:177] op_sel_hi:[1,0]
    v_pk_mul_f32 v[8:9], v[8:9], v[176:177] op_sel_hi:[1,0]
    v_pk_mul_f32 v[10:11], v[10:11], v[176:177] op_sel_hi:[1,0]
    v_pk_mul_f32 v[12:13], v[12:13], v[176:177] op_sel_hi:[1,0]
    v_pk_mul_f32 v[14:15], v[14:15], v[176:177] op_sel_hi:[1,0]
    v_pk_mul_f32 v[16:17], v[16:17], v[176:177] op_sel_hi:[1,0]
    v_pk_mul_f32 v[18:19], v[18:19], v[176:177] op_sel_hi:[1,0]
    v_pk_mul_f32 v[20:21], v[20:21], v[176:177] op_sel_hi:[1,0]
    v_pk_mul_f32 v[22:23], v[22:23], v[176:177] op_sel_hi:[1,0]
    v_pk_mul_f32 v[24:25], v[24:25], v[176:177] op_sel_hi:[1,0]
    v_pk_mul_f32 v[26:27], v[26:27], v[176:177] op_sel_hi:[1,0]
    v_pk_mul_f32 v[28:29], v[28:29], v[176:177] op_sel_hi:[1,0]
    v_pk_mul_f32 v[30:31], v[30:31], v[176:177] op_sel_hi:[1,0]
    v_cvt_pk_bf16_f32 v96, v0, v1
    v_cvt_pk_bf16_f32 v97, v2, v3
    v_cvt_pk_bf16_f32 v98, v4, v5
    v_cvt_pk_bf16_f32 v99, v6, v7
    v_cvt_pk_bf16_f32 v100, v8, v9
    v_cvt_pk_bf16_f32 v101, v10, v11
    v_cvt_pk_bf16_f32 v102, v12, v13
    v_cvt_pk_bf16_f32 v103, v14, v15
    v_cvt_pk_bf16_f32 v104, v16, v17
    v_cvt_pk_bf16_f32 v105, v18, v19
    v_cvt_pk_bf16_f32 v106, v20, v21
    v_cvt_pk_bf16_f32 v107, v22, v23
    v_cvt_pk_bf16_f32 v108, v24, v25
    v_cvt_pk_bf16_f32 v109, v26, v27
    v_cvt_pk_bf16_f32 v110, v28, v29
    v_cvt_pk_bf16_f32 v111, v30, v31
    s_add_u32 s44, s86, 18432
    buffer_store_dwordx4 v[96:99], v254, s[20:23], s86 offen offset:0 sc1
    buffer_store_dwordx4 v[100:103], v254, s[20:23], s86 offen offset:1024 sc1
    buffer_store_dwordx4 v[104:107], v254, s[20:23], s44 offen offset:0 sc1
    buffer_store_dwordx4 v[108:111], v254, s[20:23], s44 offen offset:1024 sc1
    s_add_u32 s86, s86, 2048
    v_mov_b32 v176, v233
    v_pk_mul_f32 v[32:33], v[32:33], v[176:177] op_sel_hi:[1,0]
    v_pk_mul_f32 v[34:35], v[34:35], v[176:177] op_sel_hi:[1,0]
    v_pk_mul_f32 v[36:37], v[36:37], v[176:177] op_sel_hi:[1,0]
    v_pk_mul_f32 v[38:39], v[38:39], v[176:177] op_sel_hi:[1,0]
    v_pk_mul_f32 v[40:41], v[40:41], v[176:177] op_sel_hi:[1,0]
    v_pk_mul_f32 v[42:43], v[42:43], v[176:177] op_sel_hi:[1,0]
    v_pk_mul_f32 v[44:45], v[44:45], v[176:177] op_sel_hi:[1,0]
    v_pk_mul_f32 v[46:47], v[46:47], v[176:177] op_sel_hi:[1,0]
    v_pk_mul_f32 v[48:49], v[48:49], v[176:177] op_sel_hi:[1,0]
    v_pk_mul_f32 v[50:51], v[50:51], v[176:177] op_sel_hi:[1,0]
    v_pk_mul_f32 v[52:53], v[52:53], v[176:177] op_sel_hi:[1,0]
    v_pk_mul_f32 v[54:55], v[54:55], v[176:177] op_sel_hi:[1,0]
    v_pk_mul_f32 v[56:57], v[56:57], v[176:177] op_sel_hi:[1,0]
    v_pk_mul_f32 v[58:59], v[58:59], v[176:177] op_sel_hi:[1,0]
    v_pk_mul_f32 v[60:61], v[60:61], v[176:177] op_sel_hi:[1,0]
    v_pk_mul_f32 v[62:63], v[62:63], v[176:177] op_sel_hi:[1,0]
    v_cvt_pk_bf16_f32 v112, v32, v33
    v_cvt_pk_bf16_f32 v113, v34, v35
    v_cvt_pk_bf16_f32 v114, v36, v37
    v_cvt_pk_bf16_f32 v115, v38, v39
    v_cvt_pk_bf16_f32 v116, v40, v41
    v_cvt_pk_bf16_f32 v117, v42, v43
    v_cvt_pk_bf16_f32 v118, v44, v45
    v_cvt_pk_bf16_f32 v119, v46, v47
    v_cvt_pk_bf16_f32 v120, v48, v49
    v_cvt_pk_bf16_f32 v121, v50, v51
    v_cvt_pk_bf16_f32 v122, v52, v53
    v_cvt_pk_bf16_f32 v123, v54, v55
    v_cvt_pk_bf16_f32 v124, v56, v57
    v_cvt_pk_bf16_f32 v125, v58, v59
    v_cvt_pk_bf16_f32 v126, v60, v61
    v_cvt_pk_bf16_f32 v127, v62, v63
    s_add_u32 s44, s86, 18432
    buffer_store_dwordx4 v[112:115], v254, s[20:23], s86 offen offset:0 sc1
    buffer_store_dwordx4 v[116:119], v254, s[20:23], s86 offen offset:1024 sc1
    buffer_store_dwordx4 v[120:123], v254, s[20:23], s44 offen offset:0 sc1
    buffer_store_dwordx4 v[124:127], v254, s[20:23], s44 offen offset:1024 sc1
    s_barrier
    ds_write_b128 v253, v[96:99] offset:0
    ds_write_b128 v253, v[100:103] offset:1024
    ds_write_b128 v253, v[104:107] offset:19456
    ds_write_b128 v253, v[108:111] offset:20480
    ds_write_b128 v253, v[112:115] offset:2048
    ds_write_b128 v253, v[116:119] offset:3072
    ds_write_b128 v253, v[120:123] offset:21504
    ds_write_b128 v253, v[124:127] offset:22528
    s_waitcnt vmcnt(8)
    s_branch op_entry
wl_rare0:
    s_nop 7
    v_max3_f32 v251, v176, v177, v178
    v_max3_f32 v251, v251, v179, v180
    v_max3_f32 v251, v251, v181, v182
    v_max_f32 v251, v251, v183
    v_mov_b32 v252, v251
    s_nop 1
    v_permlane32_swap_b32 v251, v252
    v_max_f32 v251, v251, v252
    v_mov_b32 v252, v251
    s_nop 1
    v_permlane16_swap_b32 v251, v252
    v_max_f32 v251, v251, v252
    v_max_f32 v251, s43, v251
    v_max_f32 v252, 0, v251
    v_exp_f32_e64 v252, -v252
    v_sub_f32 v220, v220, v251
    v_sub_f32 v221, v221, v251
    v_sub_f32 v222, v222, v251
    v_sub_f32 v223, v223, v251
    v_mul_f32 v232, v232, v252
    v_mul_f32 v0, v0, v252
    v_mul_f32 v1, v1, v252
    v_mul_f32 v2, v2, v252
    v_mul_f32 v3, v3, v252
    v_mul_f32 v4, v4, v252
    v_mul_f32 v5, v5, v252
    v_mul_f32 v6, v6, v252
    v_mul_f32 v7, v7, v252
    v_mul_f32 v8, v8, v252
    v_mul_f32 v9, v9, v252
    v_mul_f32 v10, v10, v252
    v_mul_f32 v11, v11, v252
    v_mul_f32 v12, v12, v252
    v_mul_f32 v13, v13, v252
    v_mul_f32 v14, v14, v252
    v_mul_f32 v15, v15, v252
    v_mul_f32 v16, v16, v252
    v_mul_f32 v17, v17, v252
    v_mul_f32 v18, v18, v252
    v_mul_f32 v19, v19, v252
    v_mul_f32 v20, v20, v252
    v_mul_f32 v21, v21, v252
    v_mul_f32 v22, v22, v252
    v_mul_f32 v23, v23, v252
    v_mul_f32 v24, v24, v252
    v_mul_f32 v25, v25, v252
    v_mul_f32 v26, v26, v252
    v_mul_f32 v27, v27, v252
    v_mul_f32 v28, v28, v252
    v_mul_f32 v29, v29, v252
    v_mul_f32 v30, v30, v252
    v_mul_f32 v31, v31, v252
    v_sub_f32 v176, v176, v251
    v_sub_f32 v177, v177, v251
    v_sub_f32 v178, v178, v251
    v_sub_f32 v179, v179, v251
    v_sub_f32 v180, v180, v251
    v_sub_f32 v181, v181, v251
    v_sub_f32 v182, v182, v251
    v_sub_f32 v183, v183, v251
    v_exp_f32 v176, v176
    v_exp_f32 v177, v177
    v_exp_f32 v178, v178
    v_exp_f32 v179, v179
    v_exp_f32 v180, v180
    v_exp_f32 v181, v181
    v_exp_f32 v182, v182
    v_exp_f32 v183, v183
    v_add_f32 v235, v176, v177
    v_add_f32 v235, v235, v178
    v_add_f32 v235, v235, v179
    v_add_f32 v235, v235, v180
    v_add_f32 v235, v235, v181
    v_add_f32 v235, v235, v182
    v_add_f32 v235, v235, v183
    v_cvt_pk_bf16_f32 v208, v176, v177
    v_cvt_pk_bf16_f32 v209, v178, v179
    v_cvt_pk_bf16_f32 v210, v180, v181
    v_cvt_pk_bf16_f32 v211, v182, v183
    s_nop 1
    s_branch wl_back0
wl_rare1:
    s_nop 7
    v_max3_f32 v251, v184, v185, v186
    v_max3_f32 v251, v251, v187, v188
    v_max3_f32 v251, v251, v189, v190
    v_max_f32 v251, v251, v191
    v_mov_b32 v252, v251
    s_nop 1
    v_permlane32_swap_b32 v251, v252
    v_max_f32 v251, v251, v252
    v_mov_b32 v252, v251
    s_nop 1
    v_permlane16_swap_b32 v251, v252
    v_max_f32 v251, v251, v252
    v_max_f32 v251, s43, v251
    v_max_f32 v252, 0, v251
    v_exp_f32_e64 v252, -v252
    v_sub_f32 v224, v224, v251
    v_sub_f32 v225, v225, v251
    v_sub_f32 v226, v226, v251
    v_sub_f32 v227, v227, v251
    v_mul_f32 v233, v233, v252
    v_mul_f32 v32, v32, v252
    v_mul_f32 v33, v33, v252
    v_mul_f32 v34, v34, v252
    v_mul_f32 v35, v35, v252
    v_mul_f32 v36, v36, v252
    v_mul_f32 v37, v37, v252
    v_mul_f32 v38, v38, v252
    v_mul_f32 v39, v39, v252
    v_mul_f32 v40, v40, v252
    v_mul_f32 v41, v41, v252
    v_mul_f32 v42, v42, v252
    v_mul_f32 v43, v43, v252
    v_mul_f32 v44, v44, v252
    v_mul_f32 v45, v45, v252
    v_mul_f32 v46, v46, v252
    v_mul_f32 v47, v47, v252
    v_mul_f32 v48, v48, v252
    v_mul_f32 v49, v49, v252
    v_mul_f32 v50, v50, v252
    v_mul_f32 v51, v51, v252
    v_mul_f32 v52, v52, v252
    v_mul_f32 v53, v53, v252
    v_mul_f32 v54, v54, v252
    v_mul_f32 v55, v55, v252
    v_mul_f32 v56, v56, v252
    v_mul_f32 v57, v57, v252
    v_mul_f32 v58, v58, v252
    v_mul_f32 v59, v59, v252
    v_mul_f32 v60, v60, v252
    v_mul_f32 v61, v61, v252
    v_mul_f32 v62, v62, v252
    v_mul_f32 v63, v63, v252
    v_sub_f32 v184, v184, v251
    v_sub_f32 v185, v185, v251
    v_sub_f32 v186, v186, v251
    v_sub_f32 v187, v187, v251
    v_sub_f32 v188, v188, v251
    v_sub_f32 v189, v189, v251
    v_sub_f32 v190, v190, v251
    v_sub_f32 v191, v191, v251
    v_exp_f32 v184, v184
    v_exp_f32 v185, v185
    v_exp_f32 v186, v186
    v_exp_f32 v187, v187
    v_exp_f32 v188, v188
    v_exp_f32 v189, v189
    v_exp_f32 v190, v190
    v_exp_f32 v191, v191
    v_add_f32 v242, v184, v185
    v_add_f32 v242, v242, v186
    v_add_f32 v242, v242, v187
    v_add_f32 v242, v242, v188
    v_add_f32 v242, v242, v189
    v_add_f32 v242, v242, v190
    v_add_f32 v242, v242, v191
    v_cvt_pk_bf16_f32 v212, v184, v185
    v_cvt_pk_bf16_f32 v213, v186, v187
    v_cvt_pk_bf16_f32 v214, v188, v189
    v_cvt_pk_bf16_f32 v215, v190, v191
    s_mov_b32 s42, 0x43800000
    s_mov_b32 s43, 0
    s_nop 1
    s_branch wl_back1
op_entry:
    s_lshr_b32 s45, s30, 2
    s_mul_i32 s50, s45, 5
    s_and_b32 s44, s30, 3
    s_lshl_b32 s51, s44, 1
    s_add_u32 s51, s51, 1
    s_sub_u32 s45, 3, s45
    s_cmp_eq_u32 s44, 1
    s_cselect_b32 s51, s45, s51
    s_cmp_eq_u32 s44, 0
    s_cselect_b32 s51, 0, s51
    s_lshl_b32 s44, s50, 11
    s_add_u32 s44, s44, 77824
    v_add_u32 v221, s44, v254
    v_bfe_u32 v251, v250, 2, 3
    v_mul_u32_u24 v222, 1184, v251
    v_lshrrev_b32 v251, 5, v250
    v_mul_u32_u24 v251, 288, v251
    v_add_u32 v222, v222, v251
    v_and_b32 v251, 3, v250
    v_lshl_add_u32 v222, v251, 3, v222
    s_lshl_b32 s44, s51, 5
    v_add_u32 v222, s44, v222
    v_and_b32 v251, 15, v250
    v_mul_u32_u24 v225, 1152, v251
    v_lshrrev_b32 v251, 4, v250
    v_lshl_add_u32 v225, v251, 3, v225
    v_add_u32 v224, 38912, v222
    v_add_u32 v223, 38912, v221
    s_lshl_b32 s46, s31, 2
    s_add_u32 s46, s46, s84
    s_lshl_b32 s46, s46, 2
    s_add_u32 s46, s46, s85
    s_add_u32 s46, s46, 1
    s_mul_i32 s46, s46, 73728
    s_lshl_b32 s44, s30, 10
    s_add_u32 s46, s46, s44
    s_lshl_b32 s43, s30, 10
    s_add_u32 s43, s43, 77824
    s_add_u32 s44, s46, 16384
    s_add_u32 s45, s43, 16384
    s_cmp_lt_u32 s30, 2
    s_cselect_b32 s16, s20, s12
    s_cselect_b32 s17, s21, s13
    s_cselect_b32 s18, s22, s14
    s_cselect_b32 s47, s44, s77
    s_cselect_b32 s78, s45, s78
    s_mov_b32 s44, 73728
    s_cselect_b32 s48, 18432, s44
    s_cselect_b64 vcc, -1, 0
    v_cndmask_b32 v244, v244, v254, vcc
    s_mov_b32 s42, 1
    s_add_u32 s44, s85, s42
    s_cmp_eq_u32 s44, 4
    s_cselect_b32 s44, 16, 0
    s_cmp_eq_u32 s42, 4
    s_cselect_b32 s44, 0xffff0000, s44
    s_mul_i32 s45, s44, 18432
    s_sub_u32 s46, s46, s45
    s_mul_i32 s45, s44, 73728
    s_sub_u32 s77, s77, s45
    s_mul_i32 s45, s44, s48
    s_sub_u32 s47, s47, s45
    s_lshl_b32 s44, s31, 2
    s_add_u32 s44, s44, s85
    s_lshl_b32 s52, s44, 19
    s_lshl_b32 s44, s30, 12
    s_add_u32 s52, s52, s44
    s_add_u32 s52, s52, 33554432
    s_lshl_b32 s54, s85, 2
    s_add_u32 s54, s54, 128
    s_add_u32 s54, s54, s98
    s_mul_i32 s53, s31, 9
    s_add_u32 s53, s53, s50
    s_mul_i32 s53, s53, 18432
    s_mul_i32 s44, s85, 288
    s_add_u32 s53, s53, s44
    s_lshl_b32 s44, s51, 5
    s_add_u32 s53, s53, s44
    s_mov_b32 s41, 0
    s_mov_b32 s101, 0x10000000
    s_mov_b32 s40, 0
    s_waitcnt lgkmcnt(0)
    s_cmp_eq_u32 s30, 0
    s_cbranch_scc1 op53
    s_cmp_eq_u32 s30, 5
    s_cbranch_scc1 op43
    s_cmp_lt_u32 s30, 4
    s_cbranch_scc1 op52
op42:
    v_mov_b64 v[0:1], 0
    v_mov_b64 v[2:3], 0
    v_mov_b64 v[4:5], 0
    v_mov_b64 v[6:7], 0
    v_mov_b64 v[8:9], 0
    v_mov_b64 v[10:11], 0
    v_mov_b64 v[12:13], 0
    v_mov_b64 v[14:15], 0
    v_mov_b64 v[16:17], 0
    v_mov_b64 v[18:19], 0
    v_mov_b64 v[20:21], 0
    v_mov_b64 v[22:23], 0
    v_mov_b64 v[24:25], 0
    v_mov_b64 v[26:27], 0
    v_mov_b64 v[28:29], 0
    v_mov_b64 v[30:31], 0
    v_mov_b64 v[132:133], 0
    v_mov_b64 v[134:135], 0
    v_mov_b64 v[136:137], 0
    v_mov_b64 v[138:139], 0
    v_mov_b64 v[140:141], 0
    v_mov_b64 v[142:143], 0
    v_mov_b64 v[144:145], 0
    v_mov_b64 v[146:147], 0
    v_mov_b64 v[148:149], 0
    v_mov_b64 v[150:151], 0
    v_mov_b64 v[152:153], 0
    v_mov_b64 v[154:155], 0
    v_mov_b64 v[156:157], 0
    v_mov_b64 v[158:159], 0
    v_mov_b64 v[160:161], 0
    v_mov_b64 v[162:163], 0
    s_waitcnt vmcnt(0)
    s_barrier
    s_cmp_lg_u32 s30, 0
    s_cbranch_scc1 op42_g0_nf
    s_add_u32 s44, s85, s98
    v_mov_b32 v251, 1
    s_mov_b64 exec, 1
    buffer_store_byte v251, off, s[20:23], s44 sc1
    s_mov_b64 exec, -1
op42_g0_nf:
    s_cmp_lg_u32 s41, 0
    s_cbranch_scc1 op42_g0_nl
    buffer_load_dword v226, off, s[20:23], s98 sc1
op42_g0_nl:
    v_mfma_f32_16x16x32_bf16 v[0:3], v[152:155], v[132:135], v[0:3]
    ds_read_b64_tr_b16 v[120:121], v222 offset:0
    v_mfma_f32_16x16x32_bf16 v[4:7], v[152:155], v[136:139], v[4:7]
    ds_read_b64_tr_b16 v[122:123], v222 offset:576
    ds_read_b128 v[100:103], v221 offset:0
    v_mfma_f32_16x16x32_bf16 v[8:11], v[152:155], v[140:143], v[8:11]
    ds_read_b128 v[104:107], v221 offset:2048
    v_mfma_f32_16x16x32_bf16 v[12:15], v[152:155], v[144:147], v[12:15]
    ds_read_b128 v[108:111], v221 offset:4096
    v_mfma_f32_16x16x32_bf16 v[16:19], v[156:159], v[132:135], v[16:19]
    ds_read_b128 v[112:115], v221 offset:6144
    ds_read_b64_tr_b16 v[124:125], v222 offset:32
    v_mfma_f32_16x16x32_bf16 v[20:23], v[156:159], v[136:139], v[20:23]
    ds_read_b64_tr_b16 v[126:127], v222 offset:608
    v_mfma_f32_16x16x32_bf16 v[24:27], v[156:159], v[140:143], v[24:27]
    v_mfma_f32_16x16x32_bf16 v[28:31], v[156:159], v[144:147], v[28:31]
    s_waitcnt lgkmcnt(3)
    v_mfma_f32_16x16x32_bf16 v[0:3], v[120:123], v[100:103], v[0:3]
    ds_read_b64_tr_b16 v[152:153], v222 offset:9472
    v_mfma_f32_16x16x32_bf16 v[4:7], v[120:123], v[104:107], v[4:7]
    ds_read_b64_tr_b16 v[154:155], v222 offset:10048
    ds_read_b128 v[132:135], v221 offset:1024
    v_mfma_f32_16x16x32_bf16 v[8:11], v[120:123], v[108:111], v[8:11]
    ds_read_b128 v[136:139], v221 offset:3072
    s_waitcnt lgkmcnt(4)
    v_mfma_f32_16x16x32_bf16 v[12:15], v[120:123], v[112:115], v[12:15]
    ds_read_b128 v[140:143], v221 offset:5120
    v_mfma_f32_16x16x32_bf16 v[16:19], v[124:127], v[100:103], v[16:19]
    ds_read_b128 v[144:147], v221 offset:7168
    ds_read_b64_tr_b16 v[156:157], v222 offset:9504
    v_mfma_f32_16x16x32_bf16 v[20:23], v[124:127], v[104:107], v[20:23]
    ds_read_b64_tr_b16 v[158:159], v222 offset:10080
    v_mfma_f32_16x16x32_bf16 v[24:27], v[124:127], v[108:111], v[24:27]
    v_mfma_f32_16x16x32_bf16 v[28:31], v[124:127], v[112:115], v[28:31]
    s_waitcnt lgkmcnt(0)
    s_cmp_lg_u32 s41, 0
    s_cbranch_scc1 op42_g1_nw
    s_waitcnt vmcnt(0)
    v_readfirstlane_b32 s40, v226
op42_g1_nw:
    s_barrier
    s_add_u32 s44, s42, s85
    s_and_b32 s44, s44, 3
    s_lshl_b32 s44, s44, 3
    s_bitcmp1_b32 s40, s44
    s_cbranch_scc0 op42_g1_ie
op42_g1_il:
    s_mul_i32 s99, s41, 19456
    s_add_u32 m0, s43, s99
    s_add_u32 s45, s46, 8192
    buffer_load_dwordx4 v254, s[20:23], s46 offen sc1 lds
    s_add_u32 m0, m0, 8192
    s_add_u32 s46, s46, 18432
    buffer_load_dwordx4 v254, s[20:23], s45 offen sc1 lds
    s_add_u32 m0, s78, s99
    s_nop 0
    buffer_load_dwordx4 v244, s[16:19], s47 offen sc1 lds
    s_add_u32 m0, s79, s99
    s_add_u32 s47, s47, s48
    buffer_load_dwordx4 v245, s[12:15], s77 offen lds
    s_add_u32 m0, s80, s99
    s_nop 0
    buffer_load_dwordx4 v246, s[12:15], s77 offen lds
    s_add_u32 s77, s77, 73728
    s_add_u32 s41, s41, 1
    s_cmp_lt_u32 s41, 1
    s_cbranch_scc1 op42_g1_il
op42_g1_ie:
    s_cmp_lg_u32 s41, 0
    s_cbranch_scc1 op42_g1_nl
    buffer_load_dword v226, off, s[20:23], s98 sc1
op42_g1_nl:
    v_mfma_f32_16x16x32_bf16 v[0:3], v[152:155], v[132:135], v[0:3]
    ds_read_b64_tr_b16 v[120:121], v222 offset:19456
    v_mfma_f32_16x16x32_bf16 v[4:7], v[152:155], v[136:139], v[4:7]
    ds_read_b64_tr_b16 v[122:123], v222 offset:20032
    ds_read_b128 v[100:103], v221 offset:19456
    v_mfma_f32_16x16x32_bf16 v[8:11], v[152:155], v[140:143], v[8:11]
    ds_read_b128 v[104:107], v221 offset:21504
    v_mfma_f32_16x16x32_bf16 v[12:15], v[152:155], v[144:147], v[12:15]
    ds_read_b128 v[108:111], v221 offset:23552
    v_mfma_f32_16x16x32_bf16 v[16:19], v[156:159], v[132:135], v[16:19]
    ds_read_b128 v[112:115], v221 offset:25600
    ds_read_b64_tr_b16 v[124:125], v222 offset:19488
    v_mfma_f32_16x16x32_bf16 v[20:23], v[156:159], v[136:139], v[20:23]
    ds_read_b64_tr_b16 v[126:127], v222 offset:20064
    v_mfma_f32_16x16x32_bf16 v[24:27], v[156:159], v[140:143], v[24:27]
    v_mfma_f32_16x16x32_bf16 v[28:31], v[156:159], v[144:147], v[28:31]
    s_waitcnt lgkmcnt(3)
    v_mfma_f32_16x16x32_bf16 v[0:3], v[120:123], v[100:103], v[0:3]
    ds_read_b64_tr_b16 v[152:153], v222 offset:28928
    v_mfma_f32_16x16x32_bf16 v[4:7], v[120:123], v[104:107], v[4:7]
    ds_read_b64_tr_b16 v[154:155], v222 offset:29504
    ds_read_b128 v[132:135], v221 offset:20480
    v_mfma_f32_16x16x32_bf16 v[8:11], v[120:123], v[108:111], v[8:11]
    ds_read_b128 v[136:139], v221 offset:22528
    s_waitcnt lgkmcnt(4)
    v_mfma_f32_16x16x32_bf16 v[12:15], v[120:123], v[112:115], v[12:15]
    ds_read_b128 v[140:143], v221 offset:24576
    v_mfma_f32_16x16x32_bf16 v[16:19], v[124:127], v[100:103], v[16:19]
    ds_read_b128 v[144:147], v221 offset:26624
    ds_read_b64_tr_b16 v[156:157], v222 offset:28960
    v_mfma_f32_16x16x32_bf16 v[20:23], v[124:127], v[104:107], v[20:23]
    ds_read_b64_tr_b16 v[158:159], v222 offset:29536
    v_mfma_f32_16x16x32_bf16 v[24:27], v[124:127], v[108:111], v[24:27]
    v_mfma_f32_16x16x32_bf16 v[28:31], v[124:127], v[112:115], v[28:31]
    s_waitcnt lgkmcnt(0)
    s_cmp_lg_u32 s41, 0
    s_cbranch_scc1 op42_g2_nw
    s_waitcnt vmcnt(0)
    v_readfirstlane_b32 s40, v226
op42_g2_nw:
    s_barrier
    s_add_u32 s44, s42, s85
    s_and_b32 s44, s44, 3
    s_lshl_b32 s44, s44, 3
    s_bitcmp1_b32 s40, s44
    s_cbranch_scc0 op42_g2_ie
op42_g2_il:
    s_mul_i32 s99, s41, 19456
    s_add_u32 m0, s43, s99
    s_add_u32 s45, s46, 8192
    buffer_load_dwordx4 v254, s[20:23], s46 offen sc1 lds
    s_add_u32 m0, m0, 8192
    s_add_u32 s46, s46, 18432
    buffer_load_dwordx4 v254, s[20:23], s45 offen sc1 lds
    s_add_u32 m0, s78, s99
    s_nop 0
    buffer_load_dwordx4 v244, s[16:19], s47 offen sc1 lds
    s_add_u32 m0, s79, s99
    s_add_u32 s47, s47, s48
    buffer_load_dwordx4 v245, s[12:15], s77 offen lds
    s_add_u32 m0, s80, s99
    s_nop 0
    buffer_load_dwordx4 v246, s[12:15], s77 offen lds
    s_add_u32 s77, s77, 73728
    s_add_u32 s41, s41, 1
    s_cmp_lt_u32 s41, 2
    s_cbranch_scc1 op42_g2_il
op42_g2_ie:
    s_cmp_lg_u32 s41, 0
    s_cbranch_scc1 op42_g2_nl
    buffer_load_dword v226, off, s[20:23], s98 sc1
op42_g2_nl:
    v_mfma_f32_16x16x32_bf16 v[0:3], v[152:155], v[132:135], v[0:3]
    ds_read_b64_tr_b16 v[120:121], v224 offset:0
    v_mfma_f32_16x16x32_bf16 v[4:7], v[152:155], v[136:139], v[4:7]
    ds_read_b64_tr_b16 v[122:123], v224 offset:576
    ds_read_b128 v[100:103], v223 offset:0
    v_mfma_f32_16x16x32_bf16 v[8:11], v[152:155], v[140:143], v[8:11]
    ds_read_b128 v[104:107], v223 offset:2048
    v_mfma_f32_16x16x32_bf16 v[12:15], v[152:155], v[144:147], v[12:15]
    ds_read_b128 v[108:111], v223 offset:4096
    v_mfma_f32_16x16x32_bf16 v[16:19], v[156:159], v[132:135], v[16:19]
    ds_read_b128 v[112:115], v223 offset:6144
    ds_read_b64_tr_b16 v[124:125], v224 offset:32
    v_mfma_f32_16x16x32_bf16 v[20:23], v[156:159], v[136:139], v[20:23]
    ds_read_b64_tr_b16 v[126:127], v224 offset:608
    v_mfma_f32_16x16x32_bf16 v[24:27], v[156:159], v[140:143], v[24:27]
    v_mfma_f32_16x16x32_bf16 v[28:31], v[156:159], v[144:147], v[28:31]
    s_waitcnt lgkmcnt(3)
    v_mfma_f32_16x16x32_bf16 v[0:3], v[120:123], v[100:103], v[0:3]
    ds_read_b64_tr_b16 v[152:153], v224 offset:9472
    v_mfma_f32_16x16x32_bf16 v[4:7], v[120:123], v[104:107], v[4:7]
    ds_read_b64_tr_b16 v[154:155], v224 offset:10048
    ds_read_b128 v[132:135], v223 offset:1024
    v_mfma_f32_16x16x32_bf16 v[8:11], v[120:123], v[108:111], v[8:11]
    ds_read_b128 v[136:139], v223 offset:3072
    s_waitcnt lgkmcnt(4)
    v_mfma_f32_16x16x32_bf16 v[12:15], v[120:123], v[112:115], v[12:15]
    ds_read_b128 v[140:143], v223 offset:5120
    v_mfma_f32_16x16x32_bf16 v[16:19], v[124:127], v[100:103], v[16:19]
    ds_read_b128 v[144:147], v223 offset:7168
    ds_read_b64_tr_b16 v[156:157], v224 offset:9504
    v_mfma_f32_16x16x32_bf16 v[20:23], v[124:127], v[104:107], v[20:23]
    ds_read_b64_tr_b16 v[158:159], v224 offset:10080
    v_mfma_f32_16x16x32_bf16 v[24:27], v[124:127], v[108:111], v[24:27]
    v_mfma_f32_16x16x32_bf16 v[28:31], v[124:127], v[112:115], v[28:31]
    s_waitcnt lgkmcnt(0)
    s_cmp_lg_u32 s41, 0
    s_cbranch_scc1 op42_g3_nw
    s_waitcnt vmcnt(0)
    v_readfirstlane_b32 s40, v226
op42_g3_nw:
    s_barrier
    s_add_u32 s44, s42, s85
    s_and_b32 s44, s44, 3
    s_lshl_b32 s44, s44, 3
    s_bitcmp1_b32 s40, s44
    s_cbranch_scc0 op42_g3_ie
op42_g3_il:
    s_mul_i32 s99, s41, 19456
    s_add_u32 m0, s43, s99
    s_add_u32 s45, s46, 8192
    buffer_load_dwordx4 v254, s[20:23], s46 offen sc1 lds
    s_add_u32 m0, m0, 8192
    s_add_u32 s46, s46, 18432
    buffer_load_dwordx4 v254, s[20:23], s45 offen sc1 lds
    s_add_u32 m0, s78, s99
    s_nop 0
    buffer_load_dwordx4 v244, s[16:19], s47 offen sc1 lds
    s_add_u32 m0, s79, s99
    s_add_u32 s47, s47, s48
    buffer_load_dwordx4 v245, s[12:15], s77 offen lds
    s_add_u32 m0, s80, s99
    s_nop 0
    buffer_load_dwordx4 v246, s[12:15], s77 offen lds
    s_add_u32 s77, s77, 73728
    s_add_u32 s41, s41, 1
    s_cmp_lt_u32 s41, 3
    s_cbranch_scc1 op42_g3_il
op42_g3_ie:
    s_cmp_lg_u32 s41, 0
    s_cbranch_scc1 op42_g3_nl
    buffer_load_dword v226, off, s[20:23], s98 sc1
op42_g3_nl:
    v_mfma_f32_16x16x32_bf16 v[0:3], v[152:155], v[132:135], v[0:3]
    ds_read_b64_tr_b16 v[120:121], v224 offset:19456
    v_mfma_f32_16x16x32_bf16 v[4:7], v[152:155], v[136:139], v[4:7]
    ds_read_b64_tr_b16 v[122:123], v224 offset:20032
    ds_read_b128 v[100:103], v223 offset:19456
    v_mfma_f32_16x16x32_bf16 v[8:11], v[152:155], v[140:143], v[8:11]
    ds_read_b128 v[104:107], v223 offset:21504
    v_mfma_f32_16x16x32_bf16 v[12:15], v[152:155], v[144:147], v[12:15]
    ds_read_b128 v[108:111], v223 offset:23552
    v_mfma_f32_16x16x32_bf16 v[16:19], v[156:159], v[132:135], v[16:19]
    ds_read_b128 v[112:115], v223 offset:25600
    ds_read_b64_tr_b16 v[124:125], v224 offset:19488
    v_mfma_f32_16x16x32_bf16 v[20:23], v[156:159], v[136:139], v[20:23]
    ds_read_b64_tr_b16 v[126:127], v224 offset:20064
    v_mfma_f32_16x16x32_bf16 v[24:27], v[156:159], v[140:143], v[24:27]
    v_mfma_f32_16x16x32_bf16 v[28:31], v[156:159], v[144:147], v[28:31]
    s_waitcnt lgkmcnt(3)
    v_mfma_f32_16x16x32_bf16 v[0:3], v[120:123], v[100:103], v[0:3]
    ds_read_b64_tr_b16 v[152:153], v224 offset:28928
    v_mfma_f32_16x16x32_bf16 v[4:7], v[120:123], v[104:107], v[4:7]
    ds_read_b64_tr_b16 v[154:155], v224 offset:29504
    ds_read_b128 v[132:135], v223 offset:20480
    v_mfma_f32_16x16x32_bf16 v[8:11], v[120:123], v[108:111], v[8:11]
    ds_read_b128 v[136:139], v223 offset:22528
    s_waitcnt lgkmcnt(4)
    v_mfma_f32_16x16x32_bf16 v[12:15], v[120:123], v[112:115], v[12:15]
    ds_read_b128 v[140:143], v223 offset:24576
    v_mfma_f32_16x16x32_bf16 v[16:19], v[124:127], v[100:103], v[16:19]
    ds_read_b128 v[144:147], v223 offset:26624
    ds_read_b64_tr_b16 v[156:157], v224 offset:28960
    v_mfma_f32_16x16x32_bf16 v[20:23], v[124:127], v[104:107], v[20:23]
    ds_read_b64_tr_b16 v[158:159], v224 offset:29536
    v_mfma_f32_16x16x32_bf16 v[24:27], v[124:127], v[108:111], v[24:27]
    v_mfma_f32_16x16x32_bf16 v[28:31], v[124:127], v[112:115], v[28:31]
    s_waitcnt lgkmcnt(0)
    s_cmp_lg_u32 s41, 0
    s_cbranch_scc1 op42_j3
    s_waitcnt vmcnt(0)
    v_readfirstlane_b32 s40, v226
    s_add_u32 s44, s42, s85
    s_and_b32 s44, s44, 3
    s_lshl_b32 s44, s44, 3
    s_bitcmp1_b32 s40, s44
    s_cbranch_scc1 op42_p0_ok
op42_p0:
    buffer_load_dword v226, off, s[20:23], s98 sc1
    s_waitcnt vmcnt(0)
    v_readfirstlane_b32 s40, v226
    s_add_u32 s44, s42, s85
    s_and_b32 s44, s44, 3
    s_lshl_b32 s44, s44, 3
    s_bitcmp1_b32 s40, s44
    s_cbranch_scc1 op42_p0_ok
    s_sleep 4
    s_branch op42_p0
op42_p0_ok:
    buffer_load_dword v226, off, s[20:23], s98 sc1
    s_add_u32 m0, s43, 0
    s_add_u32 s45, s46, 8192
    buffer_load_dwordx4 v254, s[20:23], s46 offen sc1 lds
    s_add_u32 m0, m0, 8192
    s_add_u32 s46, s46, 18432
    buffer_load_dwordx4 v254, s[20:23], s45 offen sc1 lds
    s_add_u32 m0, s78, 0
    s_nop 0
    buffer_load_dwordx4 v244, s[16:19], s47 offen sc1 lds
    s_add_u32 m0, s79, 0
    s_add_u32 s47, s47, s48
    buffer_load_dwordx4 v245, s[12:15], s77 offen lds
    s_add_u32 m0, s80, 0
    s_nop 0
    buffer_load_dwordx4 v246, s[12:15], s77 offen lds
    s_add_u32 s77, s77, 73728
    s_add_u32 m0, s43, 19456
    s_add_u32 s45, s46, 8192
    buffer_load_dwordx4 v254, s[20:23], s46 offen sc1 lds
    s_add_u32 m0, m0, 8192
    s_add_u32 s46, s46, 18432
    buffer_load_dwordx4 v254, s[20:23], s45 offen sc1 lds
    s_add_u32 m0, s78, 19456
    s_nop 0
    buffer_load_dwordx4 v244, s[16:19], s47 offen sc1 lds
    s_add_u32 m0, s79, 19456
    s_add_u32 s47, s47, s48
    buffer_load_dwordx4 v245, s[12:15], s77 offen lds
    s_add_u32 m0, s80, 19456
    s_nop 0
    buffer_load_dwordx4 v246, s[12:15], s77 offen lds
    s_add_u32 s77, s77, 73728
    s_add_u32 m0, s43, 38912
    s_add_u32 s45, s46, 8192
    buffer_load_dwordx4 v254, s[20:23], s46 offen sc1 lds
    s_add_u32 m0, m0, 8192
    s_add_u32 s46, s46, 18432
    buffer_load_dwordx4 v254, s[20:23], s45 offen sc1 lds
    s_add_u32 m0, s78, 38912
    s_nop 0
    buffer_load_dwordx4 v244, s[16:19], s47 offen sc1 lds
    s_add_u32 m0, s79, 38912
    s_add_u32 s47, s47, s48
    buffer_load_dwordx4 v245, s[12:15], s77 offen lds
    s_add_u32 m0, s80, 38912
    s_nop 0
    buffer_load_dwordx4 v246, s[12:15], s77 offen lds
    s_add_u32 s77, s77, 73728
op42_j3:
op42_loop:
    s_waitcnt vmcnt(10)
    s_barrier
    v_mfma_f32_16x16x32_bf16 v[0:3], v[152:155], v[132:135], v[0:3]
    ds_read_b64_tr_b16 v[120:121], v222 offset:0
    s_add_u32 m0, s43, 58368
    v_mfma_f32_16x16x32_bf16 v[4:7], v[152:155], v[136:139], v[4:7]
    ds_read_b64_tr_b16 v[122:123], v222 offset:576
    ds_read_b128 v[100:103], v221 offset:0
    v_mfma_f32_16x16x32_bf16 v[8:11], v[152:155], v[140:143], v[8:11]
    ds_read_b128 v[104:107], v221 offset:2048
    s_add_u32 s45, s46, 8192
    v_mfma_f32_16x16x32_bf16 v[12:15], v[152:155], v[144:147], v[12:15]
    ds_read_b128 v[108:111], v221 offset:4096
    buffer_load_dwordx4 v254, s[20:23], s46 offen sc1 lds
    v_mfma_f32_16x16x32_bf16 v[16:19], v[156:159], v[132:135], v[16:19]
    ds_read_b128 v[112:115], v221 offset:6144
    ds_read_b64_tr_b16 v[124:125], v222 offset:32
    v_mfma_f32_16x16x32_bf16 v[20:23], v[156:159], v[136:139], v[20:23]
    ds_read_b64_tr_b16 v[126:127], v222 offset:608
    s_add_u32 m0, m0, 8192
    v_mfma_f32_16x16x32_bf16 v[24:27], v[156:159], v[140:143], v[24:27]
    s_add_u32 s46, s46, 18432
    buffer_load_dwordx4 v254, s[20:23], s45 offen sc1 lds
    v_mfma_f32_16x16x32_bf16 v[28:31], v[156:159], v[144:147], v[28:31]
    s_add_u32 m0, s78, 58368
    s_nop 0
    s_waitcnt lgkmcnt(3)
    v_mfma_f32_16x16x32_bf16 v[0:3], v[120:123], v[100:103], v[0:3]
    ds_read_b64_tr_b16 v[152:153], v222 offset:9472
    buffer_load_dwordx4 v244, s[16:19], s47 offen sc1 lds
    v_mfma_f32_16x16x32_bf16 v[4:7], v[120:123], v[104:107], v[4:7]
    ds_read_b64_tr_b16 v[154:155], v222 offset:10048
    ds_read_b128 v[132:135], v221 offset:1024
    v_mfma_f32_16x16x32_bf16 v[8:11], v[120:123], v[108:111], v[8:11]
    ds_read_b128 v[136:139], v221 offset:3072
    s_add_u32 m0, s79, 58368
    s_waitcnt lgkmcnt(4)
    v_mfma_f32_16x16x32_bf16 v[12:15], v[120:123], v[112:115], v[12:15]
    ds_read_b128 v[140:143], v221 offset:5120
    s_add_u32 s47, s47, s48
    v_mfma_f32_16x16x32_bf16 v[16:19], v[124:127], v[100:103], v[16:19]
    ds_read_b128 v[144:147], v221 offset:7168
    ds_read_b64_tr_b16 v[156:157], v222 offset:9504
    v_mfma_f32_16x16x32_bf16 v[20:23], v[124:127], v[104:107], v[20:23]
    ds_read_b64_tr_b16 v[158:159], v222 offset:10080
    buffer_load_dwordx4 v245, s[12:15], s77 offen lds
    v_mfma_f32_16x16x32_bf16 v[24:27], v[124:127], v[108:111], v[24:27]
    s_add_u32 m0, s80, 58368
    s_nop 0
    v_mfma_f32_16x16x32_bf16 v[28:31], v[124:127], v[112:115], v[28:31]
    buffer_load_dwordx4 v246, s[12:15], s77 offen lds
    s_add_u32 s77, s77, 73728
    s_waitcnt lgkmcnt(0)
    s_waitcnt vmcnt(10)
    s_barrier
    v_readfirstlane_b32 s40, v226
    s_add_u32 s42, s42, 1
    s_add_u32 s44, s42, s85
    s_and_b32 s44, s44, 3
    s_lshl_b32 s44, s44, 3
    s_bitcmp1_b32 s40, s44
    s_cbranch_scc0 op42_late
op42_rdy:
    v_mfma_f32_16x16x32_bf16 v[0:3], v[152:155], v[132:135], v[0:3]
    ds_read_b64_tr_b16 v[120:121], v222 offset:19456
    s_add_u32 s44, s85, s42
    s_cmp_eq_u32 s44, 4
    v_mfma_f32_16x16x32_bf16 v[4:7], v[152:155], v[136:139], v[4:7]
    ds_read_b64_tr_b16 v[122:123], v222 offset:20032
    ds_read_b128 v[100:103], v221 offset:19456
    v_mfma_f32_16x16x32_bf16 v[8:11], v[152:155], v[140:143], v[8:11]
    ds_read_b128 v[104:107], v221 offset:21504
    s_cselect_b32 s44, 16, 0
    s_cmp_eq_u32 s42, 4
    v_mfma_f32_16x16x32_bf16 v[12:15], v[152:155], v[144:147], v[12:15]
    ds_read_b128 v[108:111], v221 offset:23552
    s_cselect_b32 s44, 0xffff0000, s44
    s_mul_i32 s45, s44, 18432
    v_mfma_f32_16x16x32_bf16 v[16:19], v[156:159], v[132:135], v[16:19]
    ds_read_b128 v[112:115], v221 offset:25600
    ds_read_b64_tr_b16 v[124:125], v222 offset:19488
    v_mfma_f32_16x16x32_bf16 v[20:23], v[156:159], v[136:139], v[20:23]
    ds_read_b64_tr_b16 v[126:127], v222 offset:20064
    s_sub_u32 s46, s46, s45
    s_mul_i32 s45, s44, 73728
    v_mfma_f32_16x16x32_bf16 v[24:27], v[156:159], v[140:143], v[24:27]
    s_sub_u32 s77, s77, s45
    s_mul_i32 s45, s44, s48
    s_sub_u32 s47, s47, s45
    v_mfma_f32_16x16x32_bf16 v[28:31], v[156:159], v[144:147], v[28:31]
    s_add_u32 m0, s43, 0
    s_add_u32 s45, s46, 8192
    buffer_load_dwordx4 v254, s[20:23], s46 offen sc1 lds
    s_waitcnt lgkmcnt(3)
    v_mfma_f32_16x16x32_bf16 v[0:3], v[120:123], v[100:103], v[0:3]
    ds_read_b64_tr_b16 v[152:153], v222 offset:28928
    s_add_u32 m0, m0, 8192
    v_mfma_f32_16x16x32_bf16 v[4:7], v[120:123], v[104:107], v[4:7]
    ds_read_b64_tr_b16 v[154:155], v222 offset:29504
    ds_read_b128 v[132:135], v221 offset:20480
    s_add_u32 s46, s46, 18432
    v_mfma_f32_16x16x32_bf16 v[8:11], v[120:123], v[108:111], v[8:11]
    ds_read_b128 v[136:139], v221 offset:22528
    buffer_load_dwordx4 v254, s[20:23], s45 offen sc1 lds
    s_add_u32 m0, s78, 0
    s_waitcnt lgkmcnt(4)
    v_mfma_f32_16x16x32_bf16 v[12:15], v[120:123], v[112:115], v[12:15]
    ds_read_b128 v[140:143], v221 offset:24576
    s_nop 0
    v_mfma_f32_16x16x32_bf16 v[16:19], v[124:127], v[100:103], v[16:19]
    ds_read_b128 v[144:147], v221 offset:26624
    ds_read_b64_tr_b16 v[156:157], v222 offset:28960
    buffer_load_dwordx4 v244, s[16:19], s47 offen sc1 lds
    v_mfma_f32_16x16x32_bf16 v[20:23], v[124:127], v[104:107], v[20:23]
    ds_read_b64_tr_b16 v[158:159], v222 offset:29536
    s_add_u32 m0, s79, 0
    s_add_u32 s47, s47, s48
    v_mfma_f32_16x16x32_bf16 v[24:27], v[124:127], v[108:111], v[24:27]
    buffer_load_dwordx4 v245, s[12:15], s77 offen lds
    s_add_u32 m0, s80, 0
    v_mfma_f32_16x16x32_bf16 v[28:31], v[124:127], v[112:115], v[28:31]
    s_nop 0
    buffer_load_dwordx4 v246, s[12:15], s77 offen lds
    s_add_u32 s77, s77, 73728
    s_waitcnt lgkmcnt(0)
    s_waitcnt vmcnt(10)
    s_barrier
    v_mfma_f32_16x16x32_bf16 v[0:3], v[152:155], v[132:135], v[0:3]
    ds_read_b64_tr_b16 v[120:121], v224 offset:0
    s_add_u32 m0, s43, 19456
    v_mfma_f32_16x16x32_bf16 v[4:7], v[152:155], v[136:139], v[4:7]
    ds_read_b64_tr_b16 v[122:123], v224 offset:576
    ds_read_b128 v[100:103], v223 offset:0
    v_mfma_f32_16x16x32_bf16 v[8:11], v[152:155], v[140:143], v[8:11]
    ds_read_b128 v[104:107], v223 offset:2048
    s_add_u32 s45, s46, 8192
    v_mfma_f32_16x16x32_bf16 v[12:15], v[152:155], v[144:147], v[12:15]
    ds_read_b128 v[108:111], v223 offset:4096
    buffer_load_dwordx4 v254, s[20:23], s46 offen sc1 lds
    v_mfma_f32_16x16x32_bf16 v[16:19], v[156:159], v[132:135], v[16:19]
    ds_read_b128 v[112:115], v223 offset:6144
    ds_read_b64_tr_b16 v[124:125], v224 offset:32
    v_mfma_f32_16x16x32_bf16 v[20:23], v[156:159], v[136:139], v[20:23]
    ds_read_b64_tr_b16 v[126:127], v224 offset:608
    s_add_u32 m0, m0, 8192
    v_mfma_f32_16x16x32_bf16 v[24:27], v[156:159], v[140:143], v[24:27]
    s_add_u32 s46, s46, 18432
    buffer_load_dwordx4 v254, s[20:23], s45 offen sc1 lds
    v_mfma_f32_16x16x32_bf16 v[28:31], v[156:159], v[144:147], v[28:31]
    s_add_u32 m0, s78, 19456
    s_nop 0
    s_waitcnt lgkmcnt(3)
    v_mfma_f32_16x16x32_bf16 v[0:3], v[120:123], v[100:103], v[0:3]
    ds_read_b64_tr_b16 v[152:153], v224 offset:9472
    buffer_load_dwordx4 v244, s[16:19], s47 offen sc1 lds
    v_mfma_f32_16x16x32_bf16 v[4:7], v[120:123], v[104:107], v[4:7]
    ds_read_b64_tr_b16 v[154:155], v224 offset:10048
    ds_read_b128 v[132:135], v223 offset:1024
    v_mfma_f32_16x16x32_bf16 v[8:11], v[120:123], v[108:111], v[8:11]
    ds_read_b128 v[136:139], v223 offset:3072
    s_add_u32 m0, s79, 19456
    s_waitcnt lgkmcnt(4)
    v_mfma_f32_16x16x32_bf16 v[12:15], v[120:123], v[112:115], v[12:15]
    ds_read_b128 v[140:143], v223 offset:5120
    s_add_u32 s47, s47, s48
    v_mfma_f32_16x16x32_bf16 v[16:19], v[124:127], v[100:103], v[16:19]
    ds_read_b128 v[144:147], v223 offset:7168
    ds_read_b64_tr_b16 v[156:157], v224 offset:9504
    v_mfma_f32_16x16x32_bf16 v[20:23], v[124:127], v[104:107], v[20:23]
    ds_read_b64_tr_b16 v[158:159], v224 offset:10080
    buffer_load_dwordx4 v245, s[12:15], s77 offen lds
    v_mfma_f32_16x16x32_bf16 v[24:27], v[124:127], v[108:111], v[24:27]
    s_add_u32 m0, s80, 19456
    s_nop 0
    v_mfma_f32_16x16x32_bf16 v[28:31], v[124:127], v[112:115], v[28:31]
    buffer_load_dwordx4 v246, s[12:15], s77 offen lds
    s_add_u32 s77, s77, 73728
    s_waitcnt lgkmcnt(0)
    s_waitcnt vmcnt(10)
    s_barrier
    v_mfma_f32_16x16x32_bf16 v[0:3], v[152:155], v[132:135], v[0:3]
    ds_read_b64_tr_b16 v[120:121], v224 offset:19456
    buffer_load_dword v226, off, s[20:23], s98 sc1
    v_mfma_f32_16x16x32_bf16 v[4:7], v[152:155], v[136:139], v[4:7]
    ds_read_b64_tr_b16 v[122:123], v224 offset:20032
    ds_read_b128 v[100:103], v223 offset:19456
    v_mfma_f32_16x16x32_bf16 v[8:11], v[152:155], v[140:143], v[8:11]
    ds_read_b128 v[104:107], v223 offset:21504
    s_add_u32 m0, s43, 38912
    v_mfma_f32_16x16x32_bf16 v[12:15], v[152:155], v[144:147], v[12:15]
    ds_read_b128 v[108:111], v223 offset:23552
    s_add_u32 s45, s46, 8192
    buffer_load_dwordx4 v254, s[20:23], s46 offen sc1 lds
    v_mfma_f32_16x16x32_bf16 v[16:19], v[156:159], v[132:135], v[16:19]
    ds_read_b128 v[112:115], v223 offset:25600
    ds_read_b64_tr_b16 v[124:125], v224 offset:19488
    v_mfma_f32_16x16x32_bf16 v[20:23], v[156:159], v[136:139], v[20:23]
    ds_read_b64_tr_b16 v[126:127], v224 offset:20064
    s_add_u32 m0, m0, 8192
    v_mfma_f32_16x16x32_bf16 v[24:27], v[156:159], v[140:143], v[24:27]
    s_add_u32 s46, s46, 18432
    buffer_load_dwordx4 v254, s[20:23], s45 offen sc1 lds
    v_mfma_f32_16x16x32_bf16 v[28:31], v[156:159], v[144:147], v[28:31]
    s_add_u32 m0, s78, 38912
    s_nop 0
    s_waitcnt lgkmcnt(3)
    v_mfma_f32_16x16x32_bf16 v[0:3], v[120:123], v[100:103], v[0:3]
    ds_read_b64_tr_b16 v[152:153], v224 offset:28928
    buffer_load_dwordx4 v244, s[16:19], s47 offen sc1 lds
    v_mfma_f32_16x16x32_bf16 v[4:7], v[120:123], v[104:107], v[4:7]
    ds_read_b64_tr_b16 v[154:155], v224 offset:29504
    ds_read_b128 v[132:135], v223 offset:20480
    v_mfma_f32_16x16x32_bf16 v[8:11], v[120:123], v[108:111], v[8:11]
    ds_read_b128 v[136:139], v223 offset:22528
    s_add_u32 m0, s79, 38912
    s_waitcnt lgkmcnt(4)
    v_mfma_f32_16x16x32_bf16 v[12:15], v[120:123], v[112:115], v[12:15]
    ds_read_b128 v[140:143], v223 offset:24576
    s_add_u32 s47, s47, s48
    buffer_load_dwordx4 v245, s[12:15], s77 offen lds
    v_mfma_f32_16x16x32_bf16 v[16:19], v[124:127], v[100:103], v[16:19]
    ds_read_b128 v[144:147], v223 offset:26624
    ds_read_b64_tr_b16 v[156:157], v224 offset:28960
    v_mfma_f32_16x16x32_bf16 v[20:23], v[124:127], v[104:107], v[20:23]
    ds_read_b64_tr_b16 v[158:159], v224 offset:29536
    s_add_u32 m0, s80, 38912
    v_mfma_f32_16x16x32_bf16 v[24:27], v[124:127], v[108:111], v[24:27]
    s_nop 0
    buffer_load_dwordx4 v246, s[12:15], s77 offen lds
    v_mfma_f32_16x16x32_bf16 v[28:31], v[124:127], v[112:115], v[28:31]
    s_add_u32 s77, s77, 73728
    s_cmp_lt_u32 s42, 4
    s_waitcnt lgkmcnt(0)
    s_cbranch_scc1 op42_loop
    s_branch op42_done
op42_late:
op42_p1:
    buffer_load_dword v226, off, s[20:23], s98 sc1
    s_waitcnt vmcnt(0)
    v_readfirstlane_b32 s40, v226
    s_add_u32 s44, s42, s85
    s_and_b32 s44, s44, 3
    s_lshl_b32 s44, s44, 3
    s_bitcmp1_b32 s40, s44
    s_cbranch_scc1 op42_p1_ok
    s_sleep 4
    s_branch op42_p1
op42_p1_ok:
    s_branch op42_rdy
op42_done:
    v_mfma_f32_16x16x32_bf16 v[0:3], v[152:155], v[132:135], v[0:3]
    v_mfma_f32_16x16x32_bf16 v[4:7], v[152:155], v[136:139], v[4:7]
    v_mfma_f32_16x16x32_bf16 v[8:11], v[152:155], v[140:143], v[8:11]
    v_mfma_f32_16x16x32_bf16 v[12:15], v[152:155], v[144:147], v[12:15]
    v_mfma_f32_16x16x32_bf16 v[16:19], v[156:159], v[132:135], v[16:19]
    v_mfma_f32_16x16x32_bf16 v[20:23], v[156:159], v[136:139], v[20:23]
    v_mfma_f32_16x16x32_bf16 v[24:27], v[156:159], v[140:143], v[24:27]
    v_mfma_f32_16x16x32_bf16 v[28:31], v[156:159], v[144:147], v[28:31]
    s_cmp_eq_u32 s84, 0
    s_cbranch_scc1 op42_k0
    s_cmp_eq_u32 s84, 1
    s_cbranch_scc1 op42_k1
    s_cmp_eq_u32 s84, 2
    s_cbranch_scc1 op42_k2
op42_k3:
    s_nop 7
    s_add_u32 s44, s52, 98304
    v_cvt_pk_bf16_f32 v0, v0, v1
    v_cvt_pk_bf16_f32 v1, v2, v3
    v_cvt_pk_bf16_f32 v2, v16, v17
    v_cvt_pk_bf16_f32 v3, v18, v19
    buffer_store_dwordx4 v[0:3], v254, s[20:23], s44 offen offset:0 sc1
    s_add_u32 s44, s52, 229376
    v_cvt_pk_bf16_f32 v4, v4, v5
    v_cvt_pk_bf16_f32 v5, v6, v7
    v_cvt_pk_bf16_f32 v6, v20, v21
    v_cvt_pk_bf16_f32 v7, v22, v23
    buffer_store_dwordx4 v[4:7], v254, s[20:23], s44 offen offset:0 sc1
    s_add_u32 s44, s52, 360448
    v_cvt_pk_bf16_f32 v8, v8, v9
    v_cvt_pk_bf16_f32 v9, v10, v11
    v_cvt_pk_bf16_f32 v10, v24, v25
    v_cvt_pk_bf16_f32 v11, v26, v27
    buffer_store_dwordx4 v[8:11], v254, s[20:23], s44 offen offset:0 sc1
    s_waitcnt vmcnt(0)
    s_barrier
    s_cmp_lg_u32 s30, 0
    s_cbranch_scc1 op42_nr3
    v_lshlrev_b32 v226, 8, v250
    v_mov_b32 v251, 1
    s_add_u32 s44, s54, -765
    s_mov_b64 exec, 15
    buffer_store_byte v251, v226, s[20:23], s44 offen sc1
    s_mov_b64 exec, -1
op42_nr3:
op42_q3:
    buffer_load_dword v226, off, s[20:23], s54 sc1
    s_waitcnt vmcnt(0)
    v_readfirstlane_b32 s40, v226
    s_nop 0
    s_cmp_eq_u32 s40, 0x01010101
    s_cbranch_scc1 op42_q3_ok
    s_sleep 4
    s_branch op42_q3
op42_q3_ok:
    s_add_u32 s94, s52, 393216
    s_add_u32 s95, s52, 425984
    s_add_u32 s96, s52, 458752
    buffer_load_dwordx4 v[100:103], v254, s[20:23], s94 offen offset:0 sc1
    buffer_load_dwordx4 v[104:107], v254, s[20:23], s95 offen offset:0 sc1
    buffer_load_dwordx4 v[108:111], v254, s[20:23], s96 offen offset:0 sc1
    s_mov_b32 s99, 0xffff0000
    s_add_u32 s44, s53, 55296
    s_waitcnt vmcnt(0)
    v_lshlrev_b32 v251, 16, v100
    v_and_b32 v100, s99, v100
    v_lshlrev_b32 v252, 16, v101
    v_and_b32 v101, s99, v101
    v_add_f32 v12, v12, v251
    v_add_f32 v13, v13, v100
    v_add_f32 v14, v14, v252
    v_add_f32 v15, v15, v101
    v_lshlrev_b32 v251, 16, v104
    v_and_b32 v104, s99, v104
    v_lshlrev_b32 v252, 16, v105
    v_and_b32 v105, s99, v105
    v_add_f32 v12, v12, v251
    v_add_f32 v13, v13, v104
    v_add_f32 v14, v14, v252
    v_add_f32 v15, v15, v105
    v_lshlrev_b32 v251, 16, v108
    v_and_b32 v108, s99, v108
    v_lshlrev_b32 v252, 16, v109
    v_and_b32 v109, s99, v109
    v_add_f32 v12, v12, v251
    v_add_f32 v13, v13, v108
    v_add_f32 v14, v14, v252
    v_add_f32 v15, v15, v109
    v_cvt_pk_bf16_f32 v12, v12, v13
    v_cvt_pk_bf16_f32 v13, v14, v15
    buffer_store_dwordx2 v[12:13], v225, s[8:11], s44 offen
    s_add_u32 s44, s53, 55328
    v_lshlrev_b32 v251, 16, v102
    v_and_b32 v102, s99, v102
    v_lshlrev_b32 v252, 16, v103
    v_and_b32 v103, s99, v103
    v_add_f32 v28, v28, v251
    v_add_f32 v29, v29, v102
    v_add_f32 v30, v30, v252
    v_add_f32 v31, v31, v103
    v_lshlrev_b32 v251, 16, v106
    v_and_b32 v106, s99, v106
    v_lshlrev_b32 v252, 16, v107
    v_and_b32 v107, s99, v107
    v_add_f32 v28, v28, v251
    v_add_f32 v29, v29, v106
    v_add_f32 v30, v30, v252
    v_add_f32 v31, v31, v107
    v_lshlrev_b32 v251, 16, v110
    v_and_b32 v110, s99, v110
    v_lshlrev_b32 v252, 16, v111
    v_and_b32 v111, s99, v111
    v_add_f32 v28, v28, v251
    v_add_f32 v29, v29, v110
    v_add_f32 v30, v30, v252
    v_add_f32 v31, v31, v111
    v_cvt_pk_bf16_f32 v28, v28, v29
    v_cvt_pk_bf16_f32 v29, v30, v31
    buffer_store_dwordx2 v[28:29], v225, s[8:11], s44 offen
    s_branch attn_fin
op42_k0:
    s_nop 7
    s_add_u32 s44, s52, 131072
    v_cvt_pk_bf16_f32 v4, v4, v5
    v_cvt_pk_bf16_f32 v5, v6, v7
    v_cvt_pk_bf16_f32 v6, v20, v21
    v_cvt_pk_bf16_f32 v7, v22, v23
    buffer_store_dwordx4 v[4:7], v254, s[20:23], s44 offen offset:0 sc1
    s_add_u32 s44, s52, 262144
    v_cvt_pk_bf16_f32 v8, v8, v9
    v_cvt_pk_bf16_f32 v9, v10, v11
    v_cvt_pk_bf16_f32 v10, v24, v25
    v_cvt_pk_bf16_f32 v11, v26, v27
    buffer_store_dwordx4 v[8:11], v254, s[20:23], s44 offen offset:0 sc1
    s_add_u32 s44, s52, 393216
    v_cvt_pk_bf16_f32 v12, v12, v13
    v_cvt_pk_bf16_f32 v13, v14, v15
    v_cvt_pk_bf16_f32 v14, v28, v29
    v_cvt_pk_bf16_f32 v15, v30, v31
    buffer_store_dwordx4 v[12:15], v254, s[20:23], s44 offen offset:0 sc1
    s_waitcnt vmcnt(0)
    s_barrier
    s_cmp_lg_u32 s30, 0
    s_cbranch_scc1 op42_nr0
    v_lshlrev_b32 v226, 8, v250
    v_mov_b32 v251, 1
    s_add_u32 s44, s54, 0
    s_mov_b64 exec, 15
    buffer_store_byte v251, v226, s[20:23], s44 offen sc1
    s_mov_b64 exec, -1
op42_nr0:
op42_q0:
    buffer_load_dword v226, off, s[20:23], s54 sc1
    s_waitcnt vmcnt(0)
    v_readfirstlane_b32 s40, v226
    s_nop 0
    s_cmp_eq_u32 s40, 0x01010101
    s_cbranch_scc1 op42_q0_ok
    s_sleep 4
    s_branch op42_q0
op42_q0_ok:
    s_add_u32 s94, s52, 32768
    s_add_u32 s95, s52, 65536
    s_add_u32 s96, s52, 98304
    buffer_load_dwordx4 v[100:103], v254, s[20:23], s94 offen offset:0 sc1
    buffer_load_dwordx4 v[104:107], v254, s[20:23], s95 offen offset:0 sc1
    buffer_load_dwordx4 v[108:111], v254, s[20:23], s96 offen offset:0 sc1
    s_mov_b32 s99, 0xffff0000
    s_add_u32 s44, s53, 0
    s_waitcnt vmcnt(0)
    v_lshlrev_b32 v251, 16, v100
    v_and_b32 v100, s99, v100
    v_lshlrev_b32 v252, 16, v101
    v_and_b32 v101, s99, v101
    v_add_f32 v0, v0, v251
    v_add_f32 v1, v1, v100
    v_add_f32 v2, v2, v252
    v_add_f32 v3, v3, v101
    v_lshlrev_b32 v251, 16, v104
    v_and_b32 v104, s99, v104
    v_lshlrev_b32 v252, 16, v105
    v_and_b32 v105, s99, v105
    v_add_f32 v0, v0, v251
    v_add_f32 v1, v1, v104
    v_add_f32 v2, v2, v252
    v_add_f32 v3, v3, v105
    v_lshlrev_b32 v251, 16, v108
    v_and_b32 v108, s99, v108
    v_lshlrev_b32 v252, 16, v109
    v_and_b32 v109, s99, v109
    v_add_f32 v0, v0, v251
    v_add_f32 v1, v1, v108
    v_add_f32 v2, v2, v252
    v_add_f32 v3, v3, v109
    v_cvt_pk_bf16_f32 v0, v0, v1
    v_cvt_pk_bf16_f32 v1, v2, v3
    buffer_store_dwordx2 v[0:1], v225, s[8:11], s44 offen
    s_add_u32 s44, s53, 32
    v_lshlrev_b32 v251, 16, v102
    v_and_b32 v102, s99, v102
    v_lshlrev_b32 v252, 16, v103
    v_and_b32 v103, s99, v103
    v_add_f32 v16, v16, v251
    v_add_f32 v17, v17, v102
    v_add_f32 v18, v18, v252
    v_add_f32 v19, v19, v103
    v_lshlrev_b32 v251, 16, v106
    v_and_b32 v106, s99, v106
    v_lshlrev_b32 v252, 16, v107
    v_and_b32 v107, s99, v107
    v_add_f32 v16, v16, v251
    v_add_f32 v17, v17, v106
    v_add_f32 v18, v18, v252
    v_add_f32 v19, v19, v107
    v_lshlrev_b32 v251, 16, v110
    v_and_b32 v110, s99, v110
    v_lshlrev_b32 v252, 16, v111
    v_and_b32 v111, s99, v111
    v_add_f32 v16, v16, v251
    v_add_f32 v17, v17, v110
    v_add_f32 v18, v18, v252
    v_add_f32 v19, v19, v111
    v_cvt_pk_bf16_f32 v16, v16, v17
    v_cvt_pk_bf16_f32 v17, v18, v19
    buffer_store_dwordx2 v[16:17], v225, s[8:11], s44 offen
    s_branch attn_fin
op42_k1:
    s_nop 7
    s_add_u32 s44, s52, 32768
    v_cvt_pk_bf16_f32 v0, v0, v1
    v_cvt_pk_bf16_f32 v1, v2, v3
    v_cvt_pk_bf16_f32 v2, v16, v17
    v_cvt_pk_bf16_f32 v3, v18, v19
    buffer_store_dwordx4 v[0:3], v254, s[20:23], s44 offen offset:0 sc1
    s_add_u32 s44, s52, 294912
    v_cvt_pk_bf16_f32 v8, v8, v9
    v_cvt_pk_bf16_f32 v9, v10, v11
    v_cvt_pk_bf16_f32 v10, v24, v25
    v_cvt_pk_bf16_f32 v11, v26, v27
    buffer_store_dwordx4 v[8:11], v254, s[20:23], s44 offen offset:0 sc1
    s_add_u32 s44, s52, 425984
    v_cvt_pk_bf16_f32 v12, v12, v13
    v_cvt_pk_bf16_f32 v13, v14, v15
    v_cvt_pk_bf16_f32 v14, v28, v29
    v_cvt_pk_bf16_f32 v15, v30, v31
    buffer_store_dwordx4 v[12:15], v254, s[20:23], s44 offen offset:0 sc1
    s_waitcnt vmcnt(0)
    s_barrier
    s_cmp_lg_u32 s30, 0
    s_cbranch_scc1 op42_nr1
    v_lshlrev_b32 v226, 8, v250
    v_mov_b32 v251, 1
    s_add_u32 s44, s54, -255
    s_mov_b64 exec, 15
    buffer_store_byte v251, v226, s[20:23], s44 offen sc1
    s_mov_b64 exec, -1
op42_nr1:
op42_q1:
    buffer_load_dword v226, off, s[20:23], s54 sc1
    s_waitcnt vmcnt(0)
    v_readfirstlane_b32 s40, v226
    s_nop 0
    s_cmp_eq_u32 s40, 0x01010101
    s_cbranch_scc1 op42_q1_ok
    s_sleep 4
    s_branch op42_q1
op42_q1_ok:
    s_add_u32 s94, s52, 131072
    s_add_u32 s95, s52, 196608
    s_add_u32 s96, s52, 229376
    buffer_load_dwordx4 v[100:103], v254, s[20:23], s94 offen offset:0 sc1
    buffer_load_dwordx4 v[104:107], v254, s[20:23], s95 offen offset:0 sc1
    buffer_load_dwordx4 v[108:111], v254, s[20:23], s96 offen offset:0 sc1
    s_mov_b32 s99, 0xffff0000
    s_add_u32 s44, s53, 18432
    s_waitcnt vmcnt(0)
    v_lshlrev_b32 v251, 16, v100
    v_and_b32 v100, s99, v100
    v_lshlrev_b32 v252, 16, v101
    v_and_b32 v101, s99, v101
    v_add_f32 v4, v4, v251
    v_add_f32 v5, v5, v100
    v_add_f32 v6, v6, v252
    v_add_f32 v7, v7, v101
    v_lshlrev_b32 v251, 16, v104
    v_and_b32 v104, s99, v104
    v_lshlrev_b32 v252, 16, v105
    v_and_b32 v105, s99, v105
    v_add_f32 v4, v4, v251
    v_add_f32 v5, v5, v104
    v_add_f32 v6, v6, v252
    v_add_f32 v7, v7, v105
    v_lshlrev_b32 v251, 16, v108
    v_and_b32 v108, s99, v108
    v_lshlrev_b32 v252, 16, v109
    v_and_b32 v109, s99, v109
    v_add_f32 v4, v4, v251
    v_add_f32 v5, v5, v108
    v_add_f32 v6, v6, v252
    v_add_f32 v7, v7, v109
    v_cvt_pk_bf16_f32 v4, v4, v5
    v_cvt_pk_bf16_f32 v5, v6, v7
    buffer_store_dwordx2 v[4:5], v225, s[8:11], s44 offen
    s_add_u32 s44, s53, 18464
    v_lshlrev_b32 v251, 16, v102
    v_and_b32 v102, s99, v102
    v_lshlrev_b32 v252, 16, v103
    v_and_b32 v103, s99, v103
    v_add_f32 v20, v20, v251
    v_add_f32 v21, v21, v102
    v_add_f32 v22, v22, v252
    v_add_f32 v23, v23, v103
    v_lshlrev_b32 v251, 16, v106
    v_and_b32 v106, s99, v106
    v_lshlrev_b32 v252, 16, v107
    v_and_b32 v107, s99, v107
    v_add_f32 v20, v20, v251
    v_add_f32 v21, v21, v106
    v_add_f32 v22, v22, v252
    v_add_f32 v23, v23, v107
    v_lshlrev_b32 v251, 16, v110
    v_and_b32 v110, s99, v110
    v_lshlrev_b32 v252, 16, v111
    v_and_b32 v111, s99, v111
    v_add_f32 v20, v20, v251
    v_add_f32 v21, v21, v110
    v_add_f32 v22, v22, v252
    v_add_f32 v23, v23, v111
    v_cvt_pk_bf16_f32 v20, v20, v21
    v_cvt_pk_bf16_f32 v21, v22, v23
    buffer_store_dwordx2 v[20:21], v225, s[8:11], s44 offen
    s_branch attn_fin
op42_k2:
    s_nop 7
    s_add_u32 s44, s52, 65536
    v_cvt_pk_bf16_f32 v0, v0, v1
    v_cvt_pk_bf16_f32 v1, v2, v3
    v_cvt_pk_bf16_f32 v2, v16, v17
    v_cvt_pk_bf16_f32 v3, v18, v19
    buffer_store_dwordx4 v[0:3], v254, s[20:23], s44 offen offset:0 sc1
    s_add_u32 s44, s52, 196608
    v_cvt_pk_bf16_f32 v4, v4, v5
    v_cvt_pk_bf16_f32 v5, v6, v7
    v_cvt_pk_bf16_f32 v6, v20, v21
    v_cvt_pk_bf16_f32 v7, v22, v23
    buffer_store_dwordx4 v[4:7], v254, s[20:23], s44 offen offset:0 sc1
    s_add_u32 s44, s52, 458752
    v_cvt_pk_bf16_f32 v12, v12, v13
    v_cvt_pk_bf16_f32 v13, v14, v15
    v_cvt_pk_bf16_f32 v14, v28, v29
    v_cvt_pk_bf16_f32 v15, v30, v31
    buffer_store_dwordx4 v[12:15], v254, s[20:23], s44 offen offset:0 sc1
    s_waitcnt vmcnt(0)
    s_barrier
    s_cmp_lg_u32 s30, 0
    s_cbranch_scc1 op42_nr2
    v_lshlrev_b32 v226, 8, v250
    v_mov_b32 v251, 1
    s_add_u32 s44, s54, -510
    s_mov_b64 exec, 15
    buffer_store_byte v251, v226, s[20:23], s44 offen sc1
    s_mov_b64 exec, -1
op42_nr2:
op42_q2:
    buffer_load_dword v226, off, s[20:23], s54 sc1
    s_waitcnt vmcnt(0)
    v_readfirstlane_b32 s40, v226
    s_nop 0
    s_cmp_eq_u32 s40, 0x01010101
    s_cbranch_scc1 op42_q2_ok
    s_sleep 4
    s_branch op42_q2
op42_q2_ok:
    s_add_u32 s94, s52, 262144
    s_add_u32 s95, s52, 294912
    s_add_u32 s96, s52, 360448
    buffer_load_dwordx4 v[100:103], v254, s[20:23], s94 offen offset:0 sc1
    buffer_load_dwordx4 v[104:107], v254, s[20:23], s95 offen offset:0 sc1
    buffer_load_dwordx4 v[108:111], v254, s[20:23], s96 offen offset:0 sc1
    s_mov_b32 s99, 0xffff0000
    s_add_u32 s44, s53, 36864
    s_waitcnt vmcnt(0)
    v_lshlrev_b32 v251, 16, v100
    v_and_b32 v100, s99, v100
    v_lshlrev_b32 v252, 16, v101
    v_and_b32 v101, s99, v101
    v_add_f32 v8, v8, v251
    v_add_f32 v9, v9, v100
    v_add_f32 v10, v10, v252
    v_add_f32 v11, v11, v101
    v_lshlrev_b32 v251, 16, v104
    v_and_b32 v104, s99, v104
    v_lshlrev_b32 v252, 16, v105
    v_and_b32 v105, s99, v105
    v_add_f32 v8, v8, v251
    v_add_f32 v9, v9, v104
    v_add_f32 v10, v10, v252
    v_add_f32 v11, v11, v105
    v_lshlrev_b32 v251, 16, v108
    v_and_b32 v108, s99, v108
    v_lshlrev_b32 v252, 16, v109
    v_and_b32 v109, s99, v109
    v_add_f32 v8, v8, v251
    v_add_f32 v9, v9, v108
    v_add_f32 v10, v10, v252
    v_add_f32 v11, v11, v109
    v_cvt_pk_bf16_f32 v8, v8, v9
    v_cvt_pk_bf16_f32 v9, v10, v11
    buffer_store_dwordx2 v[8:9], v225, s[8:11], s44 offen
    s_add_u32 s44, s53, 36896
    v_lshlrev_b32 v251, 16, v102
    v_and_b32 v102, s99, v102
    v_lshlrev_b32 v252, 16, v103
    v_and_b32 v103, s99, v103
    v_add_f32 v24, v24, v251
    v_add_f32 v25, v25, v102
    v_add_f32 v26, v26, v252
    v_add_f32 v27, v27, v103
    v_lshlrev_b32 v251, 16, v106
    v_and_b32 v106, s99, v106
    v_lshlrev_b32 v252, 16, v107
    v_and_b32 v107, s99, v107
    v_add_f32 v24, v24, v251
    v_add_f32 v25, v25, v106
    v_add_f32 v26, v26, v252
    v_add_f32 v27, v27, v107
    v_lshlrev_b32 v251, 16, v110
    v_and_b32 v110, s99, v110
    v_lshlrev_b32 v252, 16, v111
    v_and_b32 v111, s99, v111
    v_add_f32 v24, v24, v251
    v_add_f32 v25, v25, v110
    v_add_f32 v26, v26, v252
    v_add_f32 v27, v27, v111
    v_cvt_pk_bf16_f32 v24, v24, v25
    v_cvt_pk_bf16_f32 v25, v26, v27
    buffer_store_dwordx2 v[24:25], v225, s[8:11], s44 offen
    s_branch attn_fin
op53:
    v_mov_b64 v[0:1], 0
    v_mov_b64 v[2:3], 0
    v_mov_b64 v[4:5], 0
    v_mov_b64 v[6:7], 0
    v_mov_b64 v[8:9], 0
    v_mov_b64 v[10:11], 0
    v_mov_b64 v[12:13], 0
    v_mov_b64 v[14:15], 0
    v_mov_b64 v[16:17], 0
    v_mov_b64 v[18:19], 0
    v_mov_b64 v[20:21], 0
    v_mov_b64 v[22:23], 0
    v_mov_b64 v[24:25], 0
    v_mov_b64 v[26:27], 0
    v_mov_b64 v[28:29], 0
    v_mov_b64 v[30:31], 0
    v_mov_b64 v[32:33], 0
    v_mov_b64 v[34:35], 0
    v_mov_b64 v[36:37], 0
    v_mov_b64 v[38:39], 0
    v_mov_b64 v[40:41], 0
    v_mov_b64 v[42:43], 0
    v_mov_b64 v[44:45], 0
    v_mov_b64 v[46:47], 0
    v_mov_b64 v[48:49], 0
    v_mov_b64 v[50:51], 0
    v_mov_b64 v[52:53], 0
    v_mov_b64 v[54:55], 0
    v_mov_b64 v[56:57], 0
    v_mov_b64 v[58:59], 0
    v_mov_b64 v[132:133], 0
    v_mov_b64 v[134:135], 0
    v_mov_b64 v[136:137], 0
    v_mov_b64 v[138:139], 0
    v_mov_b64 v[140:141], 0
    v_mov_b64 v[142:143], 0
    v_mov_b64 v[144:145], 0
    v_mov_b64 v[146:147], 0
    v_mov_b64 v[148:149], 0
    v_mov_b64 v[150:151], 0
    v_mov_b64 v[152:153], 0
    v_mov_b64 v[154:155], 0
    v_mov_b64 v[156:157], 0
    v_mov_b64 v[158:159], 0
    v_mov_b64 v[160:161], 0
    v_mov_b64 v[162:163], 0
    s_waitcnt vmcnt(0)
    s_barrier
    s_cmp_lg_u32 s30, 0
    s_cbranch_scc1 op53_g0_nf
    s_add_u32 s44, s85, s98
    v_mov_b32 v251, 1
    s_mov_b64 exec, 1
    buffer_store_byte v251, off, s[20:23], s44 sc1
    s_mov_b64 exec, -1
op53_g0_nf:
    s_cmp_lg_u32 s41, 0
    s_cbranch_scc1 op53_g0_nl
    buffer_load_dword v226, off, s[20:23], s98 sc1
op53_g0_nl:
    v_mfma_f32_16x16x32_bf16 v[0:3], v[152:155], v[132:135], v[0:3]
    ds_read_b64_tr_b16 v[120:121], v222 offset:0
    v_mfma_f32_16x16x32_bf16 v[4:7], v[152:155], v[136:139], v[4:7]
    ds_read_b64_tr_b16 v[122:123], v222 offset:576
    v_mfma_f32_16x16x32_bf16 v[8:11], v[152:155], v[140:143], v[8:11]
    ds_read_b128 v[100:103], v221 offset:0
    v_mfma_f32_16x16x32_bf16 v[12:15], v[152:155], v[144:147], v[12:15]
    v_mfma_f32_16x16x32_bf16 v[16:19], v[152:155], v[148:151], v[16:19]
    ds_read_b128 v[104:107], v221 offset:2048
    v_mfma_f32_16x16x32_bf16 v[20:23], v[156:159], v[132:135], v[20:23]
    ds_read_b128 v[108:111], v221 offset:4096
    v_mfma_f32_16x16x32_bf16 v[24:27], v[156:159], v[136:139], v[24:27]
    ds_read_b128 v[112:115], v221 offset:6144
    v_mfma_f32_16x16x32_bf16 v[28:31], v[156:159], v[140:143], v[28:31]
    ds_read_b128 v[116:119], v221 offset:8192
    v_mfma_f32_16x16x32_bf16 v[32:35], v[156:159], v[144:147], v[32:35]
    ds_read_b64_tr_b16 v[124:125], v222 offset:32
    v_mfma_f32_16x16x32_bf16 v[36:39], v[156:159], v[148:151], v[36:39]
    v_mfma_f32_16x16x32_bf16 v[40:43], v[160:163], v[132:135], v[40:43]
    ds_read_b64_tr_b16 v[126:127], v222 offset:608
    v_mfma_f32_16x16x32_bf16 v[44:47], v[160:163], v[136:139], v[44:47]
    ds_read_b64_tr_b16 v[128:129], v222 offset:64
    v_mfma_f32_16x16x32_bf16 v[48:51], v[160:163], v[140:143], v[48:51]
    ds_read_b64_tr_b16 v[130:131], v222 offset:640
    v_mfma_f32_16x16x32_bf16 v[52:55], v[160:163], v[144:147], v[52:55]
    v_mfma_f32_16x16x32_bf16 v[56:59], v[160:163], v[148:151], v[56:59]
    s_waitcnt lgkmcnt(6)
    v_mfma_f32_16x16x32_bf16 v[0:3], v[120:123], v[100:103], v[0:3]
    ds_read_b64_tr_b16 v[152:153], v222 offset:9472
    v_mfma_f32_16x16x32_bf16 v[4:7], v[120:123], v[104:107], v[4:7]
    ds_read_b64_tr_b16 v[154:155], v222 offset:10048
    v_mfma_f32_16x16x32_bf16 v[8:11], v[120:123], v[108:111], v[8:11]
    ds_read_b128 v[132:135], v221 offset:1024
    s_waitcnt lgkmcnt(5)
    v_mfma_f32_16x16x32_bf16 v[12:15], v[120:123], v[112:115], v[12:15]
    v_mfma_f32_16x16x32_bf16 v[16:19], v[120:123], v[116:119], v[16:19]
    ds_read_b128 v[136:139], v221 offset:3072
    v_mfma_f32_16x16x32_bf16 v[20:23], v[124:127], v[100:103], v[20:23]
    ds_read_b128 v[140:143], v221 offset:5120
    v_mfma_f32_16x16x32_bf16 v[24:27], v[124:127], v[104:107], v[24:27]
    ds_read_b128 v[144:147], v221 offset:7168
    v_mfma_f32_16x16x32_bf16 v[28:31], v[124:127], v[108:111], v[28:31]
    ds_read_b128 v[148:151], v221 offset:9216
    v_mfma_f32_16x16x32_bf16 v[32:35], v[124:127], v[112:115], v[32:35]
    ds_read_b64_tr_b16 v[156:157], v222 offset:9504
    v_mfma_f32_16x16x32_bf16 v[36:39], v[124:127], v[116:119], v[36:39]
    s_waitcnt lgkmcnt(8)
    v_mfma_f32_16x16x32_bf16 v[40:43], v[128:131], v[100:103], v[40:43]
    ds_read_b64_tr_b16 v[158:159], v222 offset:10080
    v_mfma_f32_16x16x32_bf16 v[44:47], v[128:131], v[104:107], v[44:47]
    ds_read_b64_tr_b16 v[160:161], v222 offset:9536
    v_mfma_f32_16x16x32_bf16 v[48:51], v[128:131], v[108:111], v[48:51]
    ds_read_b64_tr_b16 v[162:163], v222 offset:10112
    v_mfma_f32_16x16x32_bf16 v[52:55], v[128:131], v[112:115], v[52:55]
    v_mfma_f32_16x16x32_bf16 v[56:59], v[128:131], v[116:119], v[56:59]
    s_waitcnt lgkmcnt(0)
    s_cmp_lg_u32 s41, 0
    s_cbranch_scc1 op53_g1_nw
    s_waitcnt vmcnt(0)
    v_readfirstlane_b32 s40, v226
op53_g1_nw:
    s_barrier
    s_add_u32 s44, s42, s85
    s_and_b32 s44, s44, 3
    s_lshl_b32 s44, s44, 3
    s_bitcmp1_b32 s40, s44
    s_cbranch_scc0 op53_g1_ie
op53_g1_il:
    s_mul_i32 s99, s41, 19456
    s_add_u32 m0, s43, s99
    s_add_u32 s45, s46, 8192
    buffer_load_dwordx4 v254, s[20:23], s46 offen sc1 lds
    s_add_u32 m0, m0, 8192
    s_add_u32 s46, s46, 18432
    buffer_load_dwordx4 v254, s[20:23], s45 offen sc1 lds
    s_add_u32 m0, s78, s99
    s_nop 0
    buffer_load_dwordx4 v244, s[16:19], s47 offen sc1 lds
    s_add_u32 m0, s79, s99
    s_add_u32 s47, s47, s48
    buffer_load_dwordx4 v245, s[12:15], s77 offen lds
    s_add_u32 m0, s80, s99
    s_nop 0
    buffer_load_dwordx4 v246, s[12:15], s77 offen lds
    s_add_u32 s77, s77, 73728
    s_add_u32 s41, s41, 1
    s_cmp_lt_u32 s41, 1
    s_cbranch_scc1 op53_g1_il
op53_g1_ie:
    s_cmp_lg_u32 s41, 0
    s_cbranch_scc1 op53_g1_nl
    buffer_load_dword v226, off, s[20:23], s98 sc1
op53_g1_nl:
    v_mfma_f32_16x16x32_bf16 v[0:3], v[152:155], v[132:135], v[0:3]
    ds_read_b64_tr_b16 v[120:121], v222 offset:19456
    v_mfma_f32_16x16x32_bf16 v[4:7], v[152:155], v[136:139], v[4:7]
    ds_read_b64_tr_b16 v[122:123], v222 offset:20032
    v_mfma_f32_16x16x32_bf16 v[8:11], v[152:155], v[140:143], v[8:11]
    ds_read_b128 v[100:103], v221 offset:19456
    v_mfma_f32_16x16x32_bf16 v[12:15], v[152:155], v[144:147], v[12:15]
    v_mfma_f32_16x16x32_bf16 v[16:19], v[152:155], v[148:151], v[16:19]
    ds_read_b128 v[104:107], v221 offset:21504
    v_mfma_f32_16x16x32_bf16 v[20:23], v[156:159], v[132:135], v[20:23]
    ds_read_b128 v[108:111], v221 offset:23552
    v_mfma_f32_16x16x32_bf16 v[24:27], v[156:159], v[136:139], v[24:27]
    ds_read_b128 v[112:115], v221 offset:25600
    v_mfma_f32_16x16x32_bf16 v[28:31], v[156:159], v[140:143], v[28:31]
    ds_read_b128 v[116:119], v221 offset:27648
    v_mfma_f32_16x16x32_bf16 v[32:35], v[156:159], v[144:147], v[32:35]
    ds_read_b64_tr_b16 v[124:125], v222 offset:19488
    v_mfma_f32_16x16x32_bf16 v[36:39], v[156:159], v[148:151], v[36:39]
    v_mfma_f32_16x16x32_bf16 v[40:43], v[160:163], v[132:135], v[40:43]
    ds_read_b64_tr_b16 v[126:127], v222 offset:20064
    v_mfma_f32_16x16x32_bf16 v[44:47], v[160:163], v[136:139], v[44:47]
    ds_read_b64_tr_b16 v[128:129], v222 offset:19520
    v_mfma_f32_16x16x32_bf16 v[48:51], v[160:163], v[140:143], v[48:51]
    ds_read_b64_tr_b16 v[130:131], v222 offset:20096
    v_mfma_f32_16x16x32_bf16 v[52:55], v[160:163], v[144:147], v[52:55]
    v_mfma_f32_16x16x32_bf16 v[56:59], v[160:163], v[148:151], v[56:59]
    s_waitcnt lgkmcnt(6)
    v_mfma_f32_16x16x32_bf16 v[0:3], v[120:123], v[100:103], v[0:3]
    ds_read_b64_tr_b16 v[152:153], v222 offset:28928
    v_mfma_f32_16x16x32_bf16 v[4:7], v[120:123], v[104:107], v[4:7]
    ds_read_b64_tr_b16 v[154:155], v222 offset:29504
    v_mfma_f32_16x16x32_bf16 v[8:11], v[120:123], v[108:111], v[8:11]
    ds_read_b128 v[132:135], v221 offset:20480
    s_waitcnt lgkmcnt(5)
    v_mfma_f32_16x16x32_bf16 v[12:15], v[120:123], v[112:115], v[12:15]
    v_mfma_f32_16x16x32_bf16 v[16:19], v[120:123], v[116:119], v[16:19]
    ds_read_b128 v[136:139], v221 offset:22528
    v_mfma_f32_16x16x32_bf16 v[20:23], v[124:127], v[100:103], v[20:23]
    ds_read_b128 v[140:143], v221 offset:24576
    v_mfma_f32_16x16x32_bf16 v[24:27], v[124:127], v[104:107], v[24:27]
    ds_read_b128 v[144:147], v221 offset:26624
    v_mfma_f32_16x16x32_bf16 v[28:31], v[124:127], v[108:111], v[28:31]
    ds_read_b128 v[148:151], v221 offset:28672
    v_mfma_f32_16x16x32_bf16 v[32:35], v[124:127], v[112:115], v[32:35]
    ds_read_b64_tr_b16 v[156:157], v222 offset:28960
    v_mfma_f32_16x16x32_bf16 v[36:39], v[124:127], v[116:119], v[36:39]
    s_waitcnt lgkmcnt(8)
    v_mfma_f32_16x16x32_bf16 v[40:43], v[128:131], v[100:103], v[40:43]
    ds_read_b64_tr_b16 v[158:159], v222 offset:29536
    v_mfma_f32_16x16x32_bf16 v[44:47], v[128:131], v[104:107], v[44:47]
    ds_read_b64_tr_b16 v[160:161], v222 offset:28992
    v_mfma_f32_16x16x32_bf16 v[48:51], v[128:131], v[108:111], v[48:51]
    ds_read_b64_tr_b16 v[162:163], v222 offset:29568
    v_mfma_f32_16x16x32_bf16 v[52:55], v[128:131], v[112:115], v[52:55]
    v_mfma_f32_16x16x32_bf16 v[56:59], v[128:131], v[116:119], v[56:59]
    s_waitcnt lgkmcnt(0)
    s_cmp_lg_u32 s41, 0
    s_cbranch_scc1 op53_g2_nw
    s_waitcnt vmcnt(0)
    v_readfirstlane_b32 s40, v226
op53_g2_nw:
    s_barrier
    s_add_u32 s44, s42, s85
    s_and_b32 s44, s44, 3
    s_lshl_b32 s44, s44, 3
    s_bitcmp1_b32 s40, s44
    s_cbranch_scc0 op53_g2_ie
op53_g2_il:
    s_mul_i32 s99, s41, 19456
    s_add_u32 m0, s43, s99
    s_add_u32 s45, s46, 8192
    buffer_load_dwordx4 v254, s[20:23], s46 offen sc1 lds
    s_add_u32 m0, m0, 8192
    s_add_u32 s46, s46, 18432
    buffer_load_dwordx4 v254, s[20:23], s45 offen sc1 lds
    s_add_u32 m0, s78, s99
    s_nop 0
    buffer_load_dwordx4 v244, s[16:19], s47 offen sc1 lds
    s_add_u32 m0, s79, s99
    s_add_u32 s47, s47, s48
    buffer_load_dwordx4 v245, s[12:15], s77 offen lds
    s_add_u32 m0, s80, s99
    s_nop 0
    buffer_load_dwordx4 v246, s[12:15], s77 offen lds
    s_add_u32 s77, s77, 73728
    s_add_u32 s41, s41, 1
    s_cmp_lt_u32 s41, 2
    s_cbranch_scc1 op53_g2_il
op53_g2_ie:
    s_cmp_lg_u32 s41, 0
    s_cbranch_scc1 op53_g2_nl
    buffer_load_dword v226, off, s[20:23], s98 sc1
op53_g2_nl:
    v_mfma_f32_16x16x32_bf16 v[0:3], v[152:155], v[132:135], v[0:3]
    ds_read_b64_tr_b16 v[120:121], v224 offset:0
    v_mfma_f32_16x16x32_bf16 v[4:7], v[152:155], v[136:139], v[4:7]
    ds_read_b64_tr_b16 v[122:123], v224 offset:576
    v_mfma_f32_16x16x32_bf16 v[8:11], v[152:155], v[140:143], v[8:11]
    ds_read_b128 v[100:103], v223 offset:0
    v_mfma_f32_16x16x32_bf16 v[12:15], v[152:155], v[144:147], v[12:15]
    v_mfma_f32_16x16x32_bf16 v[16:19], v[152:155], v[148:151], v[16:19]
    ds_read_b128 v[104:107], v223 offset:2048
    v_mfma_f32_16x16x32_bf16 v[20:23], v[156:159], v[132:135], v[20:23]
    ds_read_b128 v[108:111], v223 offset:4096
    v_mfma_f32_16x16x32_bf16 v[24:27], v[156:159], v[136:139], v[24:27]
    ds_read_b128 v[112:115], v223 offset:6144
    v_mfma_f32_16x16x32_bf16 v[28:31], v[156:159], v[140:143], v[28:31]
    ds_read_b128 v[116:119], v223 offset:8192
    v_mfma_f32_16x16x32_bf16 v[32:35], v[156:159], v[144:147], v[32:35]
    ds_read_b64_tr_b16 v[124:125], v224 offset:32
    v_mfma_f32_16x16x32_bf16 v[36:39], v[156:159], v[148:151], v[36:39]
    v_mfma_f32_16x16x32_bf16 v[40:43], v[160:163], v[132:135], v[40:43]
    ds_read_b64_tr_b16 v[126:127], v224 offset:608
    v_mfma_f32_16x16x32_bf16 v[44:47], v[160:163], v[136:139], v[44:47]
    ds_read_b64_tr_b16 v[128:129], v224 offset:64
    v_mfma_f32_16x16x32_bf16 v[48:51], v[160:163], v[140:143], v[48:51]
    ds_read_b64_tr_b16 v[130:131], v224 offset:640
    v_mfma_f32_16x16x32_bf16 v[52:55], v[160:163], v[144:147], v[52:55]
    v_mfma_f32_16x16x32_bf16 v[56:59], v[160:163], v[148:151], v[56:59]
    s_waitcnt lgkmcnt(6)
    v_mfma_f32_16x16x32_bf16 v[0:3], v[120:123], v[100:103], v[0:3]
    ds_read_b64_tr_b16 v[152:153], v224 offset:9472
    v_mfma_f32_16x16x32_bf16 v[4:7], v[120:123], v[104:107], v[4:7]
    ds_read_b64_tr_b16 v[154:155], v224 offset:10048
    v_mfma_f32_16x16x32_bf16 v[8:11], v[120:123], v[108:111], v[8:11]
    ds_read_b128 v[132:135], v223 offset:1024
    s_waitcnt lgkmcnt(5)
    v_mfma_f32_16x16x32_bf16 v[12:15], v[120:123], v[112:115], v[12:15]
    v_mfma_f32_16x16x32_bf16 v[16:19], v[120:123], v[116:119], v[16:19]
    ds_read_b128 v[136:139], v223 offset:3072
    v_mfma_f32_16x16x32_bf16 v[20:23], v[124:127], v[100:103], v[20:23]
    ds_read_b128 v[140:143], v223 offset:5120
    v_mfma_f32_16x16x32_bf16 v[24:27], v[124:127], v[104:107], v[24:27]
    ds_read_b128 v[144:147], v223 offset:7168
    v_mfma_f32_16x16x32_bf16 v[28:31], v[124:127], v[108:111], v[28:31]
    ds_read_b128 v[148:151], v223 offset:9216
    v_mfma_f32_16x16x32_bf16 v[32:35], v[124:127], v[112:115], v[32:35]
    ds_read_b64_tr_b16 v[156:157], v224 offset:9504
    v_mfma_f32_16x16x32_bf16 v[36:39], v[124:127], v[116:119], v[36:39]
    s_waitcnt lgkmcnt(8)
    v_mfma_f32_16x16x32_bf16 v[40:43], v[128:131], v[100:103], v[40:43]
    ds_read_b64_tr_b16 v[158:159], v224 offset:10080
    v_mfma_f32_16x16x32_bf16 v[44:47], v[128:131], v[104:107], v[44:47]
    ds_read_b64_tr_b16 v[160:161], v224 offset:9536
    v_mfma_f32_16x16x32_bf16 v[48:51], v[128:131], v[108:111], v[48:51]
    ds_read_b64_tr_b16 v[162:163], v224 offset:10112
    v_mfma_f32_16x16x32_bf16 v[52:55], v[128:131], v[112:115], v[52:55]
    v_mfma_f32_16x16x32_bf16 v[56:59], v[128:131], v[116:119], v[56:59]
    s_waitcnt lgkmcnt(0)
    s_cmp_lg_u32 s41, 0
    s_cbranch_scc1 op53_g3_nw
    s_waitcnt vmcnt(0)
    v_readfirstlane_b32 s40, v226
op53_g3_nw:
    s_barrier
    s_add_u32 s44, s42, s85
    s_and_b32 s44, s44, 3
    s_lshl_b32 s44, s44, 3
    s_bitcmp1_b32 s40, s44
    s_cbranch_scc0 op53_g3_ie
op53_g3_il:
    s_mul_i32 s99, s41, 19456
    s_add_u32 m0, s43, s99
    s_add_u32 s45, s46, 8192
    buffer_load_dwordx4 v254, s[20:23], s46 offen sc1 lds
    s_add_u32 m0, m0, 8192
    s_add_u32 s46, s46, 18432
    buffer_load_dwordx4 v254, s[20:23], s45 offen sc1 lds
    s_add_u32 m0, s78, s99
    s_nop 0
    buffer_load_dwordx4 v244, s[16:19], s47 offen sc1 lds
    s_add_u32 m0, s79, s99
    s_add_u32 s47, s47, s48
    buffer_load_dwordx4 v245, s[12:15], s77 offen lds
    s_add_u32 m0, s80, s99
    s_nop 0
    buffer_load_dwordx4 v246, s[12:15], s77 offen lds
    s_add_u32 s77, s77, 73728
    s_add_u32 s41, s41, 1
    s_cmp_lt_u32 s41, 3
    s_cbranch_scc1 op53_g3_il
op53_g3_ie:
    s_cmp_lg_u32 s41, 0
    s_cbranch_scc1 op53_g3_nl
    buffer_load_dword v226, off, s[20:23], s98 sc1
op53_g3_nl:
    v_mfma_f32_16x16x32_bf16 v[0:3], v[152:155], v[132:135], v[0:3]
    ds_read_b64_tr_b16 v[120:121], v224 offset:19456
    v_mfma_f32_16x16x32_bf16 v[4:7], v[152:155], v[136:139], v[4:7]
    ds_read_b64_tr_b16 v[122:123], v224 offset:20032
    v_mfma_f32_16x16x32_bf16 v[8:11], v[152:155], v[140:143], v[8:11]
    ds_read_b128 v[100:103], v223 offset:19456
    v_mfma_f32_16x16x32_bf16 v[12:15], v[152:155], v[144:147], v[12:15]
    v_mfma_f32_16x16x32_bf16 v[16:19], v[152:155], v[148:151], v[16:19]
    ds_read_b128 v[104:107], v223 offset:21504
    v_mfma_f32_16x16x32_bf16 v[20:23], v[156:159], v[132:135], v[20:23]
    ds_read_b128 v[108:111], v223 offset:23552
    v_mfma_f32_16x16x32_bf16 v[24:27], v[156:159], v[136:139], v[24:27]
    ds_read_b128 v[112:115], v223 offset:25600
    v_mfma_f32_16x16x32_bf16 v[28:31], v[156:159], v[140:143], v[28:31]
    ds_read_b128 v[116:119], v223 offset:27648
    v_mfma_f32_16x16x32_bf16 v[32:35], v[156:159], v[144:147], v[32:35]
    ds_read_b64_tr_b16 v[124:125], v224 offset:19488
    v_mfma_f32_16x16x32_bf16 v[36:39], v[156:159], v[148:151], v[36:39]
    v_mfma_f32_16x16x32_bf16 v[40:43], v[160:163], v[132:135], v[40:43]
    ds_read_b64_tr_b16 v[126:127], v224 offset:20064
    v_mfma_f32_16x16x32_bf16 v[44:47], v[160:163], v[136:139], v[44:47]
    ds_read_b64_tr_b16 v[128:129], v224 offset:19520
    v_mfma_f32_16x16x32_bf16 v[48:51], v[160:163], v[140:143], v[48:51]
    ds_read_b64_tr_b16 v[130:131], v224 offset:20096
    v_mfma_f32_16x16x32_bf16 v[52:55], v[160:163], v[144:147], v[52:55]
    v_mfma_f32_16x16x32_bf16 v[56:59], v[160:163], v[148:151], v[56:59]
    s_waitcnt lgkmcnt(6)
    v_mfma_f32_16x16x32_bf16 v[0:3], v[120:123], v[100:103], v[0:3]
    ds_read_b64_tr_b16 v[152:153], v224 offset:28928
    v_mfma_f32_16x16x32_bf16 v[4:7], v[120:123], v[104:107], v[4:7]
    ds_read_b64_tr_b16 v[154:155], v224 offset:29504
    v_mfma_f32_16x16x32_bf16 v[8:11], v[120:123], v[108:111], v[8:11]
    ds_read_b128 v[132:135], v223 offset:20480
    s_waitcnt lgkmcnt(5)
    v_mfma_f32_16x16x32_bf16 v[12:15], v[120:123], v[112:115], v[12:15]
    v_mfma_f32_16x16x32_bf16 v[16:19], v[120:123], v[116:119], v[16:19]
    ds_read_b128 v[136:139], v223 offset:22528
    v_mfma_f32_16x16x32_bf16 v[20:23], v[124:127], v[100:103], v[20:23]
    ds_read_b128 v[140:143], v223 offset:24576
    v_mfma_f32_16x16x32_bf16 v[24:27], v[124:127], v[104:107], v[24:27]
    ds_read_b128 v[144:147], v223 offset:26624
    v_mfma_f32_16x16x32_bf16 v[28:31], v[124:127], v[108:111], v[28:31]
    ds_read_b128 v[148:151], v223 offset:28672
    v_mfma_f32_16x16x32_bf16 v[32:35], v[124:127], v[112:115], v[32:35]
    ds_read_b64_tr_b16 v[156:157], v224 offset:28960
    v_mfma_f32_16x16x32_bf16 v[36:39], v[124:127], v[116:119], v[36:39]
    s_waitcnt lgkmcnt(8)
    v_mfma_f32_16x16x32_bf16 v[40:43], v[128:131], v[100:103], v[40:43]
    ds_read_b64_tr_b16 v[158:159], v224 offset:29536
    v_mfma_f32_16x16x32_bf16 v[44:47], v[128:131], v[104:107], v[44:47]
    ds_read_b64_tr_b16 v[160:161], v224 offset:28992
    v_mfma_f32_16x16x32_bf16 v[48:51], v[128:131], v[108:111], v[48:51]
    ds_read_b64_tr_b16 v[162:163], v224 offset:29568
    v_mfma_f32_16x16x32_bf16 v[52:55], v[128:131], v[112:115], v[52:55]
    v_mfma_f32_16x16x32_bf16 v[56:59], v[128:131], v[116:119], v[56:59]
    s_waitcnt lgkmcnt(0)
    s_cmp_lg_u32 s41, 0
    s_cbranch_scc1 op53_j3
    s_waitcnt vmcnt(0)
    v_readfirstlane_b32 s40, v226
    s_add_u32 s44, s42, s85
    s_and_b32 s44, s44, 3
    s_lshl_b32 s44, s44, 3
    s_bitcmp1_b32 s40, s44
    s_cbranch_scc1 op53_p0_ok
op53_p0:
    buffer_load_dword v226, off, s[20:23], s98 sc1
    s_waitcnt vmcnt(0)
    v_readfirstlane_b32 s40, v226
    s_add_u32 s44, s42, s85
    s_and_b32 s44, s44, 3
    s_lshl_b32 s44, s44, 3
    s_bitcmp1_b32 s40, s44
    s_cbranch_scc1 op53_p0_ok
    s_sleep 4
    s_branch op53_p0
op53_p0_ok:
    buffer_load_dword v226, off, s[20:23], s98 sc1
    s_add_u32 m0, s43, 0
    s_add_u32 s45, s46, 8192
    buffer_load_dwordx4 v254, s[20:23], s46 offen sc1 lds
    s_add_u32 m0, m0, 8192
    s_add_u32 s46, s46, 18432
    buffer_load_dwordx4 v254, s[20:23], s45 offen sc1 lds
    s_add_u32 m0, s78, 0
    s_nop 0
    buffer_load_dwordx4 v244, s[16:19], s47 offen sc1 lds
    s_add_u32 m0, s79, 0
    s_add_u32 s47, s47, s48
    buffer_load_dwordx4 v245, s[12:15], s77 offen lds
    s_add_u32 m0, s80, 0
    s_nop 0
    buffer_load_dwordx4 v246, s[12:15], s77 offen lds
    s_add_u32 s77, s77, 73728
    s_add_u32 m0, s43, 19456
    s_add_u32 s45, s46, 8192
    buffer_load_dwordx4 v254, s[20:23], s46 offen sc1 lds
    s_add_u32 m0, m0, 8192
    s_add_u32 s46, s46, 18432
    buffer_load_dwordx4 v254, s[20:23], s45 offen sc1 lds
    s_add_u32 m0, s78, 19456
    s_nop 0
    buffer_load_dwordx4 v244, s[16:19], s47 offen sc1 lds
    s_add_u32 m0, s79, 19456
    s_add_u32 s47, s47, s48
    buffer_load_dwordx4 v245, s[12:15], s77 offen lds
    s_add_u32 m0, s80, 19456
    s_nop 0
    buffer_load_dwordx4 v246, s[12:15], s77 offen lds
    s_add_u32 s77, s77, 73728
    s_add_u32 m0, s43, 38912
    s_add_u32 s45, s46, 8192
    buffer_load_dwordx4 v254, s[20:23], s46 offen sc1 lds
    s_add_u32 m0, m0, 8192
    s_add_u32 s46, s46, 18432
    buffer_load_dwordx4 v254, s[20:23], s45 offen sc1 lds
    s_add_u32 m0, s78, 38912
    s_nop 0
    buffer_load_dwordx4 v244, s[16:19], s47 offen sc1 lds
    s_add_u32 m0, s79, 38912
    s_add_u32 s47, s47, s48
    buffer_load_dwordx4 v245, s[12:15], s77 offen lds
    s_add_u32 m0, s80, 38912
    s_nop 0
    buffer_load_dwordx4 v246, s[12:15], s77 offen lds
    s_add_u32 s77, s77, 73728
op53_j3:
op53_loop:
    s_waitcnt vmcnt(10)
    s_barrier
    v_mfma_f32_16x16x32_bf16 v[0:3], v[152:155], v[132:135], v[0:3]
    ds_read_b64_tr_b16 v[120:121], v222 offset:0
    v_mfma_f32_16x16x32_bf16 v[4:7], v[152:155], v[136:139], v[4:7]
    ds_read_b64_tr_b16 v[122:123], v222 offset:576
    s_add_u32 m0, s43, 58368
    v_mfma_f32_16x16x32_bf16 v[8:11], v[152:155], v[140:143], v[8:11]
    ds_read_b128 v[100:103], v221 offset:0
    v_mfma_f32_16x16x32_bf16 v[12:15], v[152:155], v[144:147], v[12:15]
    s_add_u32 s45, s46, 8192
    v_mfma_f32_16x16x32_bf16 v[16:19], v[152:155], v[148:151], v[16:19]
    ds_read_b128 v[104:107], v221 offset:2048
    v_mfma_f32_16x16x32_bf16 v[20:23], v[156:159], v[132:135], v[20:23]
    ds_read_b128 v[108:111], v221 offset:4096
    buffer_load_dwordx4 v254, s[20:23], s46 offen sc1 lds
    v_mfma_f32_16x16x32_bf16 v[24:27], v[156:159], v[136:139], v[24:27]
    ds_read_b128 v[112:115], v221 offset:6144
    v_mfma_f32_16x16x32_bf16 v[28:31], v[156:159], v[140:143], v[28:31]
    ds_read_b128 v[116:119], v221 offset:8192
    v_mfma_f32_16x16x32_bf16 v[32:35], v[156:159], v[144:147], v[32:35]
    ds_read_b64_tr_b16 v[124:125], v222 offset:32
    v_mfma_f32_16x16x32_bf16 v[36:39], v[156:159], v[148:151], v[36:39]
    s_add_u32 m0, m0, 8192
    s_add_u32 s46, s46, 18432
    v_mfma_f32_16x16x32_bf16 v[40:43], v[160:163], v[132:135], v[40:43]
    ds_read_b64_tr_b16 v[126:127], v222 offset:608
    v_mfma_f32_16x16x32_bf16 v[44:47], v[160:163], v[136:139], v[44:47]
    ds_read_b64_tr_b16 v[128:129], v222 offset:64
    v_mfma_f32_16x16x32_bf16 v[48:51], v[160:163], v[140:143], v[48:51]
    ds_read_b64_tr_b16 v[130:131], v222 offset:640
    v_mfma_f32_16x16x32_bf16 v[52:55], v[160:163], v[144:147], v[52:55]
    buffer_load_dwordx4 v254, s[20:23], s45 offen sc1 lds
    s_add_u32 m0, s78, 58368
    v_mfma_f32_16x16x32_bf16 v[56:59], v[160:163], v[148:151], v[56:59]
    s_nop 0
    s_waitcnt lgkmcnt(6)
    v_mfma_f32_16x16x32_bf16 v[0:3], v[120:123], v[100:103], v[0:3]
    ds_read_b64_tr_b16 v[152:153], v222 offset:9472
    v_mfma_f32_16x16x32_bf16 v[4:7], v[120:123], v[104:107], v[4:7]
    ds_read_b64_tr_b16 v[154:155], v222 offset:10048
    buffer_load_dwordx4 v244, s[16:19], s47 offen sc1 lds
    v_mfma_f32_16x16x32_bf16 v[8:11], v[120:123], v[108:111], v[8:11]
    ds_read_b128 v[132:135], v221 offset:1024
    s_waitcnt lgkmcnt(5)
    v_mfma_f32_16x16x32_bf16 v[12:15], v[120:123], v[112:115], v[12:15]
    s_add_u32 m0, s79, 58368
    v_mfma_f32_16x16x32_bf16 v[16:19], v[120:123], v[116:119], v[16:19]
    ds_read_b128 v[136:139], v221 offset:3072
    v_mfma_f32_16x16x32_bf16 v[20:23], v[124:127], v[100:103], v[20:23]
    ds_read_b128 v[140:143], v221 offset:5120
    s_add_u32 s47, s47, s48
    v_mfma_f32_16x16x32_bf16 v[24:27], v[124:127], v[104:107], v[24:27]
    ds_read_b128 v[144:147], v221 offset:7168
    v_mfma_f32_16x16x32_bf16 v[28:31], v[124:127], v[108:111], v[28:31]
    ds_read_b128 v[148:151], v221 offset:9216
    v_mfma_f32_16x16x32_bf16 v[32:35], v[124:127], v[112:115], v[32:35]
    ds_read_b64_tr_b16 v[156:157], v222 offset:9504
    v_mfma_f32_16x16x32_bf16 v[36:39], v[124:127], v[116:119], v[36:39]
    buffer_load_dwordx4 v245, s[12:15], s77 offen lds
    s_add_u32 m0, s80, 58368
    s_waitcnt lgkmcnt(8)
    v_mfma_f32_16x16x32_bf16 v[40:43], v[128:131], v[100:103], v[40:43]
    ds_read_b64_tr_b16 v[158:159], v222 offset:10080
    v_mfma_f32_16x16x32_bf16 v[44:47], v[128:131], v[104:107], v[44:47]
    ds_read_b64_tr_b16 v[160:161], v222 offset:9536
    v_mfma_f32_16x16x32_bf16 v[48:51], v[128:131], v[108:111], v[48:51]
    ds_read_b64_tr_b16 v[162:163], v222 offset:10112
    v_mfma_f32_16x16x32_bf16 v[52:55], v[128:131], v[112:115], v[52:55]
    s_nop 0
    buffer_load_dwordx4 v246, s[12:15], s77 offen lds
    v_mfma_f32_16x16x32_bf16 v[56:59], v[128:131], v[116:119], v[56:59]
    s_add_u32 s77, s77, 73728
    s_waitcnt lgkmcnt(0)
    s_waitcnt vmcnt(10)
    s_barrier
    v_readfirstlane_b32 s40, v226
    s_add_u32 s42, s42, 1
    s_add_u32 s44, s42, s85
    s_and_b32 s44, s44, 3
    s_lshl_b32 s44, s44, 3
    s_bitcmp1_b32 s40, s44
    s_cbranch_scc0 op53_late
op53_rdy:
    v_mfma_f32_16x16x32_bf16 v[0:3], v[152:155], v[132:135], v[0:3]
    ds_read_b64_tr_b16 v[120:121], v222 offset:19456
    s_add_u32 s44, s85, s42
    v_mfma_f32_16x16x32_bf16 v[4:7], v[152:155], v[136:139], v[4:7]
    ds_read_b64_tr_b16 v[122:123], v222 offset:20032
    v_mfma_f32_16x16x32_bf16 v[8:11], v[152:155], v[140:143], v[8:11]
    ds_read_b128 v[100:103], v221 offset:19456
    s_cmp_eq_u32 s44, 4
    v_mfma_f32_16x16x32_bf16 v[12:15], v[152:155], v[144:147], v[12:15]
    s_cselect_b32 s44, 16, 0
    s_cmp_eq_u32 s42, 4
    v_mfma_f32_16x16x32_bf16 v[16:19], v[152:155], v[148:151], v[16:19]
    ds_read_b128 v[104:107], v221 offset:21504
    v_mfma_f32_16x16x32_bf16 v[20:23], v[156:159], v[132:135], v[20:23]
    ds_read_b128 v[108:111], v221 offset:23552
    s_cselect_b32 s44, 0xffff0000, s44
    v_mfma_f32_16x16x32_bf16 v[24:27], v[156:159], v[136:139], v[24:27]
    ds_read_b128 v[112:115], v221 offset:25600
    v_mfma_f32_16x16x32_bf16 v[28:31], v[156:159], v[140:143], v[28:31]
    ds_read_b128 v[116:119], v221 offset:27648
    s_mul_i32 s45, s44, 18432
    v_mfma_f32_16x16x32_bf16 v[32:35], v[156:159], v[144:147], v[32:35]
    ds_read_b64_tr_b16 v[124:125], v222 offset:19488
    s_sub_u32 s46, s46, s45
    v_mfma_f32_16x16x32_bf16 v[36:39], v[156:159], v[148:151], v[36:39]
    s_mul_i32 s45, s44, 73728
    v_mfma_f32_16x16x32_bf16 v[40:43], v[160:163], v[132:135], v[40:43]
    ds_read_b64_tr_b16 v[126:127], v222 offset:20064
    s_sub_u32 s77, s77, s45
    v_mfma_f32_16x16x32_bf16 v[44:47], v[160:163], v[136:139], v[44:47]
    ds_read_b64_tr_b16 v[128:129], v222 offset:19520
    s_mul_i32 s45, s44, s48
    v_mfma_f32_16x16x32_bf16 v[48:51], v[160:163], v[140:143], v[48:51]
    ds_read_b64_tr_b16 v[130:131], v222 offset:20096
    v_mfma_f32_16x16x32_bf16 v[52:55], v[160:163], v[144:147], v[52:55]
    s_sub_u32 s47, s47, s45
    s_add_u32 m0, s43, 0
    v_mfma_f32_16x16x32_bf16 v[56:59], v[160:163], v[148:151], v[56:59]
    s_add_u32 s45, s46, 8192
    s_waitcnt lgkmcnt(6)
    v_mfma_f32_16x16x32_bf16 v[0:3], v[120:123], v[100:103], v[0:3]
    ds_read_b64_tr_b16 v[152:153], v222 offset:28928
    buffer_load_dwordx4 v254, s[20:23], s46 offen sc1 lds
    v_mfma_f32_16x16x32_bf16 v[4:7], v[120:123], v[104:107], v[4:7]
    ds_read_b64_tr_b16 v[154:155], v222 offset:29504
    s_add_u32 m0, m0, 8192
    v_mfma_f32_16x16x32_bf16 v[8:11], v[120:123], v[108:111], v[8:11]
    ds_read_b128 v[132:135], v221 offset:20480
    s_waitcnt lgkmcnt(5)
    v_mfma_f32_16x16x32_bf16 v[12:15], v[120:123], v[112:115], v[12:15]
    s_add_u32 s46, s46, 18432
    buffer_load_dwordx4 v254, s[20:23], s45 offen sc1 lds
    v_mfma_f32_16x16x32_bf16 v[16:19], v[120:123], v[116:119], v[16:19]
    ds_read_b128 v[136:139], v221 offset:22528
    s_add_u32 m0, s78, 0
    v_mfma_f32_16x16x32_bf16 v[20:23], v[124:127], v[100:103], v[20:23]
    ds_read_b128 v[140:143], v221 offset:24576
    v_mfma_f32_16x16x32_bf16 v[24:27], v[124:127], v[104:107], v[24:27]
    ds_read_b128 v[144:147], v221 offset:26624
    s_nop 0
    v_mfma_f32_16x16x32_bf16 v[28:31], v[124:127], v[108:111], v[28:31]
    ds_read_b128 v[148:151], v221 offset:28672
    buffer_load_dwordx4 v244, s[16:19], s47 offen sc1 lds
    v_mfma_f32_16x16x32_bf16 v[32:35], v[124:127], v[112:115], v[32:35]
    ds_read_b64_tr_b16 v[156:157], v222 offset:28960
    v_mfma_f32_16x16x32_bf16 v[36:39], v[124:127], v[116:119], v[36:39]
    s_add_u32 m0, s79, 0
    s_add_u32 s47, s47, s48
    s_waitcnt lgkmcnt(8)
    v_mfma_f32_16x16x32_bf16 v[40:43], v[128:131], v[100:103], v[40:43]
    ds_read_b64_tr_b16 v[158:159], v222 offset:29536
    v_mfma_f32_16x16x32_bf16 v[44:47], v[128:131], v[104:107], v[44:47]
    ds_read_b64_tr_b16 v[160:161], v222 offset:28992
    buffer_load_dwordx4 v245, s[12:15], s77 offen lds
    v_mfma_f32_16x16x32_bf16 v[48:51], v[128:131], v[108:111], v[48:51]
    ds_read_b64_tr_b16 v[162:163], v222 offset:29568
    s_add_u32 m0, s80, 0
    v_mfma_f32_16x16x32_bf16 v[52:55], v[128:131], v[112:115], v[52:55]
    s_nop 0
    v_mfma_f32_16x16x32_bf16 v[56:59], v[128:131], v[116:119], v[56:59]
    buffer_load_dwordx4 v246, s[12:15], s77 offen lds
    s_add_u32 s77, s77, 73728
    s_waitcnt lgkmcnt(0)
    s_waitcnt vmcnt(10)
    s_barrier
    v_mfma_f32_16x16x32_bf16 v[0:3], v[152:155], v[132:135], v[0:3]
    ds_read_b64_tr_b16 v[120:121], v224 offset:0
    v_mfma_f32_16x16x32_bf16 v[4:7], v[152:155], v[136:139], v[4:7]
    ds_read_b64_tr_b16 v[122:123], v224 offset:576
    s_add_u32 m0, s43, 19456
    v_mfma_f32_16x16x32_bf16 v[8:11], v[152:155], v[140:143], v[8:11]
    ds_read_b128 v[100:103], v223 offset:0
    v_mfma_f32_16x16x32_bf16 v[12:15], v[152:155], v[144:147], v[12:15]
    s_add_u32 s45, s46, 8192
    v_mfma_f32_16x16x32_bf16 v[16:19], v[152:155], v[148:151], v[16:19]
    ds_read_b128 v[104:107], v223 offset:2048
    v_mfma_f32_16x16x32_bf16 v[20:23], v[156:159], v[132:135], v[20:23]
    ds_read_b128 v[108:111], v223 offset:4096
    buffer_load_dwordx4 v254, s[20:23], s46 offen sc1 lds
    v_mfma_f32_16x16x32_bf16 v[24:27], v[156:159], v[136:139], v[24:27]
    ds_read_b128 v[112:115], v223 offset:6144
    v_mfma_f32_16x16x32_bf16 v[28:31], v[156:159], v[140:143], v[28:31]
    ds_read_b128 v[116:119], v223 offset:8192
    v_mfma_f32_16x16x32_bf16 v[32:35], v[156:159], v[144:147], v[32:35]
    ds_read_b64_tr_b16 v[124:125], v224 offset:32
    v_mfma_f32_16x16x32_bf16 v[36:39], v[156:159], v[148:151], v[36:39]
    s_add_u32 m0, m0, 8192
    s_add_u32 s46, s46, 18432
    v_mfma_f32_16x16x32_bf16 v[40:43], v[160:163], v[132:135], v[40:43]
    ds_read_b64_tr_b16 v[126:127], v224 offset:608
    v_mfma_f32_16x16x32_bf16 v[44:47], v[160:163], v[136:139], v[44:47]
    ds_read_b64_tr_b16 v[128:129], v224 offset:64
    v_mfma_f32_16x16x32_bf16 v[48:51], v[160:163], v[140:143], v[48:51]
    ds_read_b64_tr_b16 v[130:131], v224 offset:640
    v_mfma_f32_16x16x32_bf16 v[52:55], v[160:163], v[144:147], v[52:55]
    buffer_load_dwordx4 v254, s[20:23], s45 offen sc1 lds
    s_add_u32 m0, s78, 19456
    v_mfma_f32_16x16x32_bf16 v[56:59], v[160:163], v[148:151], v[56:59]
    s_nop 0
    s_waitcnt lgkmcnt(6)
    v_mfma_f32_16x16x32_bf16 v[0:3], v[120:123], v[100:103], v[0:3]
    ds_read_b64_tr_b16 v[152:153], v224 offset:9472
    v_mfma_f32_16x16x32_bf16 v[4:7], v[120:123], v[104:107], v[4:7]
    ds_read_b64_tr_b16 v[154:155], v224 offset:10048
    buffer_load_dwordx4 v244, s[16:19], s47 offen sc1 lds
    v_mfma_f32_16x16x32_bf16 v[8:11], v[120:123], v[108:111], v[8:11]
    ds_read_b128 v[132:135], v223 offset:1024
    s_waitcnt lgkmcnt(5)
    v_mfma_f32_16x16x32_bf16 v[12:15], v[120:123], v[112:115], v[12:15]
    s_add_u32 m0, s79, 19456
    v_mfma_f32_16x16x32_bf16 v[16:19], v[120:123], v[116:119], v[16:19]
    ds_read_b128 v[136:139], v223 offset:3072
    v_mfma_f32_16x16x32_bf16 v[20:23], v[124:127], v[100:103], v[20:23]
    ds_read_b128 v[140:143], v223 offset:5120
    s_add_u32 s47, s47, s48
    v_mfma_f32_16x16x32_bf16 v[24:27], v[124:127], v[104:107], v[24:27]
    ds_read_b128 v[144:147], v223 offset:7168
    v_mfma_f32_16x16x32_bf16 v[28:31], v[124:127], v[108:111], v[28:31]
    ds_read_b128 v[148:151], v223 offset:9216
    v_mfma_f32_16x16x32_bf16 v[32:35], v[124:127], v[112:115], v[32:35]
    ds_read_b64_tr_b16 v[156:157], v224 offset:9504
    v_mfma_f32_16x16x32_bf16 v[36:39], v[124:127], v[116:119], v[36:39]
    buffer_load_dwordx4 v245, s[12:15], s77 offen lds
    s_add_u32 m0, s80, 19456
    s_waitcnt lgkmcnt(8)
    v_mfma_f32_16x16x32_bf16 v[40:43], v[128:131], v[100:103], v[40:43]
    ds_read_b64_tr_b16 v[158:159], v224 offset:10080
    v_mfma_f32_16x16x32_bf16 v[44:47], v[128:131], v[104:107], v[44:47]
    ds_read_b64_tr_b16 v[160:161], v224 offset:9536
    v_mfma_f32_16x16x32_bf16 v[48:51], v[128:131], v[108:111], v[48:51]
    ds_read_b64_tr_b16 v[162:163], v224 offset:10112
    v_mfma_f32_16x16x32_bf16 v[52:55], v[128:131], v[112:115], v[52:55]
    s_nop 0
    buffer_load_dwordx4 v246, s[12:15], s77 offen lds
    v_mfma_f32_16x16x32_bf16 v[56:59], v[128:131], v[116:119], v[56:59]
    s_add_u32 s77, s77, 73728
    s_waitcnt lgkmcnt(0)
    s_waitcnt vmcnt(10)
    s_barrier
    v_mfma_f32_16x16x32_bf16 v[0:3], v[152:155], v[132:135], v[0:3]
    ds_read_b64_tr_b16 v[120:121], v224 offset:19456
    v_mfma_f32_16x16x32_bf16 v[4:7], v[152:155], v[136:139], v[4:7]
    ds_read_b64_tr_b16 v[122:123], v224 offset:20032
    buffer_load_dword v226, off, s[20:23], s98 sc1
    v_mfma_f32_16x16x32_bf16 v[8:11], v[152:155], v[140:143], v[8:11]
    ds_read_b128 v[100:103], v223 offset:19456
    v_mfma_f32_16x16x32_bf16 v[12:15], v[152:155], v[144:147], v[12:15]
    s_add_u32 m0, s43, 38912
    v_mfma_f32_16x16x32_bf16 v[16:19], v[152:155], v[148:151], v[16:19]
    ds_read_b128 v[104:107], v223 offset:21504
    s_add_u32 s45, s46, 8192
    v_mfma_f32_16x16x32_bf16 v[20:23], v[156:159], v[132:135], v[20:23]
    ds_read_b128 v[108:111], v223 offset:23552
    v_mfma_f32_16x16x32_bf16 v[24:27], v[156:159], v[136:139], v[24:27]
    ds_read_b128 v[112:115], v223 offset:25600
    v_mfma_f32_16x16x32_bf16 v[28:31], v[156:159], v[140:143], v[28:31]
    ds_read_b128 v[116:119], v223 offset:27648
    buffer_load_dwordx4 v254, s[20:23], s46 offen sc1 lds
    v_mfma_f32_16x16x32_bf16 v[32:35], v[156:159], v[144:147], v[32:35]
    ds_read_b64_tr_b16 v[124:125], v224 offset:19488
    v_mfma_f32_16x16x32_bf16 v[36:39], v[156:159], v[148:151], v[36:39]
    s_add_u32 m0, m0, 8192
    v_mfma_f32_16x16x32_bf16 v[40:43], v[160:163], v[132:135], v[40:43]
    ds_read_b64_tr_b16 v[126:127], v224 offset:20064
    s_add_u32 s46, s46, 18432
    v_mfma_f32_16x16x32_bf16 v[44:47], v[160:163], v[136:139], v[44:47]
    ds_read_b64_tr_b16 v[128:129], v224 offset:19520
    v_mfma_f32_16x16x32_bf16 v[48:51], v[160:163], v[140:143], v[48:51]
    ds_read_b64_tr_b16 v[130:131], v224 offset:20096
    v_mfma_f32_16x16x32_bf16 v[52:55], v[160:163], v[144:147], v[52:55]
    buffer_load_dwordx4 v254, s[20:23], s45 offen sc1 lds
    s_add_u32 m0, s78, 38912
    v_mfma_f32_16x16x32_bf16 v[56:59], v[160:163], v[148:151], v[56:59]
    s_nop 0
    s_waitcnt lgkmcnt(6)
    v_mfma_f32_16x16x32_bf16 v[0:3], v[120:123], v[100:103], v[0:3]
    ds_read_b64_tr_b16 v[152:153], v224 offset:28928
    v_mfma_f32_16x16x32_bf16 v[4:7], v[120:123], v[104:107], v[4:7]
    ds_read_b64_tr_b16 v[154:155], v224 offset:29504
    buffer_load_dwordx4 v244, s[16:19], s47 offen sc1 lds
    v_mfma_f32_16x16x32_bf16 v[8:11], v[120:123], v[108:111], v[8:11]
    ds_read_b128 v[132:135], v223 offset:20480
    s_waitcnt lgkmcnt(5)
    v_mfma_f32_16x16x32_bf16 v[12:15], v[120:123], v[112:115], v[12:15]
    s_add_u32 m0, s79, 38912
    v_mfma_f32_16x16x32_bf16 v[16:19], v[120:123], v[116:119], v[16:19]
    ds_read_b128 v[136:139], v223 offset:22528
    s_add_u32 s47, s47, s48
    v_mfma_f32_16x16x32_bf16 v[20:23], v[124:127], v[100:103], v[20:23]
    ds_read_b128 v[140:143], v223 offset:24576
    v_mfma_f32_16x16x32_bf16 v[24:27], v[124:127], v[104:107], v[24:27]
    ds_read_b128 v[144:147], v223 offset:26624
    v_mfma_f32_16x16x32_bf16 v[28:31], v[124:127], v[108:111], v[28:31]
    ds_read_b128 v[148:151], v223 offset:28672
    buffer_load_dwordx4 v245, s[12:15], s77 offen lds
    v_mfma_f32_16x16x32_bf16 v[32:35], v[124:127], v[112:115], v[32:35]
    ds_read_b64_tr_b16 v[156:157], v224 offset:28960
    v_mfma_f32_16x16x32_bf16 v[36:39], v[124:127], v[116:119], v[36:39]
    s_add_u32 m0, s80, 38912
    s_waitcnt lgkmcnt(8)
    v_mfma_f32_16x16x32_bf16 v[40:43], v[128:131], v[100:103], v[40:43]
    ds_read_b64_tr_b16 v[158:159], v224 offset:29536
    s_nop 0
    v_mfma_f32_16x16x32_bf16 v[44:47], v[128:131], v[104:107], v[44:47]
    ds_read_b64_tr_b16 v[160:161], v224 offset:28992
    v_mfma_f32_16x16x32_bf16 v[48:51], v[128:131], v[108:111], v[48:51]
    ds_read_b64_tr_b16 v[162:163], v224 offset:29568
    v_mfma_f32_16x16x32_bf16 v[52:55], v[128:131], v[112:115], v[52:55]
    buffer_load_dwordx4 v246, s[12:15], s77 offen lds
    s_add_u32 s77, s77, 73728
    v_mfma_f32_16x16x32_bf16 v[56:59], v[128:131], v[116:119], v[56:59]
    s_cmp_lt_u32 s42, 4
    s_waitcnt lgkmcnt(0)
    s_cbranch_scc1 op53_loop
    s_branch op53_done
op53_late:
op53_p1:
    buffer_load_dword v226, off, s[20:23], s98 sc1
    s_waitcnt vmcnt(0)
    v_readfirstlane_b32 s40, v226
    s_add_u32 s44, s42, s85
    s_and_b32 s44, s44, 3
    s_lshl_b32 s44, s44, 3
    s_bitcmp1_b32 s40, s44
    s_cbranch_scc1 op53_p1_ok
    s_sleep 4
    s_branch op53_p1
op53_p1_ok:
    s_branch op53_rdy
op53_done:
    v_mfma_f32_16x16x32_bf16 v[0:3], v[152:155], v[132:135], v[0:3]
    v_mfma_f32_16x16x32_bf16 v[4:7], v[152:155], v[136:139], v[4:7]
    v_mfma_f32_16x16x32_bf16 v[8:11], v[152:155], v[140:143], v[8:11]
    v_mfma_f32_16x16x32_bf16 v[12:15], v[152:155], v[144:147], v[12:15]
    v_mfma_f32_16x16x32_bf16 v[16:19], v[152:155], v[148:151], v[16:19]
    v_mfma_f32_16x16x32_bf16 v[20:23], v[156:159], v[132:135], v[20:23]
    v_mfma_f32_16x16x32_bf16 v[24:27], v[156:159], v[136:139], v[24:27]
    v_mfma_f32_16x16x32_bf16 v[28:31], v[156:159], v[140:143], v[28:31]
    v_mfma_f32_16x16x32_bf16 v[32:35], v[156:159], v[144:147], v[32:35]
    v_mfma_f32_16x16x32_bf16 v[36:39], v[156:159], v[148:151], v[36:39]
    v_mfma_f32_16x16x32_bf16 v[40:43], v[160:163], v[132:135], v[40:43]
    v_mfma_f32_16x16x32_bf16 v[44:47], v[160:163], v[136:139], v[44:47]
    v_mfma_f32_16x16x32_bf16 v[48:51], v[160:163], v[140:143], v[48:51]
    v_mfma_f32_16x16x32_bf16 v[52:55], v[160:163], v[144:147], v[52:55]
    v_mfma_f32_16x16x32_bf16 v[56:59], v[160:163], v[148:151], v[56:59]
    s_cmp_eq_u32 s84, 0
    s_cbranch_scc1 op53_k0
    s_cmp_eq_u32 s84, 1
    s_cbranch_scc1 op53_k1
    s_cmp_eq_u32 s84, 2
    s_cbranch_scc1 op53_k2
op53_k3:
    s_nop 7
    s_add_u32 s44, s52, 98304
    v_cvt_pk_bf16_f32 v0, v0, v1
    v_cvt_pk_bf16_f32 v1, v2, v3
    v_cvt_pk_bf16_f32 v2, v16, v17
    v_cvt_pk_bf16_f32 v3, v18, v19
    buffer_store_dwordx4 v[0:3], v254, s[20:23], s44 offen offset:0 sc1
    v_cvt_pk_bf16_f32 v32, v32, v33
    v_cvt_pk_bf16_f32 v33, v34, v35
    v_cvt_pk_bf16_f32 v34, v48, v49
    v_cvt_pk_bf16_f32 v35, v50, v51
    buffer_store_dwordx4 v[32:35], v254, s[20:23], s44 offen offset:1024 sc1
    s_add_u32 s44, s52, 229376
    v_cvt_pk_bf16_f32 v4, v4, v5
    v_cvt_pk_bf16_f32 v5, v6, v7
    v_cvt_pk_bf16_f32 v6, v20, v21
    v_cvt_pk_bf16_f32 v7, v22, v23
    buffer_store_dwordx4 v[4:7], v254, s[20:23], s44 offen offset:0 sc1
    v_cvt_pk_bf16_f32 v36, v36, v37
    v_cvt_pk_bf16_f32 v37, v38, v39
    v_cvt_pk_bf16_f32 v38, v52, v53
    v_cvt_pk_bf16_f32 v39, v54, v55
    buffer_store_dwordx4 v[36:39], v254, s[20:23], s44 offen offset:1024 sc1
    s_add_u32 s44, s52, 360448
    v_cvt_pk_bf16_f32 v8, v8, v9
    v_cvt_pk_bf16_f32 v9, v10, v11
    v_cvt_pk_bf16_f32 v10, v24, v25
    v_cvt_pk_bf16_f32 v11, v26, v27
    buffer_store_dwordx4 v[8:11], v254, s[20:23], s44 offen offset:0 sc1
    v_cvt_pk_bf16_f32 v40, v40, v41
    v_cvt_pk_bf16_f32 v41, v42, v43
    v_cvt_pk_bf16_f32 v42, v56, v57
    v_cvt_pk_bf16_f32 v43, v58, v59
    buffer_store_dwordx4 v[40:43], v254, s[20:23], s44 offen offset:1024 sc1
    s_waitcnt vmcnt(0)
    s_barrier
    s_cmp_lg_u32 s30, 0
    s_cbranch_scc1 op53_nr3
    v_lshlrev_b32 v226, 8, v250
    v_mov_b32 v251, 1
    s_add_u32 s44, s54, -765
    s_mov_b64 exec, 15
    buffer_store_byte v251, v226, s[20:23], s44 offen sc1
    s_mov_b64 exec, -1
op53_nr3:
op53_q3:
    buffer_load_dword v226, off, s[20:23], s54 sc1
    s_waitcnt vmcnt(0)
    v_readfirstlane_b32 s40, v226
    s_nop 0
    s_cmp_eq_u32 s40, 0x01010101
    s_cbranch_scc1 op53_q3_ok
    s_sleep 4
    s_branch op53_q3
op53_q3_ok:
    s_add_u32 s94, s52, 393216
    s_add_u32 s95, s52, 425984
    s_add_u32 s96, s52, 458752
    buffer_load_dwordx4 v[100:103], v254, s[20:23], s94 offen offset:0 sc1
    buffer_load_dwordx4 v[104:107], v254, s[20:23], s95 offen offset:0 sc1
    buffer_load_dwordx4 v[108:111], v254, s[20:23], s96 offen offset:0 sc1
    buffer_load_dwordx4 v[112:115], v254, s[20:23], s94 offen offset:1024 sc1
    buffer_load_dwordx4 v[116:119], v254, s[20:23], s95 offen offset:1024 sc1
    buffer_load_dwordx4 v[120:123], v254, s[20:23], s96 offen offset:1024 sc1
    s_mov_b32 s99, 0xffff0000
    s_add_u32 s44, s53, 55296
    s_waitcnt vmcnt(3)
    v_lshlrev_b32 v251, 16, v100
    v_and_b32 v100, s99, v100
    v_lshlrev_b32 v252, 16, v101
    v_and_b32 v101, s99, v101
    v_add_f32 v12, v12, v251
    v_add_f32 v13, v13, v100
    v_add_f32 v14, v14, v252
    v_add_f32 v15, v15, v101
    v_lshlrev_b32 v251, 16, v104
    v_and_b32 v104, s99, v104
    v_lshlrev_b32 v252, 16, v105
    v_and_b32 v105, s99, v105
    v_add_f32 v12, v12, v251
    v_add_f32 v13, v13, v104
    v_add_f32 v14, v14, v252
    v_add_f32 v15, v15, v105
    v_lshlrev_b32 v251, 16, v108
    v_and_b32 v108, s99, v108
    v_lshlrev_b32 v252, 16, v109
    v_and_b32 v109, s99, v109
    v_add_f32 v12, v12, v251
    v_add_f32 v13, v13, v108
    v_add_f32 v14, v14, v252
    v_add_f32 v15, v15, v109
    v_cvt_pk_bf16_f32 v12, v12, v13
    v_cvt_pk_bf16_f32 v13, v14, v15
    buffer_store_dwordx2 v[12:13], v225, s[8:11], s44 offen
    s_add_u32 s44, s53, 36896
    v_lshlrev_b32 v251, 16, v102
    v_and_b32 v102, s99, v102
    v_lshlrev_b32 v252, 16, v103
    v_and_b32 v103, s99, v103
    v_add_f32 v28, v28, v251
    v_add_f32 v29, v29, v102
    v_add_f32 v30, v30, v252
    v_add_f32 v31, v31, v103
    v_lshlrev_b32 v251, 16, v106
    v_and_b32 v106, s99, v106
    v_lshlrev_b32 v252, 16, v107
    v_and_b32 v107, s99, v107
    v_add_f32 v28, v28, v251
    v_add_f32 v29, v29, v106
    v_add_f32 v30, v30, v252
    v_add_f32 v31, v31, v107
    v_lshlrev_b32 v251, 16, v110
    v_and_b32 v110, s99, v110
    v_lshlrev_b32 v252, 16, v111
    v_and_b32 v111, s99, v111
    v_add_f32 v28, v28, v251
    v_add_f32 v29, v29, v110
    v_add_f32 v30, v30, v252
    v_add_f32 v31, v31, v111
    v_cvt_pk_bf16_f32 v28, v28, v29
    v_cvt_pk_bf16_f32 v29, v30, v31
    buffer_store_dwordx2 v[28:29], v225, s[8:11], s44 offen
    s_add_u32 s44, s53, 18496
    s_waitcnt vmcnt(2)
    v_lshlrev_b32 v251, 16, v112
    v_and_b32 v112, s99, v112
    v_lshlrev_b32 v252, 16, v113
    v_and_b32 v113, s99, v113
    v_add_f32 v44, v44, v251
    v_add_f32 v45, v45, v112
    v_add_f32 v46, v46, v252
    v_add_f32 v47, v47, v113
    v_lshlrev_b32 v251, 16, v116
    v_and_b32 v116, s99, v116
    v_lshlrev_b32 v252, 16, v117
    v_and_b32 v117, s99, v117
    v_add_f32 v44, v44, v251
    v_add_f32 v45, v45, v116
    v_add_f32 v46, v46, v252
    v_add_f32 v47, v47, v117
    v_lshlrev_b32 v251, 16, v120
    v_and_b32 v120, s99, v120
    v_lshlrev_b32 v252, 16, v121
    v_and_b32 v121, s99, v121
    v_add_f32 v44, v44, v251
    v_add_f32 v45, v45, v120
    v_add_f32 v46, v46, v252
    v_add_f32 v47, v47, v121
    v_cvt_pk_bf16_f32 v44, v44, v45
    v_cvt_pk_bf16_f32 v45, v46, v47
    buffer_store_dwordx2 v[44:45], v225, s[8:11], s44 offen
    s_branch attn_fin
op53_k0:
    s_nop 7
    s_add_u32 s44, s52, 131072
    v_cvt_pk_bf16_f32 v4, v4, v5
    v_cvt_pk_bf16_f32 v5, v6, v7
    v_cvt_pk_bf16_f32 v6, v20, v21
    v_cvt_pk_bf16_f32 v7, v22, v23
    buffer_store_dwordx4 v[4:7], v254, s[20:23], s44 offen offset:0 sc1
    v_cvt_pk_bf16_f32 v36, v36, v37
    v_cvt_pk_bf16_f32 v37, v38, v39
    v_cvt_pk_bf16_f32 v38, v52, v53
    v_cvt_pk_bf16_f32 v39, v54, v55
    buffer_store_dwordx4 v[36:39], v254, s[20:23], s44 offen offset:1024 sc1
    s_add_u32 s44, s52, 262144
    v_cvt_pk_bf16_f32 v8, v8, v9
    v_cvt_pk_bf16_f32 v9, v10, v11
    v_cvt_pk_bf16_f32 v10, v24, v25
    v_cvt_pk_bf16_f32 v11, v26, v27
    buffer_store_dwordx4 v[8:11], v254, s[20:23], s44 offen offset:0 sc1
    v_cvt_pk_bf16_f32 v40, v40, v41
    v_cvt_pk_bf16_f32 v41, v42, v43
    v_cvt_pk_bf16_f32 v42, v56, v57
    v_cvt_pk_bf16_f32 v43, v58, v59
    buffer_store_dwordx4 v[40:43], v254, s[20:23], s44 offen offset:1024 sc1
    s_add_u32 s44, s52, 393216
    v_cvt_pk_bf16_f32 v12, v12, v13
    v_cvt_pk_bf16_f32 v13, v14, v15
    v_cvt_pk_bf16_f32 v14, v28, v29
    v_cvt_pk_bf16_f32 v15, v30, v31
    buffer_store_dwordx4 v[12:15], v254, s[20:23], s44 offen offset:0 sc1
    v_cvt_pk_bf16_f32 v44, v44, v45
    v_cvt_pk_bf16_f32 v45, v46, v47
    buffer_store_dwordx4 v[44:47], v254, s[20:23], s44 offen offset:1024 sc1
    s_waitcnt vmcnt(0)
    s_barrier
    s_cmp_lg_u32 s30, 0
    s_cbranch_scc1 op53_nr0
    v_lshlrev_b32 v226, 8, v250
    v_mov_b32 v251, 1
    s_add_u32 s44, s54, 0
    s_mov_b64 exec, 15
    buffer_store_byte v251, v226, s[20:23], s44 offen sc1
    s_mov_b64 exec, -1
op53_nr0:
op53_q0:
    buffer_load_dword v226, off, s[20:23], s54 sc1
    s_waitcnt vmcnt(0)
    v_readfirstlane_b32 s40, v226
    s_nop 0
    s_cmp_eq_u32 s40, 0x01010101
    s_cbranch_scc1 op53_q0_ok
    s_sleep 4
    s_branch op53_q0
op53_q0_ok:
    s_add_u32 s94, s52, 32768
    s_add_u32 s95, s52, 65536
    s_add_u32 s96, s52, 98304
    buffer_load_dwordx4 v[100:103], v254, s[20:23], s94 offen offset:0 sc1
    buffer_load_dwordx4 v[104:107], v254, s[20:23], s95 offen offset:0 sc1
    buffer_load_dwordx4 v[108:111], v254, s[20:23], s96 offen offset:0 sc1
    buffer_load_dwordx4 v[112:115], v254, s[20:23], s94 offen offset:1024 sc1
    buffer_load_dwordx4 v[116:119], v254, s[20:23], s95 offen offset:1024 sc1
    buffer_load_dwordx4 v[120:123], v254, s[20:23], s96 offen offset:1024 sc1
    s_mov_b32 s99, 0xffff0000
    s_add_u32 s44, s53, 0
    s_waitcnt vmcnt(3)
    v_lshlrev_b32 v251, 16, v100
    v_and_b32 v100, s99, v100
    v_lshlrev_b32 v252, 16, v101
    v_and_b32 v101, s99, v101
    v_add_f32 v0, v0, v251
    v_add_f32 v1, v1, v100
    v_add_f32 v2, v2, v252
    v_add_f32 v3, v3, v101
    v_lshlrev_b32 v251, 16, v104
    v_and_b32 v104, s99, v104
    v_lshlrev_b32 v252, 16, v105
    v_and_b32 v105, s99, v105
    v_add_f32 v0, v0, v251
    v_add_f32 v1, v1, v104
    v_add_f32 v2, v2, v252
    v_add_f32 v3, v3, v105
    v_lshlrev_b32 v251, 16, v108
    v_and_b32 v108, s99, v108
    v_lshlrev_b32 v252, 16, v109
    v_and_b32 v109, s99, v109
    v_add_f32 v0, v0, v251
    v_add_f32 v1, v1, v108
    v_add_f32 v2, v2, v252
    v_add_f32 v3, v3, v109
    v_cvt_pk_bf16_f32 v0, v0, v1
    v_cvt_pk_bf16_f32 v1, v2, v3
    buffer_store_dwordx2 v[0:1], v225, s[8:11], s44 offen
    s_add_u32 s44, s53, 73728
    v_lshlrev_b32 v251, 16, v102
    v_and_b32 v102, s99, v102
    v_lshlrev_b32 v252, 16, v103
    v_and_b32 v103, s99, v103
    v_add_f32 v16, v16, v251
    v_add_f32 v17, v17, v102
    v_add_f32 v18, v18, v252
    v_add_f32 v19, v19, v103
    v_lshlrev_b32 v251, 16, v106
    v_and_b32 v106, s99, v106
    v_lshlrev_b32 v252, 16, v107
    v_and_b32 v107, s99, v107
    v_add_f32 v16, v16, v251
    v_add_f32 v17, v17, v106
    v_add_f32 v18, v18, v252
    v_add_f32 v19, v19, v107
    v_lshlrev_b32 v251, 16, v110
    v_and_b32 v110, s99, v110
    v_lshlrev_b32 v252, 16, v111
    v_and_b32 v111, s99, v111
    v_add_f32 v16, v16, v251
    v_add_f32 v17, v17, v110
    v_add_f32 v18, v18, v252
    v_add_f32 v19, v19, v111
    v_cvt_pk_bf16_f32 v16, v16, v17
    v_cvt_pk_bf16_f32 v17, v18, v19
    buffer_store_dwordx2 v[16:17], v225, s[8:11], s44 offen
    s_add_u32 s44, s53, 55328
    s_waitcnt vmcnt(2)
    v_lshlrev_b32 v251, 16, v112
    v_and_b32 v112, s99, v112
    v_lshlrev_b32 v252, 16, v113
    v_and_b32 v113, s99, v113
    v_add_f32 v32, v32, v251
    v_add_f32 v33, v33, v112
    v_add_f32 v34, v34, v252
    v_add_f32 v35, v35, v113
    v_lshlrev_b32 v251, 16, v116
    v_and_b32 v116, s99, v116
    v_lshlrev_b32 v252, 16, v117
    v_and_b32 v117, s99, v117
    v_add_f32 v32, v32, v251
    v_add_f32 v33, v33, v116
    v_add_f32 v34, v34, v252
    v_add_f32 v35, v35, v117
    v_lshlrev_b32 v251, 16, v120
    v_and_b32 v120, s99, v120
    v_lshlrev_b32 v252, 16, v121
    v_and_b32 v121, s99, v121
    v_add_f32 v32, v32, v251
    v_add_f32 v33, v33, v120
    v_add_f32 v34, v34, v252
    v_add_f32 v35, v35, v121
    v_cvt_pk_bf16_f32 v32, v32, v33
    v_cvt_pk_bf16_f32 v33, v34, v35
    buffer_store_dwordx2 v[32:33], v225, s[8:11], s44 offen
    s_add_u32 s44, s53, 36928
    v_lshlrev_b32 v251, 16, v114
    v_and_b32 v114, s99, v114
    v_lshlrev_b32 v252, 16, v115
    v_and_b32 v115, s99, v115
    v_add_f32 v48, v48, v251
    v_add_f32 v49, v49, v114
    v_add_f32 v50, v50, v252
    v_add_f32 v51, v51, v115
    v_lshlrev_b32 v251, 16, v118
    v_and_b32 v118, s99, v118
    v_lshlrev_b32 v252, 16, v119
    v_and_b32 v119, s99, v119
    v_add_f32 v48, v48, v251
    v_add_f32 v49, v49, v118
    v_add_f32 v50, v50, v252
    v_add_f32 v51, v51, v119
    v_lshlrev_b32 v251, 16, v122
    v_and_b32 v122, s99, v122
    v_lshlrev_b32 v252, 16, v123
    v_and_b32 v123, s99, v123
    v_add_f32 v48, v48, v251
    v_add_f32 v49, v49, v122
    v_add_f32 v50, v50, v252
    v_add_f32 v51, v51, v123
    v_cvt_pk_bf16_f32 v48, v48, v49
    v_cvt_pk_bf16_f32 v49, v50, v51
    buffer_store_dwordx2 v[48:49], v225, s[8:11], s44 offen
    s_branch attn_fin
op53_k1:
    s_nop 7
    s_add_u32 s44, s52, 32768
    v_cvt_pk_bf16_f32 v0, v0, v1
    v_cvt_pk_bf16_f32 v1, v2, v3
    v_cvt_pk_bf16_f32 v2, v16, v17
    v_cvt_pk_bf16_f32 v3, v18, v19
    buffer_store_dwordx4 v[0:3], v254, s[20:23], s44 offen offset:0 sc1
    v_cvt_pk_bf16_f32 v32, v32, v33
    v_cvt_pk_bf16_f32 v33, v34, v35
    v_cvt_pk_bf16_f32 v34, v48, v49
    v_cvt_pk_bf16_f32 v35, v50, v51
    buffer_store_dwordx4 v[32:35], v254, s[20:23], s44 offen offset:1024 sc1
    s_add_u32 s44, s52, 294912
    v_cvt_pk_bf16_f32 v8, v8, v9
    v_cvt_pk_bf16_f32 v9, v10, v11
    v_cvt_pk_bf16_f32 v10, v24, v25
    v_cvt_pk_bf16_f32 v11, v26, v27
    buffer_store_dwordx4 v[8:11], v254, s[20:23], s44 offen offset:0 sc1
    v_cvt_pk_bf16_f32 v40, v40, v41
    v_cvt_pk_bf16_f32 v41, v42, v43
    v_cvt_pk_bf16_f32 v42, v56, v57
    v_cvt_pk_bf16_f32 v43, v58, v59
    buffer_store_dwordx4 v[40:43], v254, s[20:23], s44 offen offset:1024 sc1
    s_add_u32 s44, s52, 425984
    v_cvt_pk_bf16_f32 v12, v12, v13
    v_cvt_pk_bf16_f32 v13, v14, v15
    v_cvt_pk_bf16_f32 v14, v28, v29
    v_cvt_pk_bf16_f32 v15, v30, v31
    buffer_store_dwordx4 v[12:15], v254, s[20:23], s44 offen offset:0 sc1
    v_cvt_pk_bf16_f32 v44, v44, v45
    v_cvt_pk_bf16_f32 v45, v46, v47
    buffer_store_dwordx4 v[44:47], v254, s[20:23], s44 offen offset:1024 sc1
    s_waitcnt vmcnt(0)
    s_barrier
    s_cmp_lg_u32 s30, 0
    s_cbranch_scc1 op53_nr1
    v_lshlrev_b32 v226, 8, v250
    v_mov_b32 v251, 1
    s_add_u32 s44, s54, -255
    s_mov_b64 exec, 15
    buffer_store_byte v251, v226, s[20:23], s44 offen sc1
    s_mov_b64 exec, -1
op53_nr1:
op53_q1:
    buffer_load_dword v226, off, s[20:23], s54 sc1
    s_waitcnt vmcnt(0)
    v_readfirstlane_b32 s40, v226
    s_nop 0
    s_cmp_eq_u32 s40, 0x01010101
    s_cbranch_scc1 op53_q1_ok
    s_sleep 4
    s_branch op53_q1
op53_q1_ok:
    s_add_u32 s94, s52, 131072
    s_add_u32 s95, s52, 196608
    s_add_u32 s96, s52, 229376
    buffer_load_dwordx4 v[100:103], v254, s[20:23], s94 offen offset:0 sc1
    buffer_load_dwordx4 v[104:107], v254, s[20:23], s95 offen offset:0 sc1
    buffer_load_dwordx4 v[108:111], v254, s[20:23], s96 offen offset:0 sc1
    buffer_load_dwordx4 v[112:115], v254, s[20:23], s94 offen offset:1024 sc1
    buffer_load_dwordx4 v[116:119], v254, s[20:23], s95 offen offset:1024 sc1
    buffer_load_dwordx4 v[120:123], v254, s[20:23], s96 offen offset:1024 sc1
    s_mov_b32 s99, 0xffff0000
    s_add_u32 s44, s53, 18432
    s_waitcnt vmcnt(3)
    v_lshlrev_b32 v251, 16, v100
    v_and_b32 v100, s99, v100
    v_lshlrev_b32 v252, 16, v101
    v_and_b32 v101, s99, v101
    v_add_f32 v4, v4, v251
    v_add_f32 v5, v5, v100
    v_add_f32 v6, v6, v252
    v_add_f32 v7, v7, v101
    v_lshlrev_b32 v251, 16, v104
    v_and_b32 v104, s99, v104
    v_lshlrev_b32 v252, 16, v105
    v_and_b32 v105, s99, v105
    v_add_f32 v4, v4, v251
    v_add_f32 v5, v5, v104
    v_add_f32 v6, v6, v252
    v_add_f32 v7, v7, v105
    v_lshlrev_b32 v251, 16, v108
    v_and_b32 v108, s99, v108
    v_lshlrev_b32 v252, 16, v109
    v_and_b32 v109, s99, v109
    v_add_f32 v4, v4, v251
    v_add_f32 v5, v5, v108
    v_add_f32 v6, v6, v252
    v_add_f32 v7, v7, v109
    v_cvt_pk_bf16_f32 v4, v4, v5
    v_cvt_pk_bf16_f32 v5, v6, v7
    buffer_store_dwordx2 v[4:5], v225, s[8:11], s44 offen
    s_add_u32 s44, s53, 32
    v_lshlrev_b32 v251, 16, v102
    v_and_b32 v102, s99, v102
    v_lshlrev_b32 v252, 16, v103
    v_and_b32 v103, s99, v103
    v_add_f32 v20, v20, v251
    v_add_f32 v21, v21, v102
    v_add_f32 v22, v22, v252
    v_add_f32 v23, v23, v103
    v_lshlrev_b32 v251, 16, v106
    v_and_b32 v106, s99, v106
    v_lshlrev_b32 v252, 16, v107
    v_and_b32 v107, s99, v107
    v_add_f32 v20, v20, v251
    v_add_f32 v21, v21, v106
    v_add_f32 v22, v22, v252
    v_add_f32 v23, v23, v107
    v_lshlrev_b32 v251, 16, v110
    v_and_b32 v110, s99, v110
    v_lshlrev_b32 v252, 16, v111
    v_and_b32 v111, s99, v111
    v_add_f32 v20, v20, v251
    v_add_f32 v21, v21, v110
    v_add_f32 v22, v22, v252
    v_add_f32 v23, v23, v111
    v_cvt_pk_bf16_f32 v20, v20, v21
    v_cvt_pk_bf16_f32 v21, v22, v23
    buffer_store_dwordx2 v[20:21], v225, s[8:11], s44 offen
    s_add_u32 s44, s53, 73760
    s_waitcnt vmcnt(2)
    v_lshlrev_b32 v251, 16, v112
    v_and_b32 v112, s99, v112
    v_lshlrev_b32 v252, 16, v113
    v_and_b32 v113, s99, v113
    v_add_f32 v36, v36, v251
    v_add_f32 v37, v37, v112
    v_add_f32 v38, v38, v252
    v_add_f32 v39, v39, v113
    v_lshlrev_b32 v251, 16, v116
    v_and_b32 v116, s99, v116
    v_lshlrev_b32 v252, 16, v117
    v_and_b32 v117, s99, v117
    v_add_f32 v36, v36, v251
    v_add_f32 v37, v37, v116
    v_add_f32 v38, v38, v252
    v_add_f32 v39, v39, v117
    v_lshlrev_b32 v251, 16, v120
    v_and_b32 v120, s99, v120
    v_lshlrev_b32 v252, 16, v121
    v_and_b32 v121, s99, v121
    v_add_f32 v36, v36, v251
    v_add_f32 v37, v37, v120
    v_add_f32 v38, v38, v252
    v_add_f32 v39, v39, v121
    v_cvt_pk_bf16_f32 v36, v36, v37
    v_cvt_pk_bf16_f32 v37, v38, v39
    buffer_store_dwordx2 v[36:37], v225, s[8:11], s44 offen
    s_add_u32 s44, s53, 55360
    v_lshlrev_b32 v251, 16, v114
    v_and_b32 v114, s99, v114
    v_lshlrev_b32 v252, 16, v115
    v_and_b32 v115, s99, v115
    v_add_f32 v52, v52, v251
    v_add_f32 v53, v53, v114
    v_add_f32 v54, v54, v252
    v_add_f32 v55, v55, v115
    v_lshlrev_b32 v251, 16, v118
    v_and_b32 v118, s99, v118
    v_lshlrev_b32 v252, 16, v119
    v_and_b32 v119, s99, v119
    v_add_f32 v52, v52, v251
    v_add_f32 v53, v53, v118
    v_add_f32 v54, v54, v252
    v_add_f32 v55, v55, v119
    v_lshlrev_b32 v251, 16, v122
    v_and_b32 v122, s99, v122
    v_lshlrev_b32 v252, 16, v123
    v_and_b32 v123, s99, v123
    v_add_f32 v52, v52, v251
    v_add_f32 v53, v53, v122
    v_add_f32 v54, v54, v252
    v_add_f32 v55, v55, v123
    v_cvt_pk_bf16_f32 v52, v52, v53
    v_cvt_pk_bf16_f32 v53, v54, v55
    buffer_store_dwordx2 v[52:53], v225, s[8:11], s44 offen
    s_branch attn_fin
op53_k2:
    s_nop 7
    s_add_u32 s44, s52, 65536
    v_cvt_pk_bf16_f32 v0, v0, v1
    v_cvt_pk_bf16_f32 v1, v2, v3
    v_cvt_pk_bf16_f32 v2, v16, v17
    v_cvt_pk_bf16_f32 v3, v18, v19
    buffer_store_dwordx4 v[0:3], v254, s[20:23], s44 offen offset:0 sc1
    v_cvt_pk_bf16_f32 v32, v32, v33
    v_cvt_pk_bf16_f32 v33, v34, v35
    v_cvt_pk_bf16_f32 v34, v48, v49
    v_cvt_pk_bf16_f32 v35, v50, v51
    buffer_store_dwordx4 v[32:35], v254, s[20:23], s44 offen offset:1024 sc1
    s_add_u32 s44, s52, 196608
    v_cvt_pk_bf16_f32 v4, v4, v5
    v_cvt_pk_bf16_f32 v5, v6, v7
    v_cvt_pk_bf16_f32 v6, v20, v21
    v_cvt_pk_bf16_f32 v7, v22, v23
    buffer_store_dwordx4 v[4:7], v254, s[20:23], s44 offen offset:0 sc1
    v_cvt_pk_bf16_f32 v36, v36, v37
    v_cvt_pk_bf16_f32 v37, v38, v39
    v_cvt_pk_bf16_f32 v38, v52, v53
    v_cvt_pk_bf16_f32 v39, v54, v55
    buffer_store_dwordx4 v[36:39], v254, s[20:23], s44 offen offset:1024 sc1
    s_add_u32 s44, s52, 458752
    v_cvt_pk_bf16_f32 v12, v12, v13
    v_cvt_pk_bf16_f32 v13, v14, v15
    v_cvt_pk_bf16_f32 v14, v28, v29
    v_cvt_pk_bf16_f32 v15, v30, v31
    buffer_store_dwordx4 v[12:15], v254, s[20:23], s44 offen offset:0 sc1
    v_cvt_pk_bf16_f32 v44, v44, v45
    v_cvt_pk_bf16_f32 v45, v46, v47
    buffer_store_dwordx4 v[44:47], v254, s[20:23], s44 offen offset:1024 sc1
    s_waitcnt vmcnt(0)
    s_barrier
    s_cmp_lg_u32 s30, 0
    s_cbranch_scc1 op53_nr2
    v_lshlrev_b32 v226, 8, v250
    v_mov_b32 v251, 1
    s_add_u32 s44, s54, -510
    s_mov_b64 exec, 15
    buffer_store_byte v251, v226, s[20:23], s44 offen sc1
    s_mov_b64 exec, -1
op53_nr2:
op53_q2:
    buffer_load_dword v226, off, s[20:23], s54 sc1
    s_waitcnt vmcnt(0)
    v_readfirstlane_b32 s40, v226
    s_nop 0
    s_cmp_eq_u32 s40, 0x01010101
    s_cbranch_scc1 op53_q2_ok
    s_sleep 4
    s_branch op53_q2
op53_q2_ok:
    s_add_u32 s94, s52, 262144
    s_add_u32 s95, s52, 294912
    s_add_u32 s96, s52, 360448
    buffer_load_dwordx4 v[100:103], v254, s[20:23], s94 offen offset:0 sc1
    buffer_load_dwordx4 v[104:107], v254, s[20:23], s95 offen offset:0 sc1
    buffer_load_dwordx4 v[108:111], v254, s[20:23], s96 offen offset:0 sc1
    buffer_load_dwordx4 v[112:115], v254, s[20:23], s94 offen offset:1024 sc1
    buffer_load_dwordx4 v[116:119], v254, s[20:23], s95 offen offset:1024 sc1
    buffer_load_dwordx4 v[120:123], v254, s[20:23], s96 offen offset:1024 sc1
    s_mov_b32 s99, 0xffff0000
    s_add_u32 s44, s53, 36864
    s_waitcnt vmcnt(3)
    v_lshlrev_b32 v251, 16, v100
    v_and_b32 v100, s99, v100
    v_lshlrev_b32 v252, 16, v101
    v_and_b32 v101, s99, v101
    v_add_f32 v8, v8, v251
    v_add_f32 v9, v9, v100
    v_add_f32 v10, v10, v252
    v_add_f32 v11, v11, v101
    v_lshlrev_b32 v251, 16, v104
    v_and_b32 v104, s99, v104
    v_lshlrev_b32 v252, 16, v105
    v_and_b32 v105, s99, v105
    v_add_f32 v8, v8, v251
    v_add_f32 v9, v9, v104
    v_add_f32 v10, v10, v252
    v_add_f32 v11, v11, v105
    v_lshlrev_b32 v251, 16, v108
    v_and_b32 v108, s99, v108
    v_lshlrev_b32 v252, 16, v109
    v_and_b32 v109, s99, v109
    v_add_f32 v8, v8, v251
    v_add_f32 v9, v9, v108
    v_add_f32 v10, v10, v252
    v_add_f32 v11, v11, v109
    v_cvt_pk_bf16_f32 v8, v8, v9
    v_cvt_pk_bf16_f32 v9, v10, v11
    buffer_store_dwordx2 v[8:9], v225, s[8:11], s44 offen
    s_add_u32 s44, s53, 18464
    v_lshlrev_b32 v251, 16, v102
    v_and_b32 v102, s99, v102
    v_lshlrev_b32 v252, 16, v103
    v_and_b32 v103, s99, v103
    v_add_f32 v24, v24, v251
    v_add_f32 v25, v25, v102
    v_add_f32 v26, v26, v252
    v_add_f32 v27, v27, v103
    v_lshlrev_b32 v251, 16, v106
    v_and_b32 v106, s99, v106
    v_lshlrev_b32 v252, 16, v107
    v_and_b32 v107, s99, v107
    v_add_f32 v24, v24, v251
    v_add_f32 v25, v25, v106
    v_add_f32 v26, v26, v252
    v_add_f32 v27, v27, v107
    v_lshlrev_b32 v251, 16, v110
    v_and_b32 v110, s99, v110
    v_lshlrev_b32 v252, 16, v111
    v_and_b32 v111, s99, v111
    v_add_f32 v24, v24, v251
    v_add_f32 v25, v25, v110
    v_add_f32 v26, v26, v252
    v_add_f32 v27, v27, v111
    v_cvt_pk_bf16_f32 v24, v24, v25
    v_cvt_pk_bf16_f32 v25, v26, v27
    buffer_store_dwordx2 v[24:25], v225, s[8:11], s44 offen
    s_add_u32 s44, s53, 64
    s_waitcnt vmcnt(2)
    v_lshlrev_b32 v251, 16, v112
    v_and_b32 v112, s99, v112
    v_lshlrev_b32 v252, 16, v113
    v_and_b32 v113, s99, v113
    v_add_f32 v40, v40, v251
    v_add_f32 v41, v41, v112
    v_add_f32 v42, v42, v252
    v_add_f32 v43, v43, v113
    v_lshlrev_b32 v251, 16, v116
    v_and_b32 v116, s99, v116
    v_lshlrev_b32 v252, 16, v117
    v_and_b32 v117, s99, v117
    v_add_f32 v40, v40, v251
    v_add_f32 v41, v41, v116
    v_add_f32 v42, v42, v252
    v_add_f32 v43, v43, v117
    v_lshlrev_b32 v251, 16, v120
    v_and_b32 v120, s99, v120
    v_lshlrev_b32 v252, 16, v121
    v_and_b32 v121, s99, v121
    v_add_f32 v40, v40, v251
    v_add_f32 v41, v41, v120
    v_add_f32 v42, v42, v252
    v_add_f32 v43, v43, v121
    v_cvt_pk_bf16_f32 v40, v40, v41
    v_cvt_pk_bf16_f32 v41, v42, v43
    buffer_store_dwordx2 v[40:41], v225, s[8:11], s44 offen
    s_add_u32 s44, s53, 73792
    v_lshlrev_b32 v251, 16, v114
    v_and_b32 v114, s99, v114
    v_lshlrev_b32 v252, 16, v115
    v_and_b32 v115, s99, v115
    v_add_f32 v56, v56, v251
    v_add_f32 v57, v57, v114
    v_add_f32 v58, v58, v252
    v_add_f32 v59, v59, v115
    v_lshlrev_b32 v251, 16, v118
    v_and_b32 v118, s99, v118
    v_lshlrev_b32 v252, 16, v119
    v_and_b32 v119, s99, v119
    v_add_f32 v56, v56, v251
    v_add_f32 v57, v57, v118
    v_add_f32 v58, v58, v252
    v_add_f32 v59, v59, v119
    v_lshlrev_b32 v251, 16, v122
    v_and_b32 v122, s99, v122
    v_lshlrev_b32 v252, 16, v123
    v_and_b32 v123, s99, v123
    v_add_f32 v56, v56, v251
    v_add_f32 v57, v57, v122
    v_add_f32 v58, v58, v252
    v_add_f32 v59, v59, v123
    v_cvt_pk_bf16_f32 v56, v56, v57
    v_cvt_pk_bf16_f32 v57, v58, v59
    buffer_store_dwordx2 v[56:57], v225, s[8:11], s44 offen
    s_branch attn_fin
op43:
    v_mov_b64 v[0:1], 0
    v_mov_b64 v[2:3], 0
    v_mov_b64 v[4:5], 0
    v_mov_b64 v[6:7], 0
    v_mov_b64 v[8:9], 0
    v_mov_b64 v[10:11], 0
    v_mov_b64 v[12:13], 0
    v_mov_b64 v[14:15], 0
    v_mov_b64 v[16:17], 0
    v_mov_b64 v[18:19], 0
    v_mov_b64 v[20:21], 0
    v_mov_b64 v[22:23], 0
    v_mov_b64 v[24:25], 0
    v_mov_b64 v[26:27], 0
    v_mov_b64 v[28:29], 0
    v_mov_b64 v[30:31], 0
    v_mov_b64 v[32:33], 0
    v_mov_b64 v[34:35], 0
    v_mov_b64 v[36:37], 0
    v_mov_b64 v[38:39], 0
    v_mov_b64 v[40:41], 0
    v_mov_b64 v[42:43], 0
    v_mov_b64 v[44:45], 0
    v_mov_b64 v[46:47], 0
    v_mov_b64 v[132:133], 0
    v_mov_b64 v[134:135], 0
    v_mov_b64 v[136:137], 0
    v_mov_b64 v[138:139], 0
    v_mov_b64 v[140:141], 0
    v_mov_b64 v[142:143], 0
    v_mov_b64 v[144:145], 0
    v_mov_b64 v[146:147], 0
    v_mov_b64 v[148:149], 0
    v_mov_b64 v[150:151], 0
    v_mov_b64 v[152:153], 0
    v_mov_b64 v[154:155], 0
    v_mov_b64 v[156:157], 0
    v_mov_b64 v[158:159], 0
    v_mov_b64 v[160:161], 0
    v_mov_b64 v[162:163], 0
    s_waitcnt vmcnt(0)
    s_barrier
    s_cmp_lg_u32 s30, 0
    s_cbranch_scc1 op43_g0_nf
    s_add_u32 s44, s85, s98
    v_mov_b32 v251, 1
    s_mov_b64 exec, 1
    buffer_store_byte v251, off, s[20:23], s44 sc1
    s_mov_b64 exec, -1
op43_g0_nf:
    s_cmp_lg_u32 s41, 0
    s_cbranch_scc1 op43_g0_nl
    buffer_load_dword v226, off, s[20:23], s98 sc1
op43_g0_nl:
    v_mfma_f32_16x16x32_bf16 v[0:3], v[152:155], v[132:135], v[0:3]
    ds_read_b64_tr_b16 v[120:121], v222 offset:0
    v_mfma_f32_16x16x32_bf16 v[4:7], v[152:155], v[136:139], v[4:7]
    ds_read_b64_tr_b16 v[122:123], v222 offset:576
    v_mfma_f32_16x16x32_bf16 v[8:11], v[152:155], v[140:143], v[8:11]
    ds_read_b128 v[100:103], v221 offset:0
    v_mfma_f32_16x16x32_bf16 v[12:15], v[152:155], v[144:147], v[12:15]
    ds_read_b128 v[104:107], v221 offset:2048
    v_mfma_f32_16x16x32_bf16 v[16:19], v[156:159], v[132:135], v[16:19]
    ds_read_b128 v[108:111], v221 offset:4096
    v_mfma_f32_16x16x32_bf16 v[20:23], v[156:159], v[136:139], v[20:23]
    ds_read_b128 v[112:115], v221 offset:6144
    v_mfma_f32_16x16x32_bf16 v[24:27], v[156:159], v[140:143], v[24:27]
    ds_read_b64_tr_b16 v[124:125], v222 offset:32
    v_mfma_f32_16x16x32_bf16 v[28:31], v[156:159], v[144:147], v[28:31]
    ds_read_b64_tr_b16 v[126:127], v222 offset:608
    v_mfma_f32_16x16x32_bf16 v[32:35], v[160:163], v[132:135], v[32:35]
    ds_read_b64_tr_b16 v[128:129], v222 offset:64
    v_mfma_f32_16x16x32_bf16 v[36:39], v[160:163], v[136:139], v[36:39]
    ds_read_b64_tr_b16 v[130:131], v222 offset:640
    v_mfma_f32_16x16x32_bf16 v[40:43], v[160:163], v[140:143], v[40:43]
    v_mfma_f32_16x16x32_bf16 v[44:47], v[160:163], v[144:147], v[44:47]
    s_waitcnt lgkmcnt(5)
    v_mfma_f32_16x16x32_bf16 v[0:3], v[120:123], v[100:103], v[0:3]
    ds_read_b64_tr_b16 v[152:153], v222 offset:9472
    v_mfma_f32_16x16x32_bf16 v[4:7], v[120:123], v[104:107], v[4:7]
    ds_read_b64_tr_b16 v[154:155], v222 offset:10048
    v_mfma_f32_16x16x32_bf16 v[8:11], v[120:123], v[108:111], v[8:11]
    ds_read_b128 v[132:135], v221 offset:1024
    s_waitcnt lgkmcnt(3)
    v_mfma_f32_16x16x32_bf16 v[12:15], v[120:123], v[112:115], v[12:15]
    ds_read_b128 v[136:139], v221 offset:3072
    v_mfma_f32_16x16x32_bf16 v[16:19], v[124:127], v[100:103], v[16:19]
    ds_read_b128 v[140:143], v221 offset:5120
    v_mfma_f32_16x16x32_bf16 v[20:23], v[124:127], v[104:107], v[20:23]
    ds_read_b128 v[144:147], v221 offset:7168
    v_mfma_f32_16x16x32_bf16 v[24:27], v[124:127], v[108:111], v[24:27]
    ds_read_b64_tr_b16 v[156:157], v222 offset:9504
    v_mfma_f32_16x16x32_bf16 v[28:31], v[124:127], v[112:115], v[28:31]
    ds_read_b64_tr_b16 v[158:159], v222 offset:10080
    v_mfma_f32_16x16x32_bf16 v[32:35], v[128:131], v[100:103], v[32:35]
    ds_read_b64_tr_b16 v[160:161], v222 offset:9536
    v_mfma_f32_16x16x32_bf16 v[36:39], v[128:131], v[104:107], v[36:39]
    ds_read_b64_tr_b16 v[162:163], v222 offset:10112
    v_mfma_f32_16x16x32_bf16 v[40:43], v[128:131], v[108:111], v[40:43]
    v_mfma_f32_16x16x32_bf16 v[44:47], v[128:131], v[112:115], v[44:47]
    s_waitcnt lgkmcnt(0)
    s_cmp_lg_u32 s41, 0
    s_cbranch_scc1 op43_g1_nw
    s_waitcnt vmcnt(0)
    v_readfirstlane_b32 s40, v226
op43_g1_nw:
    s_barrier
    s_add_u32 s44, s42, s85
    s_and_b32 s44, s44, 3
    s_lshl_b32 s44, s44, 3
    s_bitcmp1_b32 s40, s44
    s_cbranch_scc0 op43_g1_ie
op43_g1_il:
    s_mul_i32 s99, s41, 19456
    s_add_u32 m0, s43, s99
    s_add_u32 s45, s46, 8192
    buffer_load_dwordx4 v254, s[20:23], s46 offen sc1 lds
    s_add_u32 m0, m0, 8192
    s_add_u32 s46, s46, 18432
    buffer_load_dwordx4 v254, s[20:23], s45 offen sc1 lds
    s_add_u32 m0, s78, s99
    s_nop 0
    buffer_load_dwordx4 v244, s[16:19], s47 offen sc1 lds
    s_add_u32 m0, s79, s99
    s_add_u32 s47, s47, s48
    buffer_load_dwordx4 v245, s[12:15], s77 offen lds
    s_add_u32 m0, s80, s99
    s_nop 0
    buffer_load_dwordx4 v246, s[12:15], s77 offen lds
    s_add_u32 s77, s77, 73728
    s_add_u32 s41, s41, 1
    s_cmp_lt_u32 s41, 1
    s_cbranch_scc1 op43_g1_il
op43_g1_ie:
    s_cmp_lg_u32 s41, 0
    s_cbranch_scc1 op43_g1_nl
    buffer_load_dword v226, off, s[20:23], s98 sc1
op43_g1_nl:
    v_mfma_f32_16x16x32_bf16 v[0:3], v[152:155], v[132:135], v[0:3]
    ds_read_b64_tr_b16 v[120:121], v222 offset:19456
    v_mfma_f32_16x16x32_bf16 v[4:7], v[152:155], v[136:139], v[4:7]
    ds_read_b64_tr_b16 v[122:123], v222 offset:20032
    v_mfma_f32_16x16x32_bf16 v[8:11], v[152:155], v[140:143], v[8:11]
    ds_read_b128 v[100:103], v221 offset:19456
    v_mfma_f32_16x16x32_bf16 v[12:15], v[152:155], v[144:147], v[12:15]
    ds_read_b128 v[104:107], v221 offset:21504
    v_mfma_f32_16x16x32_bf16 v[16:19], v[156:159], v[132:135], v[16:19]
    ds_read_b128 v[108:111], v221 offset:23552
    v_mfma_f32_16x16x32_bf16 v[20:23], v[156:159], v[136:139], v[20:23]
    ds_read_b128 v[112:115], v221 offset:25600
    v_mfma_f32_16x16x32_bf16 v[24:27], v[156:159], v[140:143], v[24:27]
    ds_read_b64_tr_b16 v[124:125], v222 offset:19488
    v_mfma_f32_16x16x32_bf16 v[28:31], v[156:159], v[144:147], v[28:31]
    ds_read_b64_tr_b16 v[126:127], v222 offset:20064
    v_mfma_f32_16x16x32_bf16 v[32:35], v[160:163], v[132:135], v[32:35]
    ds_read_b64_tr_b16 v[128:129], v222 offset:19520
    v_mfma_f32_16x16x32_bf16 v[36:39], v[160:163], v[136:139], v[36:39]
    ds_read_b64_tr_b16 v[130:131], v222 offset:20096
    v_mfma_f32_16x16x32_bf16 v[40:43], v[160:163], v[140:143], v[40:43]
    v_mfma_f32_16x16x32_bf16 v[44:47], v[160:163], v[144:147], v[44:47]
    s_waitcnt lgkmcnt(5)
    v_mfma_f32_16x16x32_bf16 v[0:3], v[120:123], v[100:103], v[0:3]
    ds_read_b64_tr_b16 v[152:153], v222 offset:28928
    v_mfma_f32_16x16x32_bf16 v[4:7], v[120:123], v[104:107], v[4:7]
    ds_read_b64_tr_b16 v[154:155], v222 offset:29504
    v_mfma_f32_16x16x32_bf16 v[8:11], v[120:123], v[108:111], v[8:11]
    ds_read_b128 v[132:135], v221 offset:20480
    s_waitcnt lgkmcnt(3)
    v_mfma_f32_16x16x32_bf16 v[12:15], v[120:123], v[112:115], v[12:15]
    ds_read_b128 v[136:139], v221 offset:22528
    v_mfma_f32_16x16x32_bf16 v[16:19], v[124:127], v[100:103], v[16:19]
    ds_read_b128 v[140:143], v221 offset:24576
    v_mfma_f32_16x16x32_bf16 v[20:23], v[124:127], v[104:107], v[20:23]
    ds_read_b128 v[144:147], v221 offset:26624
    v_mfma_f32_16x16x32_bf16 v[24:27], v[124:127], v[108:111], v[24:27]
    ds_read_b64_tr_b16 v[156:157], v222 offset:28960
    v_mfma_f32_16x16x32_bf16 v[28:31], v[124:127], v[112:115], v[28:31]
    ds_read_b64_tr_b16 v[158:159], v222 offset:29536
    v_mfma_f32_16x16x32_bf16 v[32:35], v[128:131], v[100:103], v[32:35]
    ds_read_b64_tr_b16 v[160:161], v222 offset:28992
    v_mfma_f32_16x16x32_bf16 v[36:39], v[128:131], v[104:107], v[36:39]
    ds_read_b64_tr_b16 v[162:163], v222 offset:29568
    v_mfma_f32_16x16x32_bf16 v[40:43], v[128:131], v[108:111], v[40:43]
    v_mfma_f32_16x16x32_bf16 v[44:47], v[128:131], v[112:115], v[44:47]
    s_waitcnt lgkmcnt(0)
    s_cmp_lg_u32 s41, 0
    s_cbranch_scc1 op43_g2_nw
    s_waitcnt vmcnt(0)
    v_readfirstlane_b32 s40, v226
op43_g2_nw:
    s_barrier
    s_add_u32 s44, s42, s85
    s_and_b32 s44, s44, 3
    s_lshl_b32 s44, s44, 3
    s_bitcmp1_b32 s40, s44
    s_cbranch_scc0 op43_g2_ie
op43_g2_il:
    s_mul_i32 s99, s41, 19456
    s_add_u32 m0, s43, s99
    s_add_u32 s45, s46, 8192
    buffer_load_dwordx4 v254, s[20:23], s46 offen sc1 lds
    s_add_u32 m0, m0, 8192
    s_add_u32 s46, s46, 18432
    buffer_load_dwordx4 v254, s[20:23], s45 offen sc1 lds
    s_add_u32 m0, s78, s99
    s_nop 0
    buffer_load_dwordx4 v244, s[16:19], s47 offen sc1 lds
    s_add_u32 m0, s79, s99
    s_add_u32 s47, s47, s48
    buffer_load_dwordx4 v245, s[12:15], s77 offen lds
    s_add_u32 m0, s80, s99
    s_nop 0
    buffer_load_dwordx4 v246, s[12:15], s77 offen lds
    s_add_u32 s77, s77, 73728
    s_add_u32 s41, s41, 1
    s_cmp_lt_u32 s41, 2
    s_cbranch_scc1 op43_g2_il
op43_g2_ie:
    s_cmp_lg_u32 s41, 0
    s_cbranch_scc1 op43_g2_nl
    buffer_load_dword v226, off, s[20:23], s98 sc1
op43_g2_nl:
    v_mfma_f32_16x16x32_bf16 v[0:3], v[152:155], v[132:135], v[0:3]
    ds_read_b64_tr_b16 v[120:121], v224 offset:0
    v_mfma_f32_16x16x32_bf16 v[4:7], v[152:155], v[136:139], v[4:7]
    ds_read_b64_tr_b16 v[122:123], v224 offset:576
    v_mfma_f32_16x16x32_bf16 v[8:11], v[152:155], v[140:143], v[8:11]
    ds_read_b128 v[100:103], v223 offset:0
    v_mfma_f32_16x16x32_bf16 v[12:15], v[152:155], v[144:147], v[12:15]
    ds_read_b128 v[104:107], v223 offset:2048
    v_mfma_f32_16x16x32_bf16 v[16:19], v[156:159], v[132:135], v[16:19]
    ds_read_b128 v[108:111], v223 offset:4096
    v_mfma_f32_16x16x32_bf16 v[20:23], v[156:159], v[136:139], v[20:23]
    ds_read_b128 v[112:115], v223 offset:6144
    v_mfma_f32_16x16x32_bf16 v[24:27], v[156:159], v[140:143], v[24:27]
    ds_read_b64_tr_b16 v[124:125], v224 offset:32
    v_mfma_f32_16x16x32_bf16 v[28:31], v[156:159], v[144:147], v[28:31]
    ds_read_b64_tr_b16 v[126:127], v224 offset:608
    v_mfma_f32_16x16x32_bf16 v[32:35], v[160:163], v[132:135], v[32:35]
    ds_read_b64_tr_b16 v[128:129], v224 offset:64
    v_mfma_f32_16x16x32_bf16 v[36:39], v[160:163], v[136:139], v[36:39]
    ds_read_b64_tr_b16 v[130:131], v224 offset:640
    v_mfma_f32_16x16x32_bf16 v[40:43], v[160:163], v[140:143], v[40:43]
    v_mfma_f32_16x16x32_bf16 v[44:47], v[160:163], v[144:147], v[44:47]
    s_waitcnt lgkmcnt(5)
    v_mfma_f32_16x16x32_bf16 v[0:3], v[120:123], v[100:103], v[0:3]
    ds_read_b64_tr_b16 v[152:153], v224 offset:9472
    v_mfma_f32_16x16x32_bf16 v[4:7], v[120:123], v[104:107], v[4:7]
    ds_read_b64_tr_b16 v[154:155], v224 offset:10048
    v_mfma_f32_16x16x32_bf16 v[8:11], v[120:123], v[108:111], v[8:11]
    ds_read_b128 v[132:135], v223 offset:1024
    s_waitcnt lgkmcnt(3)
    v_mfma_f32_16x16x32_bf16 v[12:15], v[120:123], v[112:115], v[12:15]
    ds_read_b128 v[136:139], v223 offset:3072
    v_mfma_f32_16x16x32_bf16 v[16:19], v[124:127], v[100:103], v[16:19]
    ds_read_b128 v[140:143], v223 offset:5120
    v_mfma_f32_16x16x32_bf16 v[20:23], v[124:127], v[104:107], v[20:23]
    ds_read_b128 v[144:147], v223 offset:7168
    v_mfma_f32_16x16x32_bf16 v[24:27], v[124:127], v[108:111], v[24:27]
    ds_read_b64_tr_b16 v[156:157], v224 offset:9504
    v_mfma_f32_16x16x32_bf16 v[28:31], v[124:127], v[112:115], v[28:31]
    ds_read_b64_tr_b16 v[158:159], v224 offset:10080
    v_mfma_f32_16x16x32_bf16 v[32:35], v[128:131], v[100:103], v[32:35]
    ds_read_b64_tr_b16 v[160:161], v224 offset:9536
    v_mfma_f32_16x16x32_bf16 v[36:39], v[128:131], v[104:107], v[36:39]
    ds_read_b64_tr_b16 v[162:163], v224 offset:10112
    v_mfma_f32_16x16x32_bf16 v[40:43], v[128:131], v[108:111], v[40:43]
    v_mfma_f32_16x16x32_bf16 v[44:47], v[128:131], v[112:115], v[44:47]
    s_waitcnt lgkmcnt(0)
    s_cmp_lg_u32 s41, 0
    s_cbranch_scc1 op43_g3_nw
    s_waitcnt vmcnt(0)
    v_readfirstlane_b32 s40, v226
op43_g3_nw:
    s_barrier
    s_add_u32 s44, s42, s85
    s_and_b32 s44, s44, 3
    s_lshl_b32 s44, s44, 3
    s_bitcmp1_b32 s40, s44
    s_cbranch_scc0 op43_g3_ie
op43_g3_il:
    s_mul_i32 s99, s41, 19456
    s_add_u32 m0, s43, s99
    s_add_u32 s45, s46, 8192
    buffer_load_dwordx4 v254, s[20:23], s46 offen sc1 lds
    s_add_u32 m0, m0, 8192
    s_add_u32 s46, s46, 18432
    buffer_load_dwordx4 v254, s[20:23], s45 offen sc1 lds
    s_add_u32 m0, s78, s99
    s_nop 0
    buffer_load_dwordx4 v244, s[16:19], s47 offen sc1 lds
    s_add_u32 m0, s79, s99
    s_add_u32 s47, s47, s48
    buffer_load_dwordx4 v245, s[12:15], s77 offen lds
    s_add_u32 m0, s80, s99
    s_nop 0
    buffer_load_dwordx4 v246, s[12:15], s77 offen lds
    s_add_u32 s77, s77, 73728
    s_add_u32 s41, s41, 1
    s_cmp_lt_u32 s41, 3
    s_cbranch_scc1 op43_g3_il
op43_g3_ie:
    s_cmp_lg_u32 s41, 0
    s_cbranch_scc1 op43_g3_nl
    buffer_load_dword v226, off, s[20:23], s98 sc1
op43_g3_nl:
    v_mfma_f32_16x16x32_bf16 v[0:3], v[152:155], v[132:135], v[0:3]
    ds_read_b64_tr_b16 v[120:121], v224 offset:19456
    v_mfma_f32_16x16x32_bf16 v[4:7], v[152:155], v[136:139], v[4:7]
    ds_read_b64_tr_b16 v[122:123], v224 offset:20032
    v_mfma_f32_16x16x32_bf16 v[8:11], v[152:155], v[140:143], v[8:11]
    ds_read_b128 v[100:103], v223 offset:19456
    v_mfma_f32_16x16x32_bf16 v[12:15], v[152:155], v[144:147], v[12:15]
    ds_read_b128 v[104:107], v223 offset:21504
    v_mfma_f32_16x16x32_bf16 v[16:19], v[156:159], v[132:135], v[16:19]
    ds_read_b128 v[108:111], v223 offset:23552
    v_mfma_f32_16x16x32_bf16 v[20:23], v[156:159], v[136:139], v[20:23]
    ds_read_b128 v[112:115], v223 offset:25600
    v_mfma_f32_16x16x32_bf16 v[24:27], v[156:159], v[140:143], v[24:27]
    ds_read_b64_tr_b16 v[124:125], v224 offset:19488
    v_mfma_f32_16x16x32_bf16 v[28:31], v[156:159], v[144:147], v[28:31]
    ds_read_b64_tr_b16 v[126:127], v224 offset:20064
    v_mfma_f32_16x16x32_bf16 v[32:35], v[160:163], v[132:135], v[32:35]
    ds_read_b64_tr_b16 v[128:129], v224 offset:19520
    v_mfma_f32_16x16x32_bf16 v[36:39], v[160:163], v[136:139], v[36:39]
    ds_read_b64_tr_b16 v[130:131], v224 offset:20096
    v_mfma_f32_16x16x32_bf16 v[40:43], v[160:163], v[140:143], v[40:43]
    v_mfma_f32_16x16x32_bf16 v[44:47], v[160:163], v[144:147], v[44:47]
    s_waitcnt lgkmcnt(5)
    v_mfma_f32_16x16x32_bf16 v[0:3], v[120:123], v[100:103], v[0:3]
    ds_read_b64_tr_b16 v[152:153], v224 offset:28928
    v_mfma_f32_16x16x32_bf16 v[4:7], v[120:123], v[104:107], v[4:7]
    ds_read_b64_tr_b16 v[154:155], v224 offset:29504
    v_mfma_f32_16x16x32_bf16 v[8:11], v[120:123], v[108:111], v[8:11]
    ds_read_b128 v[132:135], v223 offset:20480
    s_waitcnt lgkmcnt(3)
    v_mfma_f32_16x16x32_bf16 v[12:15], v[120:123], v[112:115], v[12:15]
    ds_read_b128 v[136:139], v223 offset:22528
    v_mfma_f32_16x16x32_bf16 v[16:19], v[124:127], v[100:103], v[16:19]
    ds_read_b128 v[140:143], v223 offset:24576
    v_mfma_f32_16x16x32_bf16 v[20:23], v[124:127], v[104:107], v[20:23]
    ds_read_b128 v[144:147], v223 offset:26624
    v_mfma_f32_16x16x32_bf16 v[24:27], v[124:127], v[108:111], v[24:27]
    ds_read_b64_tr_b16 v[156:157], v224 offset:28960
    v_mfma_f32_16x16x32_bf16 v[28:31], v[124:127], v[112:115], v[28:31]
    ds_read_b64_tr_b16 v[158:159], v224 offset:29536
    v_mfma_f32_16x16x32_bf16 v[32:35], v[128:131], v[100:103], v[32:35]
    ds_read_b64_tr_b16 v[160:161], v224 offset:28992
    v_mfma_f32_16x16x32_bf16 v[36:39], v[128:131], v[104:107], v[36:39]
    ds_read_b64_tr_b16 v[162:163], v224 offset:29568
    v_mfma_f32_16x16x32_bf16 v[40:43], v[128:131], v[108:111], v[40:43]
    v_mfma_f32_16x16x32_bf16 v[44:47], v[128:131], v[112:115], v[44:47]
    s_waitcnt lgkmcnt(0)
    s_cmp_lg_u32 s41, 0
    s_cbranch_scc1 op43_j3
    s_waitcnt vmcnt(0)
    v_readfirstlane_b32 s40, v226
    s_add_u32 s44, s42, s85
    s_and_b32 s44, s44, 3
    s_lshl_b32 s44, s44, 3
    s_bitcmp1_b32 s40, s44
    s_cbranch_scc1 op43_p0_ok
op43_p0:
    buffer_load_dword v226, off, s[20:23], s98 sc1
    s_waitcnt vmcnt(0)
    v_readfirstlane_b32 s40, v226
    s_add_u32 s44, s42, s85
    s_and_b32 s44, s44, 3
    s_lshl_b32 s44, s44, 3
    s_bitcmp1_b32 s40, s44
    s_cbranch_scc1 op43_p0_ok
    s_sleep 4
    s_branch op43_p0
op43_p0_ok:
    buffer_load_dword v226, off, s[20:23], s98 sc1
    s_add_u32 m0, s43, 0
    s_add_u32 s45, s46, 8192
    buffer_load_dwordx4 v254, s[20:23], s46 offen sc1 lds
    s_add_u32 m0, m0, 8192
    s_add_u32 s46, s46, 18432
    buffer_load_dwordx4 v254, s[20:23], s45 offen sc1 lds
    s_add_u32 m0, s78, 0
    s_nop 0
    buffer_load_dwordx4 v244, s[16:19], s47 offen sc1 lds
    s_add_u32 m0, s79, 0
    s_add_u32 s47, s47, s48
    buffer_load_dwordx4 v245, s[12:15], s77 offen lds
    s_add_u32 m0, s80, 0
    s_nop 0
    buffer_load_dwordx4 v246, s[12:15], s77 offen lds
    s_add_u32 s77, s77, 73728
    s_add_u32 m0, s43, 19456
    s_add_u32 s45, s46, 8192
    buffer_load_dwordx4 v254, s[20:23], s46 offen sc1 lds
    s_add_u32 m0, m0, 8192
    s_add_u32 s46, s46, 18432
    buffer_load_dwordx4 v254, s[20:23], s45 offen sc1 lds
    s_add_u32 m0, s78, 19456
    s_nop 0
    buffer_load_dwordx4 v244, s[16:19], s47 offen sc1 lds
    s_add_u32 m0, s79, 19456
    s_add_u32 s47, s47, s48
    buffer_load_dwordx4 v245, s[12:15], s77 offen lds
    s_add_u32 m0, s80, 19456
    s_nop 0
    buffer_load_dwordx4 v246, s[12:15], s77 offen lds
    s_add_u32 s77, s77, 73728
    s_add_u32 m0, s43, 38912
    s_add_u32 s45, s46, 8192
    buffer_load_dwordx4 v254, s[20:23], s46 offen sc1 lds
    s_add_u32 m0, m0, 8192
    s_add_u32 s46, s46, 18432
    buffer_load_dwordx4 v254, s[20:23], s45 offen sc1 lds
    s_add_u32 m0, s78, 38912
    s_nop 0
    buffer_load_dwordx4 v244, s[16:19], s47 offen sc1 lds
    s_add_u32 m0, s79, 38912
    s_add_u32 s47, s47, s48
    buffer_load_dwordx4 v245, s[12:15], s77 offen lds
    s_add_u32 m0, s80, 38912
    s_nop 0
    buffer_load_dwordx4 v246, s[12:15], s77 offen lds
    s_add_u32 s77, s77, 73728
op43_j3:
op43_loop:
    s_waitcnt vmcnt(10)
    s_barrier
    v_mfma_f32_16x16x32_bf16 v[0:3], v[152:155], v[132:135], v[0:3]
    ds_read_b64_tr_b16 v[120:121], v222 offset:0
    s_add_u32 m0, s43, 58368
    v_mfma_f32_16x16x32_bf16 v[4:7], v[152:155], v[136:139], v[4:7]
    ds_read_b64_tr_b16 v[122:123], v222 offset:576
    v_mfma_f32_16x16x32_bf16 v[8:11], v[152:155], v[140:143], v[8:11]
    ds_read_b128 v[100:103], v221 offset:0
    s_add_u32 s45, s46, 8192
    v_mfma_f32_16x16x32_bf16 v[12:15], v[152:155], v[144:147], v[12:15]
    ds_read_b128 v[104:107], v221 offset:2048
    v_mfma_f32_16x16x32_bf16 v[16:19], v[156:159], v[132:135], v[16:19]
    ds_read_b128 v[108:111], v221 offset:4096
    buffer_load_dwordx4 v254, s[20:23], s46 offen sc1 lds
    v_mfma_f32_16x16x32_bf16 v[20:23], v[156:159], v[136:139], v[20:23]
    ds_read_b128 v[112:115], v221 offset:6144
    v_mfma_f32_16x16x32_bf16 v[24:27], v[156:159], v[140:143], v[24:27]
    ds_read_b64_tr_b16 v[124:125], v222 offset:32
    s_add_u32 m0, m0, 8192
    v_mfma_f32_16x16x32_bf16 v[28:31], v[156:159], v[144:147], v[28:31]
    ds_read_b64_tr_b16 v[126:127], v222 offset:608
    v_mfma_f32_16x16x32_bf16 v[32:35], v[160:163], v[132:135], v[32:35]
    ds_read_b64_tr_b16 v[128:129], v222 offset:64
    s_add_u32 s46, s46, 18432
    v_mfma_f32_16x16x32_bf16 v[36:39], v[160:163], v[136:139], v[36:39]
    ds_read_b64_tr_b16 v[130:131], v222 offset:640
    v_mfma_f32_16x16x32_bf16 v[40:43], v[160:163], v[140:143], v[40:43]
    buffer_load_dwordx4 v254, s[20:23], s45 offen sc1 lds
    s_add_u32 m0, s78, 58368
    v_mfma_f32_16x16x32_bf16 v[44:47], v[160:163], v[144:147], v[44:47]
    s_nop 0
    s_waitcnt lgkmcnt(5)
    v_mfma_f32_16x16x32_bf16 v[0:3], v[120:123], v[100:103], v[0:3]
    ds_read_b64_tr_b16 v[152:153], v222 offset:9472
    buffer_load_dwordx4 v244, s[16:19], s47 offen sc1 lds
    v_mfma_f32_16x16x32_bf16 v[4:7], v[120:123], v[104:107], v[4:7]
    ds_read_b64_tr_b16 v[154:155], v222 offset:10048
    v_mfma_f32_16x16x32_bf16 v[8:11], v[120:123], v[108:111], v[8:11]
    ds_read_b128 v[132:135], v221 offset:1024
    s_add_u32 m0, s79, 58368
    s_waitcnt lgkmcnt(3)
    v_mfma_f32_16x16x32_bf16 v[12:15], v[120:123], v[112:115], v[12:15]
    ds_read_b128 v[136:139], v221 offset:3072
    v_mfma_f32_16x16x32_bf16 v[16:19], v[124:127], v[100:103], v[16:19]
    ds_read_b128 v[140:143], v221 offset:5120
    s_add_u32 s47, s47, s48
    v_mfma_f32_16x16x32_bf16 v[20:23], v[124:127], v[104:107], v[20:23]
    ds_read_b128 v[144:147], v221 offset:7168
    v_mfma_f32_16x16x32_bf16 v[24:27], v[124:127], v[108:111], v[24:27]
    ds_read_b64_tr_b16 v[156:157], v222 offset:9504
    buffer_load_dwordx4 v245, s[12:15], s77 offen lds
    v_mfma_f32_16x16x32_bf16 v[28:31], v[124:127], v[112:115], v[28:31]
    ds_read_b64_tr_b16 v[158:159], v222 offset:10080
    v_mfma_f32_16x16x32_bf16 v[32:35], v[128:131], v[100:103], v[32:35]
    ds_read_b64_tr_b16 v[160:161], v222 offset:9536
    s_add_u32 m0, s80, 58368
    v_mfma_f32_16x16x32_bf16 v[36:39], v[128:131], v[104:107], v[36:39]
    ds_read_b64_tr_b16 v[162:163], v222 offset:10112
    v_mfma_f32_16x16x32_bf16 v[40:43], v[128:131], v[108:111], v[40:43]
    s_nop 0
    buffer_load_dwordx4 v246, s[12:15], s77 offen lds
    v_mfma_f32_16x16x32_bf16 v[44:47], v[128:131], v[112:115], v[44:47]
    s_add_u32 s77, s77, 73728
    s_waitcnt lgkmcnt(0)
    s_waitcnt vmcnt(10)
    s_barrier
    v_readfirstlane_b32 s40, v226
    s_add_u32 s42, s42, 1
    s_add_u32 s44, s42, s85
    s_and_b32 s44, s44, 3
    s_lshl_b32 s44, s44, 3
    s_bitcmp1_b32 s40, s44
    s_cbranch_scc0 op43_late
op43_rdy:
    v_mfma_f32_16x16x32_bf16 v[0:3], v[152:155], v[132:135], v[0:3]
    ds_read_b64_tr_b16 v[120:121], v222 offset:19456
    s_add_u32 s44, s85, s42
    v_mfma_f32_16x16x32_bf16 v[4:7], v[152:155], v[136:139], v[4:7]
    ds_read_b64_tr_b16 v[122:123], v222 offset:20032
    s_cmp_eq_u32 s44, 4
    v_mfma_f32_16x16x32_bf16 v[8:11], v[152:155], v[140:143], v[8:11]
    ds_read_b128 v[100:103], v221 offset:19456
    s_cselect_b32 s44, 16, 0
    v_mfma_f32_16x16x32_bf16 v[12:15], v[152:155], v[144:147], v[12:15]
    ds_read_b128 v[104:107], v221 offset:21504
    s_cmp_eq_u32 s42, 4
    v_mfma_f32_16x16x32_bf16 v[16:19], v[156:159], v[132:135], v[16:19]
    ds_read_b128 v[108:111], v221 offset:23552
    s_cselect_b32 s44, 0xffff0000, s44
    v_mfma_f32_16x16x32_bf16 v[20:23], v[156:159], v[136:139], v[20:23]
    ds_read_b128 v[112:115], v221 offset:25600
    s_mul_i32 s45, s44, 18432
    v_mfma_f32_16x16x32_bf16 v[24:27], v[156:159], v[140:143], v[24:27]
    ds_read_b64_tr_b16 v[124:125], v222 offset:19488
    s_sub_u32 s46, s46, s45
    v_mfma_f32_16x16x32_bf16 v[28:31], v[156:159], v[144:147], v[28:31]
    ds_read_b64_tr_b16 v[126:127], v222 offset:20064
    s_mul_i32 s45, s44, 73728
    v_mfma_f32_16x16x32_bf16 v[32:35], v[160:163], v[132:135], v[32:35]
    ds_read_b64_tr_b16 v[128:129], v222 offset:19520
    s_sub_u32 s77, s77, s45
    v_mfma_f32_16x16x32_bf16 v[36:39], v[160:163], v[136:139], v[36:39]
    ds_read_b64_tr_b16 v[130:131], v222 offset:20096
    s_mul_i32 s45, s44, s48
    v_mfma_f32_16x16x32_bf16 v[40:43], v[160:163], v[140:143], v[40:43]
    s_sub_u32 s47, s47, s45
    s_add_u32 m0, s43, 0
    v_mfma_f32_16x16x32_bf16 v[44:47], v[160:163], v[144:147], v[44:47]
    s_add_u32 s45, s46, 8192
    s_waitcnt lgkmcnt(5)
    v_mfma_f32_16x16x32_bf16 v[0:3], v[120:123], v[100:103], v[0:3]
    ds_read_b64_tr_b16 v[152:153], v222 offset:28928
    buffer_load_dwordx4 v254, s[20:23], s46 offen sc1 lds
    v_mfma_f32_16x16x32_bf16 v[4:7], v[120:123], v[104:107], v[4:7]
    ds_read_b64_tr_b16 v[154:155], v222 offset:29504
    s_add_u32 m0, m0, 8192
    v_mfma_f32_16x16x32_bf16 v[8:11], v[120:123], v[108:111], v[8:11]
    ds_read_b128 v[132:135], v221 offset:20480
    s_add_u32 s46, s46, 18432
    s_waitcnt lgkmcnt(3)
    v_mfma_f32_16x16x32_bf16 v[12:15], v[120:123], v[112:115], v[12:15]
    ds_read_b128 v[136:139], v221 offset:22528
    buffer_load_dwordx4 v254, s[20:23], s45 offen sc1 lds
    v_mfma_f32_16x16x32_bf16 v[16:19], v[124:127], v[100:103], v[16:19]
    ds_read_b128 v[140:143], v221 offset:24576
    s_add_u32 m0, s78, 0
    v_mfma_f32_16x16x32_bf16 v[20:23], v[124:127], v[104:107], v[20:23]
    ds_read_b128 v[144:147], v221 offset:26624
    s_nop 0
    v_mfma_f32_16x16x32_bf16 v[24:27], v[124:127], v[108:111], v[24:27]
    ds_read_b64_tr_b16 v[156:157], v222 offset:28960
    buffer_load_dwordx4 v244, s[16:19], s47 offen sc1 lds
    v_mfma_f32_16x16x32_bf16 v[28:31], v[124:127], v[112:115], v[28:31]
    ds_read_b64_tr_b16 v[158:159], v222 offset:29536
    s_add_u32 m0, s79, 0
    v_mfma_f32_16x16x32_bf16 v[32:35], v[128:131], v[100:103], v[32:35]
    ds_read_b64_tr_b16 v[160:161], v222 offset:28992
    s_add_u32 s47, s47, s48
    v_mfma_f32_16x16x32_bf16 v[36:39], v[128:131], v[104:107], v[36:39]
    ds_read_b64_tr_b16 v[162:163], v222 offset:29568
    buffer_load_dwordx4 v245, s[12:15], s77 offen lds
    v_mfma_f32_16x16x32_bf16 v[40:43], v[128:131], v[108:111], v[40:43]
    s_add_u32 m0, s80, 0
    s_nop 0
    v_mfma_f32_16x16x32_bf16 v[44:47], v[128:131], v[112:115], v[44:47]
    buffer_load_dwordx4 v246, s[12:15], s77 offen lds
    s_add_u32 s77, s77, 73728
    s_waitcnt lgkmcnt(0)
    s_waitcnt vmcnt(10)
    s_barrier
    v_mfma_f32_16x16x32_bf16 v[0:3], v[152:155], v[132:135], v[0:3]
    ds_read_b64_tr_b16 v[120:121], v224 offset:0
    s_add_u32 m0, s43, 19456
    v_mfma_f32_16x16x32_bf16 v[4:7], v[152:155], v[136:139], v[4:7]
    ds_read_b64_tr_b16 v[122:123], v224 offset:576
    v_mfma_f32_16x16x32_bf16 v[8:11], v[152:155], v[140:143], v[8:11]
    ds_read_b128 v[100:103], v223 offset:0
    s_add_u32 s45, s46, 8192
    v_mfma_f32_16x16x32_bf16 v[12:15], v[152:155], v[144:147], v[12:15]
    ds_read_b128 v[104:107], v223 offset:2048
    v_mfma_f32_16x16x32_bf16 v[16:19], v[156:159], v[132:135], v[16:19]
    ds_read_b128 v[108:111], v223 offset:4096
    buffer_load_dwordx4 v254, s[20:23], s46 offen sc1 lds
    v_mfma_f32_16x16x32_bf16 v[20:23], v[156:159], v[136:139], v[20:23]
    ds_read_b128 v[112:115], v223 offset:6144
    v_mfma_f32_16x16x32_bf16 v[24:27], v[156:159], v[140:143], v[24:27]
    ds_read_b64_tr_b16 v[124:125], v224 offset:32
    s_add_u32 m0, m0, 8192
    v_mfma_f32_16x16x32_bf16 v[28:31], v[156:159], v[144:147], v[28:31]
    ds_read_b64_tr_b16 v[126:127], v224 offset:608
    v_mfma_f32_16x16x32_bf16 v[32:35], v[160:163], v[132:135], v[32:35]
    ds_read_b64_tr_b16 v[128:129], v224 offset:64
    s_add_u32 s46, s46, 18432
    v_mfma_f32_16x16x32_bf16 v[36:39], v[160:163], v[136:139], v[36:39]
    ds_read_b64_tr_b16 v[130:131], v224 offset:640
    v_mfma_f32_16x16x32_bf16 v[40:43], v[160:163], v[140:143], v[40:43]
    buffer_load_dwordx4 v254, s[20:23], s45 offen sc1 lds
    s_add_u32 m0, s78, 19456
    v_mfma_f32_16x16x32_bf16 v[44:47], v[160:163], v[144:147], v[44:47]
    s_nop 0
    s_waitcnt lgkmcnt(5)
    v_mfma_f32_16x16x32_bf16 v[0:3], v[120:123], v[100:103], v[0:3]
    ds_read_b64_tr_b16 v[152:153], v224 offset:9472
    buffer_load_dwordx4 v244, s[16:19], s47 offen sc1 lds
    v_mfma_f32_16x16x32_bf16 v[4:7], v[120:123], v[104:107], v[4:7]
    ds_read_b64_tr_b16 v[154:155], v224 offset:10048
    v_mfma_f32_16x16x32_bf16 v[8:11], v[120:123], v[108:111], v[8:11]
    ds_read_b128 v[132:135], v223 offset:1024
    s_add_u32 m0, s79, 19456
    s_waitcnt lgkmcnt(3)
    v_mfma_f32_16x16x32_bf16 v[12:15], v[120:123], v[112:115], v[12:15]
    ds_read_b128 v[136:139], v223 offset:3072
    v_mfma_f32_16x16x32_bf16 v[16:19], v[124:127], v[100:103], v[16:19]
    ds_read_b128 v[140:143], v223 offset:5120
    s_add_u32 s47, s47, s48
    v_mfma_f32_16x16x32_bf16 v[20:23], v[124:127], v[104:107], v[20:23]
    ds_read_b128 v[144:147], v223 offset:7168
    v_mfma_f32_16x16x32_bf16 v[24:27], v[124:127], v[108:111], v[24:27]
    ds_read_b64_tr_b16 v[156:157], v224 offset:9504
    buffer_load_dwordx4 v245, s[12:15], s77 offen lds
    v_mfma_f32_16x16x32_bf16 v[28:31], v[124:127], v[112:115], v[28:31]
    ds_read_b64_tr_b16 v[158:159], v224 offset:10080
    v_mfma_f32_16x16x32_bf16 v[32:35], v[128:131], v[100:103], v[32:35]
    ds_read_b64_tr_b16 v[160:161], v224 offset:9536
    s_add_u32 m0, s80, 19456
    v_mfma_f32_16x16x32_bf16 v[36:39], v[128:131], v[104:107], v[36:39]
    ds_read_b64_tr_b16 v[162:163], v224 offset:10112
    v_mfma_f32_16x16x32_bf16 v[40:43], v[128:131], v[108:111], v[40:43]
    s_nop 0
    buffer_load_dwordx4 v246, s[12:15], s77 offen lds
    v_mfma_f32_16x16x32_bf16 v[44:47], v[128:131], v[112:115], v[44:47]
    s_add_u32 s77, s77, 73728
    s_waitcnt lgkmcnt(0)
    s_waitcnt vmcnt(10)
    s_barrier
    v_mfma_f32_16x16x32_bf16 v[0:3], v[152:155], v[132:135], v[0:3]
    ds_read_b64_tr_b16 v[120:121], v224 offset:19456
    buffer_load_dword v226, off, s[20:23], s98 sc1
    v_mfma_f32_16x16x32_bf16 v[4:7], v[152:155], v[136:139], v[4:7]
    ds_read_b64_tr_b16 v[122:123], v224 offset:20032
    v_mfma_f32_16x16x32_bf16 v[8:11], v[152:155], v[140:143], v[8:11]
    ds_read_b128 v[100:103], v223 offset:19456
    s_add_u32 m0, s43, 38912
    v_mfma_f32_16x16x32_bf16 v[12:15], v[152:155], v[144:147], v[12:15]
    ds_read_b128 v[104:107], v223 offset:21504
    v_mfma_f32_16x16x32_bf16 v[16:19], v[156:159], v[132:135], v[16:19]
    ds_read_b128 v[108:111], v223 offset:23552
    s_add_u32 s45, s46, 8192
    v_mfma_f32_16x16x32_bf16 v[20:23], v[156:159], v[136:139], v[20:23]
    ds_read_b128 v[112:115], v223 offset:25600
    v_mfma_f32_16x16x32_bf16 v[24:27], v[156:159], v[140:143], v[24:27]
    ds_read_b64_tr_b16 v[124:125], v224 offset:19488
    buffer_load_dwordx4 v254, s[20:23], s46 offen sc1 lds
    v_mfma_f32_16x16x32_bf16 v[28:31], v[156:159], v[144:147], v[28:31]
    ds_read_b64_tr_b16 v[126:127], v224 offset:20064
    s_add_u32 m0, m0, 8192
    v_mfma_f32_16x16x32_bf16 v[32:35], v[160:163], v[132:135], v[32:35]
    ds_read_b64_tr_b16 v[128:129], v224 offset:19520
    v_mfma_f32_16x16x32_bf16 v[36:39], v[160:163], v[136:139], v[36:39]
    ds_read_b64_tr_b16 v[130:131], v224 offset:20096
    s_add_u32 s46, s46, 18432
    v_mfma_f32_16x16x32_bf16 v[40:43], v[160:163], v[140:143], v[40:43]
    buffer_load_dwordx4 v254, s[20:23], s45 offen sc1 lds
    v_mfma_f32_16x16x32_bf16 v[44:47], v[160:163], v[144:147], v[44:47]
    s_add_u32 m0, s78, 38912
    s_nop 0
    s_waitcnt lgkmcnt(5)
    v_mfma_f32_16x16x32_bf16 v[0:3], v[120:123], v[100:103], v[0:3]
    ds_read_b64_tr_b16 v[152:153], v224 offset:28928
    buffer_load_dwordx4 v244, s[16:19], s47 offen sc1 lds
    v_mfma_f32_16x16x32_bf16 v[4:7], v[120:123], v[104:107], v[4:7]
    ds_read_b64_tr_b16 v[154:155], v224 offset:29504
    v_mfma_f32_16x16x32_bf16 v[8:11], v[120:123], v[108:111], v[8:11]
    ds_read_b128 v[132:135], v223 offset:20480
    s_add_u32 m0, s79, 38912
    s_waitcnt lgkmcnt(3)
    v_mfma_f32_16x16x32_bf16 v[12:15], v[120:123], v[112:115], v[12:15]
    ds_read_b128 v[136:139], v223 offset:22528
    v_mfma_f32_16x16x32_bf16 v[16:19], v[124:127], v[100:103], v[16:19]
    ds_read_b128 v[140:143], v223 offset:24576
    s_add_u32 s47, s47, s48
    v_mfma_f32_16x16x32_bf16 v[20:23], v[124:127], v[104:107], v[20:23]
    ds_read_b128 v[144:147], v223 offset:26624
    v_mfma_f32_16x16x32_bf16 v[24:27], v[124:127], v[108:111], v[24:27]
    ds_read_b64_tr_b16 v[156:157], v224 offset:28960
    buffer_load_dwordx4 v245, s[12:15], s77 offen lds
    v_mfma_f32_16x16x32_bf16 v[28:31], v[124:127], v[112:115], v[28:31]
    ds_read_b64_tr_b16 v[158:159], v224 offset:29536
    s_add_u32 m0, s80, 38912
    v_mfma_f32_16x16x32_bf16 v[32:35], v[128:131], v[100:103], v[32:35]
    ds_read_b64_tr_b16 v[160:161], v224 offset:28992
    v_mfma_f32_16x16x32_bf16 v[36:39], v[128:131], v[104:107], v[36:39]
    ds_read_b64_tr_b16 v[162:163], v224 offset:29568
    s_nop 0
    v_mfma_f32_16x16x32_bf16 v[40:43], v[128:131], v[108:111], v[40:43]
    buffer_load_dwordx4 v246, s[12:15], s77 offen lds
    v_mfma_f32_16x16x32_bf16 v[44:47], v[128:131], v[112:115], v[44:47]
    s_add_u32 s77, s77, 73728
    s_cmp_lt_u32 s42, 4
    s_waitcnt lgkmcnt(0)
    s_cbranch_scc1 op43_loop
    s_branch op43_done
op43_late:
op43_p1:
    buffer_load_dword v226, off, s[20:23], s98 sc1
    s_waitcnt vmcnt(0)
    v_readfirstlane_b32 s40, v226
    s_add_u32 s44, s42, s85
    s_and_b32 s44, s44, 3
    s_lshl_b32 s44, s44, 3
    s_bitcmp1_b32 s40, s44
    s_cbranch_scc1 op43_p1_ok
    s_sleep 4
    s_branch op43_p1
op43_p1_ok:
    s_branch op43_rdy
op43_done:
    v_mfma_f32_16x16x32_bf16 v[0:3], v[152:155], v[132:135], v[0:3]
    v_mfma_f32_16x16x32_bf16 v[4:7], v[152:155], v[136:139], v[4:7]
    v_mfma_f32_16x16x32_bf16 v[8:11], v[152:155], v[140:143], v[8:11]
    v_mfma_f32_16x16x32_bf16 v[12:15], v[152:155], v[144:147], v[12:15]
    v_mfma_f32_16x16x32_bf16 v[16:19], v[156:159], v[132:135], v[16:19]
    v_mfma_f32_16x16x32_bf16 v[20:23], v[156:159], v[136:139], v[20:23]
    v_mfma_f32_16x16x32_bf16 v[24:27], v[156:159], v[140:143], v[24:27]
    v_mfma_f32_16x16x32_bf16 v[28:31], v[156:159], v[144:147], v[28:31]
    v_mfma_f32_16x16x32_bf16 v[32:35], v[160:163], v[132:135], v[32:35]
    v_mfma_f32_16x16x32_bf16 v[36:39], v[160:163], v[136:139], v[36:39]
    v_mfma_f32_16x16x32_bf16 v[40:43], v[160:163], v[140:143], v[40:43]
    v_mfma_f32_16x16x32_bf16 v[44:47], v[160:163], v[144:147], v[44:47]
    s_cmp_eq_u32 s84, 0
    s_cbranch_scc1 op43_k0
    s_cmp_eq_u32 s84, 1
    s_cbranch_scc1 op43_k1
    s_cmp_eq_u32 s84, 2
    s_cbranch_scc1 op43_k2
op43_k3:
    s_nop 7
    s_add_u32 s44, s52, 98304
    v_cvt_pk_bf16_f32 v0, v0, v1
    v_cvt_pk_bf16_f32 v1, v2, v3
    v_cvt_pk_bf16_f32 v2, v16, v17
    v_cvt_pk_bf16_f32 v3, v18, v19
    buffer_store_dwordx4 v[0:3], v254, s[20:23], s44 offen offset:0 sc1
    v_cvt_pk_bf16_f32 v32, v32, v33
    v_cvt_pk_bf16_f32 v33, v34, v35
    buffer_store_dwordx4 v[32:35], v254, s[20:23], s44 offen offset:1024 sc1
    s_add_u32 s44, s52, 229376
    v_cvt_pk_bf16_f32 v4, v4, v5
    v_cvt_pk_bf16_f32 v5, v6, v7
    v_cvt_pk_bf16_f32 v6, v20, v21
    v_cvt_pk_bf16_f32 v7, v22, v23
    buffer_store_dwordx4 v[4:7], v254, s[20:23], s44 offen offset:0 sc1
    v_cvt_pk_bf16_f32 v36, v36, v37
    v_cvt_pk_bf16_f32 v37, v38, v39
    buffer_store_dwordx4 v[36:39], v254, s[20:23], s44 offen offset:1024 sc1
    s_add_u32 s44, s52, 360448
    v_cvt_pk_bf16_f32 v8, v8, v9
    v_cvt_pk_bf16_f32 v9, v10, v11
    v_cvt_pk_bf16_f32 v10, v24, v25
    v_cvt_pk_bf16_f32 v11, v26, v27
    buffer_store_dwordx4 v[8:11], v254, s[20:23], s44 offen offset:0 sc1
    v_cvt_pk_bf16_f32 v40, v40, v41
    v_cvt_pk_bf16_f32 v41, v42, v43
    buffer_store_dwordx4 v[40:43], v254, s[20:23], s44 offen offset:1024 sc1
    s_waitcnt vmcnt(0)
    s_barrier
    s_cmp_lg_u32 s30, 0
    s_cbranch_scc1 op43_nr3
    v_lshlrev_b32 v226, 8, v250
    v_mov_b32 v251, 1
    s_add_u32 s44, s54, -765
    s_mov_b64 exec, 15
    buffer_store_byte v251, v226, s[20:23], s44 offen sc1
    s_mov_b64 exec, -1
op43_nr3:
op43_q3:
    buffer_load_dword v226, off, s[20:23], s54 sc1
    s_waitcnt vmcnt(0)
    v_readfirstlane_b32 s40, v226
    s_nop 0
    s_cmp_eq_u32 s40, 0x01010101
    s_cbranch_scc1 op43_q3_ok
    s_sleep 4
    s_branch op43_q3
op43_q3_ok:
    s_add_u32 s94, s52, 393216
    s_add_u32 s95, s52, 425984
    s_add_u32 s96, s52, 458752
    buffer_load_dwordx4 v[100:103], v254, s[20:23], s94 offen offset:0 sc1
    buffer_load_dwordx4 v[104:107], v254, s[20:23], s95 offen offset:0 sc1
    buffer_load_dwordx4 v[108:111], v254, s[20:23], s96 offen offset:0 sc1
    buffer_load_dwordx4 v[112:115], v254, s[20:23], s94 offen offset:1024 sc1
    buffer_load_dwordx4 v[116:119], v254, s[20:23], s95 offen offset:1024 sc1
    buffer_load_dwordx4 v[120:123], v254, s[20:23], s96 offen offset:1024 sc1
    s_mov_b32 s99, 0xffff0000
    s_add_u32 s44, s53, 55296
    s_waitcnt vmcnt(3)
    v_lshlrev_b32 v251, 16, v100
    v_and_b32 v100, s99, v100
    v_lshlrev_b32 v252, 16, v101
    v_and_b32 v101, s99, v101
    v_add_f32 v12, v12, v251
    v_add_f32 v13, v13, v100
    v_add_f32 v14, v14, v252
    v_add_f32 v15, v15, v101
    v_lshlrev_b32 v251, 16, v104
    v_and_b32 v104, s99, v104
    v_lshlrev_b32 v252, 16, v105
    v_and_b32 v105, s99, v105
    v_add_f32 v12, v12, v251
    v_add_f32 v13, v13, v104
    v_add_f32 v14, v14, v252
    v_add_f32 v15, v15, v105
    v_lshlrev_b32 v251, 16, v108
    v_and_b32 v108, s99, v108
    v_lshlrev_b32 v252, 16, v109
    v_and_b32 v109, s99, v109
    v_add_f32 v12, v12, v251
    v_add_f32 v13, v13, v108
    v_add_f32 v14, v14, v252
    v_add_f32 v15, v15, v109
    v_cvt_pk_bf16_f32 v12, v12, v13
    v_cvt_pk_bf16_f32 v13, v14, v15
    buffer_store_dwordx2 v[12:13], v225, s[8:11], s44 offen
    s_add_u32 s44, s53, 55328
    v_lshlrev_b32 v251, 16, v102
    v_and_b32 v102, s99, v102
    v_lshlrev_b32 v252, 16, v103
    v_and_b32 v103, s99, v103
    v_add_f32 v28, v28, v251
    v_add_f32 v29, v29, v102
    v_add_f32 v30, v30, v252
    v_add_f32 v31, v31, v103
    v_lshlrev_b32 v251, 16, v106
    v_and_b32 v106, s99, v106
    v_lshlrev_b32 v252, 16, v107
    v_and_b32 v107, s99, v107
    v_add_f32 v28, v28, v251
    v_add_f32 v29, v29, v106
    v_add_f32 v30, v30, v252
    v_add_f32 v31, v31, v107
    v_lshlrev_b32 v251, 16, v110
    v_and_b32 v110, s99, v110
    v_lshlrev_b32 v252, 16, v111
    v_and_b32 v111, s99, v111
    v_add_f32 v28, v28, v251
    v_add_f32 v29, v29, v110
    v_add_f32 v30, v30, v252
    v_add_f32 v31, v31, v111
    v_cvt_pk_bf16_f32 v28, v28, v29
    v_cvt_pk_bf16_f32 v29, v30, v31
    buffer_store_dwordx2 v[28:29], v225, s[8:11], s44 offen
    s_add_u32 s44, s53, 55360
    s_waitcnt vmcnt(2)
    v_lshlrev_b32 v251, 16, v112
    v_and_b32 v112, s99, v112
    v_lshlrev_b32 v252, 16, v113
    v_and_b32 v113, s99, v113
    v_add_f32 v44, v44, v251
    v_add_f32 v45, v45, v112
    v_add_f32 v46, v46, v252
    v_add_f32 v47, v47, v113
    v_lshlrev_b32 v251, 16, v116
    v_and_b32 v116, s99, v116
    v_lshlrev_b32 v252, 16, v117
    v_and_b32 v117, s99, v117
    v_add_f32 v44, v44, v251
    v_add_f32 v45, v45, v116
    v_add_f32 v46, v46, v252
    v_add_f32 v47, v47, v117
    v_lshlrev_b32 v251, 16, v120
    v_and_b32 v120, s99, v120
    v_lshlrev_b32 v252, 16, v121
    v_and_b32 v121, s99, v121
    v_add_f32 v44, v44, v251
    v_add_f32 v45, v45, v120
    v_add_f32 v46, v46, v252
    v_add_f32 v47, v47, v121
    v_cvt_pk_bf16_f32 v44, v44, v45
    v_cvt_pk_bf16_f32 v45, v46, v47
    buffer_store_dwordx2 v[44:45], v225, s[8:11], s44 offen
    s_branch attn_fin
op43_k0:
    s_nop 7
    s_add_u32 s44, s52, 131072
    v_cvt_pk_bf16_f32 v4, v4, v5
    v_cvt_pk_bf16_f32 v5, v6, v7
    v_cvt_pk_bf16_f32 v6, v20, v21
    v_cvt_pk_bf16_f32 v7, v22, v23
    buffer_store_dwordx4 v[4:7], v254, s[20:23], s44 offen offset:0 sc1
    v_cvt_pk_bf16_f32 v36, v36, v37
    v_cvt_pk_bf16_f32 v37, v38, v39
    buffer_store_dwordx4 v[36:39], v254, s[20:23], s44 offen offset:1024 sc1
    s_add_u32 s44, s52, 262144
    v_cvt_pk_bf16_f32 v8, v8, v9
    v_cvt_pk_bf16_f32 v9, v10, v11
    v_cvt_pk_bf16_f32 v10, v24, v25
    v_cvt_pk_bf16_f32 v11, v26, v27
    buffer_store_dwordx4 v[8:11], v254, s[20:23], s44 offen offset:0 sc1
    v_cvt_pk_bf16_f32 v40, v40, v41
    v_cvt_pk_bf16_f32 v41, v42, v43
    buffer_store_dwordx4 v[40:43], v254, s[20:23], s44 offen offset:1024 sc1
    s_add_u32 s44, s52, 393216
    v_cvt_pk_bf16_f32 v12, v12, v13
    v_cvt_pk_bf16_f32 v13, v14, v15
    v_cvt_pk_bf16_f32 v14, v28, v29
    v_cvt_pk_bf16_f32 v15, v30, v31
    buffer_store_dwordx4 v[12:15], v254, s[20:23], s44 offen offset:0 sc1
    v_cvt_pk_bf16_f32 v44, v44, v45
    v_cvt_pk_bf16_f32 v45, v46, v47
    buffer_store_dwordx4 v[44:47], v254, s[20:23], s44 offen offset:1024 sc1
    s_waitcnt vmcnt(0)
    s_barrier
    s_cmp_lg_u32 s30, 0
    s_cbranch_scc1 op43_nr0
    v_lshlrev_b32 v226, 8, v250
    v_mov_b32 v251, 1
    s_add_u32 s44, s54, 0
    s_mov_b64 exec, 15
    buffer_store_byte v251, v226, s[20:23], s44 offen sc1
    s_mov_b64 exec, -1
op43_nr0:
op43_q0:
    buffer_load_dword v226, off, s[20:23], s54 sc1
    s_waitcnt vmcnt(0)
    v_readfirstlane_b32 s40, v226
    s_nop 0
    s_cmp_eq_u32 s40, 0x01010101
    s_cbranch_scc1 op43_q0_ok
    s_sleep 4
    s_branch op43_q0
op43_q0_ok:
    s_add_u32 s94, s52, 32768
    s_add_u32 s95, s52, 65536
    s_add_u32 s96, s52, 98304
    buffer_load_dwordx4 v[100:103], v254, s[20:23], s94 offen offset:0 sc1
    buffer_load_dwordx4 v[104:107], v254, s[20:23], s95 offen offset:0 sc1
    buffer_load_dwordx4 v[108:111], v254, s[20:23], s96 offen offset:0 sc1
    buffer_load_dwordx4 v[112:115], v254, s[20:23], s94 offen offset:1024 sc1
    buffer_load_dwordx4 v[116:119], v254, s[20:23], s95 offen offset:1024 sc1
    buffer_load_dwordx4 v[120:123], v254, s[20:23], s96 offen offset:1024 sc1
    s_mov_b32 s99, 0xffff0000
    s_add_u32 s44, s53, 0
    s_waitcnt vmcnt(3)
    v_lshlrev_b32 v251, 16, v100
    v_and_b32 v100, s99, v100
    v_lshlrev_b32 v252, 16, v101
    v_and_b32 v101, s99, v101
    v_add_f32 v0, v0, v251
    v_add_f32 v1, v1, v100
    v_add_f32 v2, v2, v252
    v_add_f32 v3, v3, v101
    v_lshlrev_b32 v251, 16, v104
    v_and_b32 v104, s99, v104
    v_lshlrev_b32 v252, 16, v105
    v_and_b32 v105, s99, v105
    v_add_f32 v0, v0, v251
    v_add_f32 v1, v1, v104
    v_add_f32 v2, v2, v252
    v_add_f32 v3, v3, v105
    v_lshlrev_b32 v251, 16, v108
    v_and_b32 v108, s99, v108
    v_lshlrev_b32 v252, 16, v109
    v_and_b32 v109, s99, v109
    v_add_f32 v0, v0, v251
    v_add_f32 v1, v1, v108
    v_add_f32 v2, v2, v252
    v_add_f32 v3, v3, v109
    v_cvt_pk_bf16_f32 v0, v0, v1
    v_cvt_pk_bf16_f32 v1, v2, v3
    buffer_store_dwordx2 v[0:1], v225, s[8:11], s44 offen
    s_add_u32 s44, s53, 32
    v_lshlrev_b32 v251, 16, v102
    v_and_b32 v102, s99, v102
    v_lshlrev_b32 v252, 16, v103
    v_and_b32 v103, s99, v103
    v_add_f32 v16, v16, v251
    v_add_f32 v17, v17, v102
    v_add_f32 v18, v18, v252
    v_add_f32 v19, v19, v103
    v_lshlrev_b32 v251, 16, v106
    v_and_b32 v106, s99, v106
    v_lshlrev_b32 v252, 16, v107
    v_and_b32 v107, s99, v107
    v_add_f32 v16, v16, v251
    v_add_f32 v17, v17, v106
    v_add_f32 v18, v18, v252
    v_add_f32 v19, v19, v107
    v_lshlrev_b32 v251, 16, v110
    v_and_b32 v110, s99, v110
    v_lshlrev_b32 v252, 16, v111
    v_and_b32 v111, s99, v111
    v_add_f32 v16, v16, v251
    v_add_f32 v17, v17, v110
    v_add_f32 v18, v18, v252
    v_add_f32 v19, v19, v111
    v_cvt_pk_bf16_f32 v16, v16, v17
    v_cvt_pk_bf16_f32 v17, v18, v19
    buffer_store_dwordx2 v[16:17], v225, s[8:11], s44 offen
    s_add_u32 s44, s53, 64
    s_waitcnt vmcnt(2)
    v_lshlrev_b32 v251, 16, v112
    v_and_b32 v112, s99, v112
    v_lshlrev_b32 v252, 16, v113
    v_and_b32 v113, s99, v113
    v_add_f32 v32, v32, v251
    v_add_f32 v33, v33, v112
    v_add_f32 v34, v34, v252
    v_add_f32 v35, v35, v113
    v_lshlrev_b32 v251, 16, v116
    v_and_b32 v116, s99, v116
    v_lshlrev_b32 v252, 16, v117
    v_and_b32 v117, s99, v117
    v_add_f32 v32, v32, v251
    v_add_f32 v33, v33, v116
    v_add_f32 v34, v34, v252
    v_add_f32 v35, v35, v117
    v_lshlrev_b32 v251, 16, v120
    v_and_b32 v120, s99, v120
    v_lshlrev_b32 v252, 16, v121
    v_and_b32 v121, s99, v121
    v_add_f32 v32, v32, v251
    v_add_f32 v33, v33, v120
    v_add_f32 v34, v34, v252
    v_add_f32 v35, v35, v121
    v_cvt_pk_bf16_f32 v32, v32, v33
    v_cvt_pk_bf16_f32 v33, v34, v35
    buffer_store_dwordx2 v[32:33], v225, s[8:11], s44 offen
    s_branch attn_fin
op43_k1:
    s_nop 7
    s_add_u32 s44, s52, 32768
    v_cvt_pk_bf16_f32 v0, v0, v1
    v_cvt_pk_bf16_f32 v1, v2, v3
    v_cvt_pk_bf16_f32 v2, v16, v17
    v_cvt_pk_bf16_f32 v3, v18, v19
    buffer_store_dwordx4 v[0:3], v254, s[20:23], s44 offen offset:0 sc1
    v_cvt_pk_bf16_f32 v32, v32, v33
    v_cvt_pk_bf16_f32 v33, v34, v35
    buffer_store_dwordx4 v[32:35], v254, s[20:23], s44 offen offset:1024 sc1
    s_add_u32 s44, s52, 294912
    v_cvt_pk_bf16_f32 v8, v8, v9
    v_cvt_pk_bf16_f32 v9, v10, v11
    v_cvt_pk_bf16_f32 v10, v24, v25
    v_cvt_pk_bf16_f32 v11, v26, v27
    buffer_store_dwordx4 v[8:11], v254, s[20:23], s44 offen offset:0 sc1
    v_cvt_pk_bf16_f32 v40, v40, v41
    v_cvt_pk_bf16_f32 v41, v42, v43
    buffer_store_dwordx4 v[40:43], v254, s[20:23], s44 offen offset:1024 sc1
    s_add_u32 s44, s52, 425984
    v_cvt_pk_bf16_f32 v12, v12, v13
    v_cvt_pk_bf16_f32 v13, v14, v15
    v_cvt_pk_bf16_f32 v14, v28, v29
    v_cvt_pk_bf16_f32 v15, v30, v31
    buffer_store_dwordx4 v[12:15], v254, s[20:23], s44 offen offset:0 sc1
    v_cvt_pk_bf16_f32 v44, v44, v45
    v_cvt_pk_bf16_f32 v45, v46, v47
    buffer_store_dwordx4 v[44:47], v254, s[20:23], s44 offen offset:1024 sc1
    s_waitcnt vmcnt(0)
    s_barrier
    s_cmp_lg_u32 s30, 0
    s_cbranch_scc1 op43_nr1
    v_lshlrev_b32 v226, 8, v250
    v_mov_b32 v251, 1
    s_add_u32 s44, s54, -255
    s_mov_b64 exec, 15
    buffer_store_byte v251, v226, s[20:23], s44 offen sc1
    s_mov_b64 exec, -1
op43_nr1:
op43_q1:
    buffer_load_dword v226, off, s[20:23], s54 sc1
    s_waitcnt vmcnt(0)
    v_readfirstlane_b32 s40, v226
    s_nop 0
    s_cmp_eq_u32 s40, 0x01010101
    s_cbranch_scc1 op43_q1_ok
    s_sleep 4
    s_branch op43_q1
op43_q1_ok:
    s_add_u32 s94, s52, 131072
    s_add_u32 s95, s52, 196608
    s_add_u32 s96, s52, 229376
    buffer_load_dwordx4 v[100:103], v254, s[20:23], s94 offen offset:0 sc1
    buffer_load_dwordx4 v[104:107], v254, s[20:23], s95 offen offset:0 sc1
    buffer_load_dwordx4 v[108:111], v254, s[20:23], s96 offen offset:0 sc1
    buffer_load_dwordx4 v[112:115], v254, s[20:23], s94 offen offset:1024 sc1
    buffer_load_dwordx4 v[116:119], v254, s[20:23], s95 offen offset:1024 sc1
    buffer_load_dwordx4 v[120:123], v254, s[20:23], s96 offen offset:1024 sc1
    s_mov_b32 s99, 0xffff0000
    s_add_u32 s44, s53, 18432
    s_waitcnt vmcnt(3)
    v_lshlrev_b32 v251, 16, v100
    v_and_b32 v100, s99, v100
    v_lshlrev_b32 v252, 16, v101
    v_and_b32 v101, s99, v101
    v_add_f32 v4, v4, v251
    v_add_f32 v5, v5, v100
    v_add_f32 v6, v6, v252
    v_add_f32 v7, v7, v101
    v_lshlrev_b32 v251, 16, v104
    v_and_b32 v104, s99, v104
    v_lshlrev_b32 v252, 16, v105
    v_and_b32 v105, s99, v105
    v_add_f32 v4, v4, v251
    v_add_f32 v5, v5, v104
    v_add_f32 v6, v6, v252
    v_add_f32 v7, v7, v105
    v_lshlrev_b32 v251, 16, v108
    v_and_b32 v108, s99, v108
    v_lshlrev_b32 v252, 16, v109
    v_and_b32 v109, s99, v109
    v_add_f32 v4, v4, v251
    v_add_f32 v5, v5, v108
    v_add_f32 v6, v6, v252
    v_add_f32 v7, v7, v109
    v_cvt_pk_bf16_f32 v4, v4, v5
    v_cvt_pk_bf16_f32 v5, v6, v7
    buffer_store_dwordx2 v[4:5], v225, s[8:11], s44 offen
    s_add_u32 s44, s53, 18464
    v_lshlrev_b32 v251, 16, v102
    v_and_b32 v102, s99, v102
    v_lshlrev_b32 v252, 16, v103
    v_and_b32 v103, s99, v103
    v_add_f32 v20, v20, v251
    v_add_f32 v21, v21, v102
    v_add_f32 v22, v22, v252
    v_add_f32 v23, v23, v103
    v_lshlrev_b32 v251, 16, v106
    v_and_b32 v106, s99, v106
    v_lshlrev_b32 v252, 16, v107
    v_and_b32 v107, s99, v107
    v_add_f32 v20, v20, v251
    v_add_f32 v21, v21, v106
    v_add_f32 v22, v22, v252
    v_add_f32 v23, v23, v107
    v_lshlrev_b32 v251, 16, v110
    v_and_b32 v110, s99, v110
    v_lshlrev_b32 v252, 16, v111
    v_and_b32 v111, s99, v111
    v_add_f32 v20, v20, v251
    v_add_f32 v21, v21, v110
    v_add_f32 v22, v22, v252
    v_add_f32 v23, v23, v111
    v_cvt_pk_bf16_f32 v20, v20, v21
    v_cvt_pk_bf16_f32 v21, v22, v23
    buffer_store_dwordx2 v[20:21], v225, s[8:11], s44 offen
    s_add_u32 s44, s53, 18496
    s_waitcnt vmcnt(2)
    v_lshlrev_b32 v251, 16, v112
    v_and_b32 v112, s99, v112
    v_lshlrev_b32 v252, 16, v113
    v_and_b32 v113, s99, v113
    v_add_f32 v36, v36, v251
    v_add_f32 v37, v37, v112
    v_add_f32 v38, v38, v252
    v_add_f32 v39, v39, v113
    v_lshlrev_b32 v251, 16, v116
    v_and_b32 v116, s99, v116
    v_lshlrev_b32 v252, 16, v117
    v_and_b32 v117, s99, v117
    v_add_f32 v36, v36, v251
    v_add_f32 v37, v37, v116
    v_add_f32 v38, v38, v252
    v_add_f32 v39, v39, v117
    v_lshlrev_b32 v251, 16, v120
    v_and_b32 v120, s99, v120
    v_lshlrev_b32 v252, 16, v121
    v_and_b32 v121, s99, v121
    v_add_f32 v36, v36, v251
    v_add_f32 v37, v37, v120
    v_add_f32 v38, v38, v252
    v_add_f32 v39, v39, v121
    v_cvt_pk_bf16_f32 v36, v36, v37
    v_cvt_pk_bf16_f32 v37, v38, v39
    buffer_store_dwordx2 v[36:37], v225, s[8:11], s44 offen
    s_branch attn_fin
op43_k2:
    s_nop 7
    s_add_u32 s44, s52, 65536
    v_cvt_pk_bf16_f32 v0, v0, v1
    v_cvt_pk_bf16_f32 v1, v2, v3
    v_cvt_pk_bf16_f32 v2, v16, v17
    v_cvt_pk_bf16_f32 v3, v18, v19
    buffer_store_dwordx4 v[0:3], v254, s[20:23], s44 offen offset:0 sc1
    v_cvt_pk_bf16_f32 v32, v32, v33
    v_cvt_pk_bf16_f32 v33, v34, v35
    buffer_store_dwordx4 v[32:35], v254, s[20:23], s44 offen offset:1024 sc1
    s_add_u32 s44, s52, 196608
    v_cvt_pk_bf16_f32 v4, v4, v5
    v_cvt_pk_bf16_f32 v5, v6, v7
    v_cvt_pk_bf16_f32 v6, v20, v21
    v_cvt_pk_bf16_f32 v7, v22, v23
    buffer_store_dwordx4 v[4:7], v254, s[20:23], s44 offen offset:0 sc1
    v_cvt_pk_bf16_f32 v36, v36, v37
    v_cvt_pk_bf16_f32 v37, v38, v39
    buffer_store_dwordx4 v[36:39], v254, s[20:23], s44 offen offset:1024 sc1
    s_add_u32 s44, s52, 458752
    v_cvt_pk_bf16_f32 v12, v12, v13
    v_cvt_pk_bf16_f32 v13, v14, v15
    v_cvt_pk_bf16_f32 v14, v28, v29
    v_cvt_pk_bf16_f32 v15, v30, v31
    buffer_store_dwordx4 v[12:15], v254, s[20:23], s44 offen offset:0 sc1
    v_cvt_pk_bf16_f32 v44, v44, v45
    v_cvt_pk_bf16_f32 v45, v46, v47
    buffer_store_dwordx4 v[44:47], v254, s[20:23], s44 offen offset:1024 sc1
    s_waitcnt vmcnt(0)
    s_barrier
    s_cmp_lg_u32 s30, 0
    s_cbranch_scc1 op43_nr2
    v_lshlrev_b32 v226, 8, v250
    v_mov_b32 v251, 1
    s_add_u32 s44, s54, -510
    s_mov_b64 exec, 15
    buffer_store_byte v251, v226, s[20:23], s44 offen sc1
    s_mov_b64 exec, -1
op43_nr2:
op43_q2:
    buffer_load_dword v226, off, s[20:23], s54 sc1
    s_waitcnt vmcnt(0)
    v_readfirstlane_b32 s40, v226
    s_nop 0
    s_cmp_eq_u32 s40, 0x01010101
    s_cbranch_scc1 op43_q2_ok
    s_sleep 4
    s_branch op43_q2
op43_q2_ok:
    s_add_u32 s94, s52, 262144
    s_add_u32 s95, s52, 294912
    s_add_u32 s96, s52, 360448
    buffer_load_dwordx4 v[100:103], v254, s[20:23], s94 offen offset:0 sc1
    buffer_load_dwordx4 v[104:107], v254, s[20:23], s95 offen offset:0 sc1
    buffer_load_dwordx4 v[108:111], v254, s[20:23], s96 offen offset:0 sc1
    buffer_load_dwordx4 v[112:115], v254, s[20:23], s94 offen offset:1024 sc1
    buffer_load_dwordx4 v[116:119], v254, s[20:23], s95 offen offset:1024 sc1
    buffer_load_dwordx4 v[120:123], v254, s[20:23], s96 offen offset:1024 sc1
    s_mov_b32 s99, 0xffff0000
    s_add_u32 s44, s53, 36864
    s_waitcnt vmcnt(3)
    v_lshlrev_b32 v251, 16, v100
    v_and_b32 v100, s99, v100
    v_lshlrev_b32 v252, 16, v101
    v_and_b32 v101, s99, v101
    v_add_f32 v8, v8, v251
    v_add_f32 v9, v9, v100
    v_add_f32 v10, v10, v252
    v_add_f32 v11, v11, v101
    v_lshlrev_b32 v251, 16, v104
    v_and_b32 v104, s99, v104
    v_lshlrev_b32 v252, 16, v105
    v_and_b32 v105, s99, v105
    v_add_f32 v8, v8, v251
    v_add_f32 v9, v9, v104
    v_add_f32 v10, v10, v252
    v_add_f32 v11, v11, v105
    v_lshlrev_b32 v251, 16, v108
    v_and_b32 v108, s99, v108
    v_lshlrev_b32 v252, 16, v109
    v_and_b32 v109, s99, v109
    v_add_f32 v8, v8, v251
    v_add_f32 v9, v9, v108
    v_add_f32 v10, v10, v252
    v_add_f32 v11, v11, v109
    v_cvt_pk_bf16_f32 v8, v8, v9
    v_cvt_pk_bf16_f32 v9, v10, v11
    buffer_store_dwordx2 v[8:9], v225, s[8:11], s44 offen
    s_add_u32 s44, s53, 36896
    v_lshlrev_b32 v251, 16, v102
    v_and_b32 v102, s99, v102
    v_lshlrev_b32 v252, 16, v103
    v_and_b32 v103, s99, v103
    v_add_f32 v24, v24, v251
    v_add_f32 v25, v25, v102
    v_add_f32 v26, v26, v252
    v_add_f32 v27, v27, v103
    v_lshlrev_b32 v251, 16, v106
    v_and_b32 v106, s99, v106
    v_lshlrev_b32 v252, 16, v107
    v_and_b32 v107, s99, v107
    v_add_f32 v24, v24, v251
    v_add_f32 v25, v25, v106
    v_add_f32 v26, v26, v252
    v_add_f32 v27, v27, v107
    v_lshlrev_b32 v251, 16, v110
    v_and_b32 v110, s99, v110
    v_lshlrev_b32 v252, 16, v111
    v_and_b32 v111, s99, v111
    v_add_f32 v24, v24, v251
    v_add_f32 v25, v25, v110
    v_add_f32 v26, v26, v252
    v_add_f32 v27, v27, v111
    v_cvt_pk_bf16_f32 v24, v24, v25
    v_cvt_pk_bf16_f32 v25, v26, v27
    buffer_store_dwordx2 v[24:25], v225, s[8:11], s44 offen
    s_add_u32 s44, s53, 36928
    s_waitcnt vmcnt(2)
    v_lshlrev_b32 v251, 16, v112
    v_and_b32 v112, s99, v112
    v_lshlrev_b32 v252, 16, v113
    v_and_b32 v113, s99, v113
    v_add_f32 v40, v40, v251
    v_add_f32 v41, v41, v112
    v_add_f32 v42, v42, v252
    v_add_f32 v43, v43, v113
    v_lshlrev_b32 v251, 16, v116
    v_and_b32 v116, s99, v116
    v_lshlrev_b32 v252, 16, v117
    v_and_b32 v117, s99, v117
    v_add_f32 v40, v40, v251
    v_add_f32 v41, v41, v116
    v_add_f32 v42, v42, v252
    v_add_f32 v43, v43, v117
    v_lshlrev_b32 v251, 16, v120
    v_and_b32 v120, s99, v120
    v_lshlrev_b32 v252, 16, v121
    v_and_b32 v121, s99, v121
    v_add_f32 v40, v40, v251
    v_add_f32 v41, v41, v120
    v_add_f32 v42, v42, v252
    v_add_f32 v43, v43, v121
    v_cvt_pk_bf16_f32 v40, v40, v41
    v_cvt_pk_bf16_f32 v41, v42, v43
    buffer_store_dwordx2 v[40:41], v225, s[8:11], s44 offen
    s_branch attn_fin
op52:
    v_mov_b64 v[0:1], 0
    v_mov_b64 v[2:3], 0
    v_mov_b64 v[4:5], 0
    v_mov_b64 v[6:7], 0
    v_mov_b64 v[8:9], 0
    v_mov_b64 v[10:11], 0
    v_mov_b64 v[12:13], 0
    v_mov_b64 v[14:15], 0
    v_mov_b64 v[16:17], 0
    v_mov_b64 v[18:19], 0
    v_mov_b64 v[20:21], 0
    v_mov_b64 v[22:23], 0
    v_mov_b64 v[24:25], 0
    v_mov_b64 v[26:27], 0
    v_mov_b64 v[28:29], 0
    v_mov_b64 v[30:31], 0
    v_mov_b64 v[32:33], 0
    v_mov_b64 v[34:35], 0
    v_mov_b64 v[36:37], 0
    v_mov_b64 v[38:39], 0
    v_mov_b64 v[132:133], 0
    v_mov_b64 v[134:135], 0
    v_mov_b64 v[136:137], 0
    v_mov_b64 v[138:139], 0
    v_mov_b64 v[140:141], 0
    v_mov_b64 v[142:143], 0
    v_mov_b64 v[144:145], 0
    v_mov_b64 v[146:147], 0
    v_mov_b64 v[148:149], 0
    v_mov_b64 v[150:151], 0
    v_mov_b64 v[152:153], 0
    v_mov_b64 v[154:155], 0
    v_mov_b64 v[156:157], 0
    v_mov_b64 v[158:159], 0
    v_mov_b64 v[160:161], 0
    v_mov_b64 v[162:163], 0
    s_waitcnt vmcnt(0)
    s_barrier
    s_cmp_lg_u32 s30, 0
    s_cbranch_scc1 op52_g0_nf
    s_add_u32 s44, s85, s98
    v_mov_b32 v251, 1
    s_mov_b64 exec, 1
    buffer_store_byte v251, off, s[20:23], s44 sc1
    s_mov_b64 exec, -1
op52_g0_nf:
    s_cmp_lg_u32 s41, 0
    s_cbranch_scc1 op52_g0_nl
    buffer_load_dword v226, off, s[20:23], s98 sc1
op52_g0_nl:
    v_mfma_f32_16x16x32_bf16 v[0:3], v[152:155], v[132:135], v[0:3]
    ds_read_b64_tr_b16 v[120:121], v222 offset:0
    v_mfma_f32_16x16x32_bf16 v[4:7], v[152:155], v[136:139], v[4:7]
    ds_read_b64_tr_b16 v[122:123], v222 offset:576
    v_mfma_f32_16x16x32_bf16 v[8:11], v[152:155], v[140:143], v[8:11]
    ds_read_b128 v[100:103], v221 offset:0
    v_mfma_f32_16x16x32_bf16 v[12:15], v[152:155], v[144:147], v[12:15]
    ds_read_b128 v[104:107], v221 offset:2048
    v_mfma_f32_16x16x32_bf16 v[16:19], v[152:155], v[148:151], v[16:19]
    ds_read_b128 v[108:111], v221 offset:4096
    ds_read_b128 v[112:115], v221 offset:6144
    v_mfma_f32_16x16x32_bf16 v[20:23], v[156:159], v[132:135], v[20:23]
    ds_read_b128 v[116:119], v221 offset:8192
    v_mfma_f32_16x16x32_bf16 v[24:27], v[156:159], v[136:139], v[24:27]
    ds_read_b64_tr_b16 v[124:125], v222 offset:32
    v_mfma_f32_16x16x32_bf16 v[28:31], v[156:159], v[140:143], v[28:31]
    ds_read_b64_tr_b16 v[126:127], v222 offset:608
    v_mfma_f32_16x16x32_bf16 v[32:35], v[156:159], v[144:147], v[32:35]
    v_mfma_f32_16x16x32_bf16 v[36:39], v[156:159], v[148:151], v[36:39]
    s_waitcnt lgkmcnt(4)
    v_mfma_f32_16x16x32_bf16 v[0:3], v[120:123], v[100:103], v[0:3]
    ds_read_b64_tr_b16 v[152:153], v222 offset:9472
    v_mfma_f32_16x16x32_bf16 v[4:7], v[120:123], v[104:107], v[4:7]
    ds_read_b64_tr_b16 v[154:155], v222 offset:10048
    v_mfma_f32_16x16x32_bf16 v[8:11], v[120:123], v[108:111], v[8:11]
    ds_read_b128 v[132:135], v221 offset:1024
    s_waitcnt lgkmcnt(3)
    v_mfma_f32_16x16x32_bf16 v[12:15], v[120:123], v[112:115], v[12:15]
    ds_read_b128 v[136:139], v221 offset:3072
    v_mfma_f32_16x16x32_bf16 v[16:19], v[120:123], v[116:119], v[16:19]
    ds_read_b128 v[140:143], v221 offset:5120
    ds_read_b128 v[144:147], v221 offset:7168
    v_mfma_f32_16x16x32_bf16 v[20:23], v[124:127], v[100:103], v[20:23]
    ds_read_b128 v[148:151], v221 offset:9216
    v_mfma_f32_16x16x32_bf16 v[24:27], v[124:127], v[104:107], v[24:27]
    ds_read_b64_tr_b16 v[156:157], v222 offset:9504
    v_mfma_f32_16x16x32_bf16 v[28:31], v[124:127], v[108:111], v[28:31]
    ds_read_b64_tr_b16 v[158:159], v222 offset:10080
    v_mfma_f32_16x16x32_bf16 v[32:35], v[124:127], v[112:115], v[32:35]
    v_mfma_f32_16x16x32_bf16 v[36:39], v[124:127], v[116:119], v[36:39]
    s_waitcnt lgkmcnt(0)
    s_cmp_lg_u32 s41, 0
    s_cbranch_scc1 op52_g1_nw
    s_waitcnt vmcnt(0)
    v_readfirstlane_b32 s40, v226
op52_g1_nw:
    s_barrier
    s_add_u32 s44, s42, s85
    s_and_b32 s44, s44, 3
    s_lshl_b32 s44, s44, 3
    s_bitcmp1_b32 s40, s44
    s_cbranch_scc0 op52_g1_ie
op52_g1_il:
    s_mul_i32 s99, s41, 19456
    s_add_u32 m0, s43, s99
    s_add_u32 s45, s46, 8192
    buffer_load_dwordx4 v254, s[20:23], s46 offen sc1 lds
    s_add_u32 m0, m0, 8192
    s_add_u32 s46, s46, 18432
    buffer_load_dwordx4 v254, s[20:23], s45 offen sc1 lds
    s_add_u32 m0, s78, s99
    s_nop 0
    buffer_load_dwordx4 v244, s[16:19], s47 offen sc1 lds
    s_add_u32 m0, s79, s99
    s_add_u32 s47, s47, s48
    buffer_load_dwordx4 v245, s[12:15], s77 offen lds
    s_add_u32 m0, s80, s99
    s_nop 0
    buffer_load_dwordx4 v246, s[12:15], s77 offen lds
    s_add_u32 s77, s77, 73728
    s_add_u32 s41, s41, 1
    s_cmp_lt_u32 s41, 1
    s_cbranch_scc1 op52_g1_il
op52_g1_ie:
    s_cmp_lg_u32 s41, 0
    s_cbranch_scc1 op52_g1_nl
    buffer_load_dword v226, off, s[20:23], s98 sc1
op52_g1_nl:
    v_mfma_f32_16x16x32_bf16 v[0:3], v[152:155], v[132:135], v[0:3]
    ds_read_b64_tr_b16 v[120:121], v222 offset:19456
    v_mfma_f32_16x16x32_bf16 v[4:7], v[152:155], v[136:139], v[4:7]
    ds_read_b64_tr_b16 v[122:123], v222 offset:20032
    v_mfma_f32_16x16x32_bf16 v[8:11], v[152:155], v[140:143], v[8:11]
    ds_read_b128 v[100:103], v221 offset:19456
    v_mfma_f32_16x16x32_bf16 v[12:15], v[152:155], v[144:147], v[12:15]
    ds_read_b128 v[104:107], v221 offset:21504
    v_mfma_f32_16x16x32_bf16 v[16:19], v[152:155], v[148:151], v[16:19]
    ds_read_b128 v[108:111], v221 offset:23552
    ds_read_b128 v[112:115], v221 offset:25600
    v_mfma_f32_16x16x32_bf16 v[20:23], v[156:159], v[132:135], v[20:23]
    ds_read_b128 v[116:119], v221 offset:27648
    v_mfma_f32_16x16x32_bf16 v[24:27], v[156:159], v[136:139], v[24:27]
    ds_read_b64_tr_b16 v[124:125], v222 offset:19488
    v_mfma_f32_16x16x32_bf16 v[28:31], v[156:159], v[140:143], v[28:31]
    ds_read_b64_tr_b16 v[126:127], v222 offset:20064
    v_mfma_f32_16x16x32_bf16 v[32:35], v[156:159], v[144:147], v[32:35]
    v_mfma_f32_16x16x32_bf16 v[36:39], v[156:159], v[148:151], v[36:39]
    s_waitcnt lgkmcnt(4)
    v_mfma_f32_16x16x32_bf16 v[0:3], v[120:123], v[100:103], v[0:3]
    ds_read_b64_tr_b16 v[152:153], v222 offset:28928
    v_mfma_f32_16x16x32_bf16 v[4:7], v[120:123], v[104:107], v[4:7]
    ds_read_b64_tr_b16 v[154:155], v222 offset:29504
    v_mfma_f32_16x16x32_bf16 v[8:11], v[120:123], v[108:111], v[8:11]
    ds_read_b128 v[132:135], v221 offset:20480
    s_waitcnt lgkmcnt(3)
    v_mfma_f32_16x16x32_bf16 v[12:15], v[120:123], v[112:115], v[12:15]
    ds_read_b128 v[136:139], v221 offset:22528
    v_mfma_f32_16x16x32_bf16 v[16:19], v[120:123], v[116:119], v[16:19]
    ds_read_b128 v[140:143], v221 offset:24576
    ds_read_b128 v[144:147], v221 offset:26624
    v_mfma_f32_16x16x32_bf16 v[20:23], v[124:127], v[100:103], v[20:23]
    ds_read_b128 v[148:151], v221 offset:28672
    v_mfma_f32_16x16x32_bf16 v[24:27], v[124:127], v[104:107], v[24:27]
    ds_read_b64_tr_b16 v[156:157], v222 offset:28960
    v_mfma_f32_16x16x32_bf16 v[28:31], v[124:127], v[108:111], v[28:31]
    ds_read_b64_tr_b16 v[158:159], v222 offset:29536
    v_mfma_f32_16x16x32_bf16 v[32:35], v[124:127], v[112:115], v[32:35]
    v_mfma_f32_16x16x32_bf16 v[36:39], v[124:127], v[116:119], v[36:39]
    s_waitcnt lgkmcnt(0)
    s_cmp_lg_u32 s41, 0
    s_cbranch_scc1 op52_g2_nw
    s_waitcnt vmcnt(0)
    v_readfirstlane_b32 s40, v226
op52_g2_nw:
    s_barrier
    s_add_u32 s44, s42, s85
    s_and_b32 s44, s44, 3
    s_lshl_b32 s44, s44, 3
    s_bitcmp1_b32 s40, s44
    s_cbranch_scc0 op52_g2_ie
op52_g2_il:
    s_mul_i32 s99, s41, 19456
    s_add_u32 m0, s43, s99
    s_add_u32 s45, s46, 8192
    buffer_load_dwordx4 v254, s[20:23], s46 offen sc1 lds
    s_add_u32 m0, m0, 8192
    s_add_u32 s46, s46, 18432
    buffer_load_dwordx4 v254, s[20:23], s45 offen sc1 lds
    s_add_u32 m0, s78, s99
    s_nop 0
    buffer_load_dwordx4 v244, s[16:19], s47 offen sc1 lds
    s_add_u32 m0, s79, s99
    s_add_u32 s47, s47, s48
    buffer_load_dwordx4 v245, s[12:15], s77 offen lds
    s_add_u32 m0, s80, s99
    s_nop 0
    buffer_load_dwordx4 v246, s[12:15], s77 offen lds
    s_add_u32 s77, s77, 73728
    s_add_u32 s41, s41, 1
    s_cmp_lt_u32 s41, 2
    s_cbranch_scc1 op52_g2_il
op52_g2_ie:
    s_cmp_lg_u32 s41, 0
    s_cbranch_scc1 op52_g2_nl
    buffer_load_dword v226, off, s[20:23], s98 sc1
op52_g2_nl:
    v_mfma_f32_16x16x32_bf16 v[0:3], v[152:155], v[132:135], v[0:3]
    ds_read_b64_tr_b16 v[120:121], v224 offset:0
    v_mfma_f32_16x16x32_bf16 v[4:7], v[152:155], v[136:139], v[4:7]
    ds_read_b64_tr_b16 v[122:123], v224 offset:576
    v_mfma_f32_16x16x32_bf16 v[8:11], v[152:155], v[140:143], v[8:11]
    ds_read_b128 v[100:103], v223 offset:0
    v_mfma_f32_16x16x32_bf16 v[12:15], v[152:155], v[144:147], v[12:15]
    ds_read_b128 v[104:107], v223 offset:2048
    v_mfma_f32_16x16x32_bf16 v[16:19], v[152:155], v[148:151], v[16:19]
    ds_read_b128 v[108:111], v223 offset:4096
    ds_read_b128 v[112:115], v223 offset:6144
    v_mfma_f32_16x16x32_bf16 v[20:23], v[156:159], v[132:135], v[20:23]
    ds_read_b128 v[116:119], v223 offset:8192
    v_mfma_f32_16x16x32_bf16 v[24:27], v[156:159], v[136:139], v[24:27]
    ds_read_b64_tr_b16 v[124:125], v224 offset:32
    v_mfma_f32_16x16x32_bf16 v[28:31], v[156:159], v[140:143], v[28:31]
    ds_read_b64_tr_b16 v[126:127], v224 offset:608
    v_mfma_f32_16x16x32_bf16 v[32:35], v[156:159], v[144:147], v[32:35]
    v_mfma_f32_16x16x32_bf16 v[36:39], v[156:159], v[148:151], v[36:39]
    s_waitcnt lgkmcnt(4)
    v_mfma_f32_16x16x32_bf16 v[0:3], v[120:123], v[100:103], v[0:3]
    ds_read_b64_tr_b16 v[152:153], v224 offset:9472
    v_mfma_f32_16x16x32_bf16 v[4:7], v[120:123], v[104:107], v[4:7]
    ds_read_b64_tr_b16 v[154:155], v224 offset:10048
    v_mfma_f32_16x16x32_bf16 v[8:11], v[120:123], v[108:111], v[8:11]
    ds_read_b128 v[132:135], v223 offset:1024
    s_waitcnt lgkmcnt(3)
    v_mfma_f32_16x16x32_bf16 v[12:15], v[120:123], v[112:115], v[12:15]
    ds_read_b128 v[136:139], v223 offset:3072
    v_mfma_f32_16x16x32_bf16 v[16:19], v[120:123], v[116:119], v[16:19]
    ds_read_b128 v[140:143], v223 offset:5120
    ds_read_b128 v[144:147], v223 offset:7168
    v_mfma_f32_16x16x32_bf16 v[20:23], v[124:127], v[100:103], v[20:23]
    ds_read_b128 v[148:151], v223 offset:9216
    v_mfma_f32_16x16x32_bf16 v[24:27], v[124:127], v[104:107], v[24:27]
    ds_read_b64_tr_b16 v[156:157], v224 offset:9504
    v_mfma_f32_16x16x32_bf16 v[28:31], v[124:127], v[108:111], v[28:31]
    ds_read_b64_tr_b16 v[158:159], v224 offset:10080
    v_mfma_f32_16x16x32_bf16 v[32:35], v[124:127], v[112:115], v[32:35]
    v_mfma_f32_16x16x32_bf16 v[36:39], v[124:127], v[116:119], v[36:39]
    s_waitcnt lgkmcnt(0)
    s_cmp_lg_u32 s41, 0
    s_cbranch_scc1 op52_g3_nw
    s_waitcnt vmcnt(0)
    v_readfirstlane_b32 s40, v226
op52_g3_nw:
    s_barrier
    s_add_u32 s44, s42, s85
    s_and_b32 s44, s44, 3
    s_lshl_b32 s44, s44, 3
    s_bitcmp1_b32 s40, s44
    s_cbranch_scc0 op52_g3_ie
op52_g3_il:
    s_mul_i32 s99, s41, 19456
    s_add_u32 m0, s43, s99
    s_add_u32 s45, s46, 8192
    buffer_load_dwordx4 v254, s[20:23], s46 offen sc1 lds
    s_add_u32 m0, m0, 8192
    s_add_u32 s46, s46, 18432
    buffer_load_dwordx4 v254, s[20:23], s45 offen sc1 lds
    s_add_u32 m0, s78, s99
    s_nop 0
    buffer_load_dwordx4 v244, s[16:19], s47 offen sc1 lds
    s_add_u32 m0, s79, s99
    s_add_u32 s47, s47, s48
    buffer_load_dwordx4 v245, s[12:15], s77 offen lds
    s_add_u32 m0, s80, s99
    s_nop 0
    buffer_load_dwordx4 v246, s[12:15], s77 offen lds
    s_add_u32 s77, s77, 73728
    s_add_u32 s41, s41, 1
    s_cmp_lt_u32 s41, 3
    s_cbranch_scc1 op52_g3_il
op52_g3_ie:
    s_cmp_lg_u32 s41, 0
    s_cbranch_scc1 op52_g3_nl
    buffer_load_dword v226, off, s[20:23], s98 sc1
op52_g3_nl:
    v_mfma_f32_16x16x32_bf16 v[0:3], v[152:155], v[132:135], v[0:3]
    ds_read_b64_tr_b16 v[120:121], v224 offset:19456
    v_mfma_f32_16x16x32_bf16 v[4:7], v[152:155], v[136:139], v[4:7]
    ds_read_b64_tr_b16 v[122:123], v224 offset:20032
    v_mfma_f32_16x16x32_bf16 v[8:11], v[152:155], v[140:143], v[8:11]
    ds_read_b128 v[100:103], v223 offset:19456
    v_mfma_f32_16x16x32_bf16 v[12:15], v[152:155], v[144:147], v[12:15]
    ds_read_b128 v[104:107], v223 offset:21504
    v_mfma_f32_16x16x32_bf16 v[16:19], v[152:155], v[148:151], v[16:19]
    ds_read_b128 v[108:111], v223 offset:23552
    ds_read_b128 v[112:115], v223 offset:25600
    v_mfma_f32_16x16x32_bf16 v[20:23], v[156:159], v[132:135], v[20:23]
    ds_read_b128 v[116:119], v223 offset:27648
    v_mfma_f32_16x16x32_bf16 v[24:27], v[156:159], v[136:139], v[24:27]
    ds_read_b64_tr_b16 v[124:125], v224 offset:19488
    v_mfma_f32_16x16x32_bf16 v[28:31], v[156:159], v[140:143], v[28:31]
    ds_read_b64_tr_b16 v[126:127], v224 offset:20064
    v_mfma_f32_16x16x32_bf16 v[32:35], v[156:159], v[144:147], v[32:35]
    v_mfma_f32_16x16x32_bf16 v[36:39], v[156:159], v[148:151], v[36:39]
    s_waitcnt lgkmcnt(4)
    v_mfma_f32_16x16x32_bf16 v[0:3], v[120:123], v[100:103], v[0:3]
    ds_read_b64_tr_b16 v[152:153], v224 offset:28928
    v_mfma_f32_16x16x32_bf16 v[4:7], v[120:123], v[104:107], v[4:7]
    ds_read_b64_tr_b16 v[154:155], v224 offset:29504
    v_mfma_f32_16x16x32_bf16 v[8:11], v[120:123], v[108:111], v[8:11]
    ds_read_b128 v[132:135], v223 offset:20480
    s_waitcnt lgkmcnt(3)
    v_mfma_f32_16x16x32_bf16 v[12:15], v[120:123], v[112:115], v[12:15]
    ds_read_b128 v[136:139], v223 offset:22528
    v_mfma_f32_16x16x32_bf16 v[16:19], v[120:123], v[116:119], v[16:19]
    ds_read_b128 v[140:143], v223 offset:24576
    ds_read_b128 v[144:147], v223 offset:26624
    v_mfma_f32_16x16x32_bf16 v[20:23], v[124:127], v[100:103], v[20:23]
    ds_read_b128 v[148:151], v223 offset:28672
    v_mfma_f32_16x16x32_bf16 v[24:27], v[124:127], v[104:107], v[24:27]
    ds_read_b64_tr_b16 v[156:157], v224 offset:28960
    v_mfma_f32_16x16x32_bf16 v[28:31], v[124:127], v[108:111], v[28:31]
    ds_read_b64_tr_b16 v[158:159], v224 offset:29536
    v_mfma_f32_16x16x32_bf16 v[32:35], v[124:127], v[112:115], v[32:35]
    v_mfma_f32_16x16x32_bf16 v[36:39], v[124:127], v[116:119], v[36:39]
    s_waitcnt lgkmcnt(0)
    s_cmp_lg_u32 s41, 0
    s_cbranch_scc1 op52_j3
    s_waitcnt vmcnt(0)
    v_readfirstlane_b32 s40, v226
    s_add_u32 s44, s42, s85
    s_and_b32 s44, s44, 3
    s_lshl_b32 s44, s44, 3
    s_bitcmp1_b32 s40, s44
    s_cbranch_scc1 op52_p0_ok
op52_p0:
    buffer_load_dword v226, off, s[20:23], s98 sc1
    s_waitcnt vmcnt(0)
    v_readfirstlane_b32 s40, v226
    s_add_u32 s44, s42, s85
    s_and_b32 s44, s44, 3
    s_lshl_b32 s44, s44, 3
    s_bitcmp1_b32 s40, s44
    s_cbranch_scc1 op52_p0_ok
    s_sleep 4
    s_branch op52_p0
op52_p0_ok:
    buffer_load_dword v226, off, s[20:23], s98 sc1
    s_add_u32 m0, s43, 0
    s_add_u32 s45, s46, 8192
    buffer_load_dwordx4 v254, s[20:23], s46 offen sc1 lds
    s_add_u32 m0, m0, 8192
    s_add_u32 s46, s46, 18432
    buffer_load_dwordx4 v254, s[20:23], s45 offen sc1 lds
    s_add_u32 m0, s78, 0
    s_nop 0
    buffer_load_dwordx4 v244, s[16:19], s47 offen sc1 lds
    s_add_u32 m0, s79, 0
    s_add_u32 s47, s47, s48
    buffer_load_dwordx4 v245, s[12:15], s77 offen lds
    s_add_u32 m0, s80, 0
    s_nop 0
    buffer_load_dwordx4 v246, s[12:15], s77 offen lds
    s_add_u32 s77, s77, 73728
    s_add_u32 m0, s43, 19456
    s_add_u32 s45, s46, 8192
    buffer_load_dwordx4 v254, s[20:23], s46 offen sc1 lds
    s_add_u32 m0, m0, 8192
    s_add_u32 s46, s46, 18432
    buffer_load_dwordx4 v254, s[20:23], s45 offen sc1 lds
    s_add_u32 m0, s78, 19456
    s_nop 0
    buffer_load_dwordx4 v244, s[16:19], s47 offen sc1 lds
    s_add_u32 m0, s79, 19456
    s_add_u32 s47, s47, s48
    buffer_load_dwordx4 v245, s[12:15], s77 offen lds
    s_add_u32 m0, s80, 19456
    s_nop 0
    buffer_load_dwordx4 v246, s[12:15], s77 offen lds
    s_add_u32 s77, s77, 73728
    s_add_u32 m0, s43, 38912
    s_add_u32 s45, s46, 8192
    buffer_load_dwordx4 v254, s[20:23], s46 offen sc1 lds
    s_add_u32 m0, m0, 8192
    s_add_u32 s46, s46, 18432
    buffer_load_dwordx4 v254, s[20:23], s45 offen sc1 lds
    s_add_u32 m0, s78, 38912
    s_nop 0
    buffer_load_dwordx4 v244, s[16:19], s47 offen sc1 lds
    s_add_u32 m0, s79, 38912
    s_add_u32 s47, s47, s48
    buffer_load_dwordx4 v245, s[12:15], s77 offen lds
    s_add_u32 m0, s80, 38912
    s_nop 0
    buffer_load_dwordx4 v246, s[12:15], s77 offen lds
    s_add_u32 s77, s77, 73728
op52_j3:
op52_loop:
    s_waitcnt vmcnt(10)
    s_barrier
    v_mfma_f32_16x16x32_bf16 v[0:3], v[152:155], v[132:135], v[0:3]
    ds_read_b64_tr_b16 v[120:121], v222 offset:0
    s_add_u32 m0, s43, 58368
    v_mfma_f32_16x16x32_bf16 v[4:7], v[152:155], v[136:139], v[4:7]
    ds_read_b64_tr_b16 v[122:123], v222 offset:576
    v_mfma_f32_16x16x32_bf16 v[8:11], v[152:155], v[140:143], v[8:11]
    ds_read_b128 v[100:103], v221 offset:0
    s_add_u32 s45, s46, 8192
    v_mfma_f32_16x16x32_bf16 v[12:15], v[152:155], v[144:147], v[12:15]
    ds_read_b128 v[104:107], v221 offset:2048
    buffer_load_dwordx4 v254, s[20:23], s46 offen sc1 lds
    v_mfma_f32_16x16x32_bf16 v[16:19], v[152:155], v[148:151], v[16:19]
    ds_read_b128 v[108:111], v221 offset:4096
    ds_read_b128 v[112:115], v221 offset:6144
    v_mfma_f32_16x16x32_bf16 v[20:23], v[156:159], v[132:135], v[20:23]
    ds_read_b128 v[116:119], v221 offset:8192
    v_mfma_f32_16x16x32_bf16 v[24:27], v[156:159], v[136:139], v[24:27]
    ds_read_b64_tr_b16 v[124:125], v222 offset:32
    s_add_u32 m0, m0, 8192
    v_mfma_f32_16x16x32_bf16 v[28:31], v[156:159], v[140:143], v[28:31]
    ds_read_b64_tr_b16 v[126:127], v222 offset:608
    s_add_u32 s46, s46, 18432
    v_mfma_f32_16x16x32_bf16 v[32:35], v[156:159], v[144:147], v[32:35]
    buffer_load_dwordx4 v254, s[20:23], s45 offen sc1 lds
    v_mfma_f32_16x16x32_bf16 v[36:39], v[156:159], v[148:151], v[36:39]
    s_add_u32 m0, s78, 58368
    s_nop 0
    s_waitcnt lgkmcnt(4)
    v_mfma_f32_16x16x32_bf16 v[0:3], v[120:123], v[100:103], v[0:3]
    ds_read_b64_tr_b16 v[152:153], v222 offset:9472
    buffer_load_dwordx4 v244, s[16:19], s47 offen sc1 lds
    v_mfma_f32_16x16x32_bf16 v[4:7], v[120:123], v[104:107], v[4:7]
    ds_read_b64_tr_b16 v[154:155], v222 offset:10048
    v_mfma_f32_16x16x32_bf16 v[8:11], v[120:123], v[108:111], v[8:11]
    ds_read_b128 v[132:135], v221 offset:1024
    s_add_u32 m0, s79, 58368
    s_waitcnt lgkmcnt(3)
    v_mfma_f32_16x16x32_bf16 v[12:15], v[120:123], v[112:115], v[12:15]
    ds_read_b128 v[136:139], v221 offset:3072
    s_add_u32 s47, s47, s48
    v_mfma_f32_16x16x32_bf16 v[16:19], v[120:123], v[116:119], v[16:19]
    ds_read_b128 v[140:143], v221 offset:5120
    ds_read_b128 v[144:147], v221 offset:7168
    v_mfma_f32_16x16x32_bf16 v[20:23], v[124:127], v[100:103], v[20:23]
    ds_read_b128 v[148:151], v221 offset:9216
    v_mfma_f32_16x16x32_bf16 v[24:27], v[124:127], v[104:107], v[24:27]
    ds_read_b64_tr_b16 v[156:157], v222 offset:9504
    buffer_load_dwordx4 v245, s[12:15], s77 offen lds
    v_mfma_f32_16x16x32_bf16 v[28:31], v[124:127], v[108:111], v[28:31]
    ds_read_b64_tr_b16 v[158:159], v222 offset:10080
    s_add_u32 m0, s80, 58368
    v_mfma_f32_16x16x32_bf16 v[32:35], v[124:127], v[112:115], v[32:35]
    s_nop 0
    v_mfma_f32_16x16x32_bf16 v[36:39], v[124:127], v[116:119], v[36:39]
    buffer_load_dwordx4 v246, s[12:15], s77 offen lds
    s_add_u32 s77, s77, 73728
    s_waitcnt lgkmcnt(0)
    s_waitcnt vmcnt(10)
    s_barrier
    v_readfirstlane_b32 s40, v226
    s_add_u32 s42, s42, 1
    s_add_u32 s44, s42, s85
    s_and_b32 s44, s44, 3
    s_lshl_b32 s44, s44, 3
    s_bitcmp1_b32 s40, s44
    s_cbranch_scc0 op52_late
op52_rdy:
    v_mfma_f32_16x16x32_bf16 v[0:3], v[152:155], v[132:135], v[0:3]
    ds_read_b64_tr_b16 v[120:121], v222 offset:19456
    s_add_u32 s44, s85, s42
    v_mfma_f32_16x16x32_bf16 v[4:7], v[152:155], v[136:139], v[4:7]
    ds_read_b64_tr_b16 v[122:123], v222 offset:20032
    s_cmp_eq_u32 s44, 4
    s_cselect_b32 s44, 16, 0
    v_mfma_f32_16x16x32_bf16 v[8:11], v[152:155], v[140:143], v[8:11]
    ds_read_b128 v[100:103], v221 offset:19456
    s_cmp_eq_u32 s42, 4
    v_mfma_f32_16x16x32_bf16 v[12:15], v[152:155], v[144:147], v[12:15]
    ds_read_b128 v[104:107], v221 offset:21504
    s_cselect_b32 s44, 0xffff0000, s44
    v_mfma_f32_16x16x32_bf16 v[16:19], v[152:155], v[148:151], v[16:19]
    ds_read_b128 v[108:111], v221 offset:23552
    ds_read_b128 v[112:115], v221 offset:25600
    v_mfma_f32_16x16x32_bf16 v[20:23], v[156:159], v[132:135], v[20:23]
    ds_read_b128 v[116:119], v221 offset:27648
    s_mul_i32 s45, s44, 18432
    s_sub_u32 s46, s46, s45
    v_mfma_f32_16x16x32_bf16 v[24:27], v[156:159], v[136:139], v[24:27]
    ds_read_b64_tr_b16 v[124:125], v222 offset:19488
    s_mul_i32 s45, s44, 73728
    v_mfma_f32_16x16x32_bf16 v[28:31], v[156:159], v[140:143], v[28:31]
    ds_read_b64_tr_b16 v[126:127], v222 offset:20064
    s_sub_u32 s77, s77, s45
    v_mfma_f32_16x16x32_bf16 v[32:35], v[156:159], v[144:147], v[32:35]
    s_mul_i32 s45, s44, s48
    s_sub_u32 s47, s47, s45
    v_mfma_f32_16x16x32_bf16 v[36:39], v[156:159], v[148:151], v[36:39]
    s_add_u32 m0, s43, 0
    s_add_u32 s45, s46, 8192
    buffer_load_dwordx4 v254, s[20:23], s46 offen sc1 lds
    s_waitcnt lgkmcnt(4)
    v_mfma_f32_16x16x32_bf16 v[0:3], v[120:123], v[100:103], v[0:3]
    ds_read_b64_tr_b16 v[152:153], v222 offset:28928
    s_add_u32 m0, m0, 8192
    v_mfma_f32_16x16x32_bf16 v[4:7], v[120:123], v[104:107], v[4:7]
    ds_read_b64_tr_b16 v[154:155], v222 offset:29504
    s_add_u32 s46, s46, 18432
    v_mfma_f32_16x16x32_bf16 v[8:11], v[120:123], v[108:111], v[8:11]
    ds_read_b128 v[132:135], v221 offset:20480
    buffer_load_dwordx4 v254, s[20:23], s45 offen sc1 lds
    s_waitcnt lgkmcnt(3)
    v_mfma_f32_16x16x32_bf16 v[12:15], v[120:123], v[112:115], v[12:15]
    ds_read_b128 v[136:139], v221 offset:22528
    s_add_u32 m0, s78, 0
    s_nop 0
    v_mfma_f32_16x16x32_bf16 v[16:19], v[120:123], v[116:119], v[16:19]
    ds_read_b128 v[140:143], v221 offset:24576
    ds_read_b128 v[144:147], v221 offset:26624
    v_mfma_f32_16x16x32_bf16 v[20:23], v[124:127], v[100:103], v[20:23]
    ds_read_b128 v[148:151], v221 offset:28672
    buffer_load_dwordx4 v244, s[16:19], s47 offen sc1 lds
    v_mfma_f32_16x16x32_bf16 v[24:27], v[124:127], v[104:107], v[24:27]
    ds_read_b64_tr_b16 v[156:157], v222 offset:28960
    s_add_u32 m0, s79, 0
    v_mfma_f32_16x16x32_bf16 v[28:31], v[124:127], v[108:111], v[28:31]
    ds_read_b64_tr_b16 v[158:159], v222 offset:29536
    s_add_u32 s47, s47, s48
    buffer_load_dwordx4 v245, s[12:15], s77 offen lds
    v_mfma_f32_16x16x32_bf16 v[32:35], v[124:127], v[112:115], v[32:35]
    s_add_u32 m0, s80, 0
    s_nop 0
    v_mfma_f32_16x16x32_bf16 v[36:39], v[124:127], v[116:119], v[36:39]
    buffer_load_dwordx4 v246, s[12:15], s77 offen lds
    s_add_u32 s77, s77, 73728
    s_waitcnt lgkmcnt(0)
    s_waitcnt vmcnt(10)
    s_barrier
    v_mfma_f32_16x16x32_bf16 v[0:3], v[152:155], v[132:135], v[0:3]
    ds_read_b64_tr_b16 v[120:121], v224 offset:0
    s_add_u32 m0, s43, 19456
    v_mfma_f32_16x16x32_bf16 v[4:7], v[152:155], v[136:139], v[4:7]
    ds_read_b64_tr_b16 v[122:123], v224 offset:576
    v_mfma_f32_16x16x32_bf16 v[8:11], v[152:155], v[140:143], v[8:11]
    ds_read_b128 v[100:103], v223 offset:0
    s_add_u32 s45, s46, 8192
    v_mfma_f32_16x16x32_bf16 v[12:15], v[152:155], v[144:147], v[12:15]
    ds_read_b128 v[104:107], v223 offset:2048
    buffer_load_dwordx4 v254, s[20:23], s46 offen sc1 lds
    v_mfma_f32_16x16x32_bf16 v[16:19], v[152:155], v[148:151], v[16:19]
    ds_read_b128 v[108:111], v223 offset:4096
    ds_read_b128 v[112:115], v223 offset:6144
    v_mfma_f32_16x16x32_bf16 v[20:23], v[156:159], v[132:135], v[20:23]
    ds_read_b128 v[116:119], v223 offset:8192
    v_mfma_f32_16x16x32_bf16 v[24:27], v[156:159], v[136:139], v[24:27]
    ds_read_b64_tr_b16 v[124:125], v224 offset:32
    s_add_u32 m0, m0, 8192
    v_mfma_f32_16x16x32_bf16 v[28:31], v[156:159], v[140:143], v[28:31]
    ds_read_b64_tr_b16 v[126:127], v224 offset:608
    s_add_u32 s46, s46, 18432
    v_mfma_f32_16x16x32_bf16 v[32:35], v[156:159], v[144:147], v[32:35]
    buffer_load_dwordx4 v254, s[20:23], s45 offen sc1 lds
    v_mfma_f32_16x16x32_bf16 v[36:39], v[156:159], v[148:151], v[36:39]
    s_add_u32 m0, s78, 19456
    s_nop 0
    s_waitcnt lgkmcnt(4)
    v_mfma_f32_16x16x32_bf16 v[0:3], v[120:123], v[100:103], v[0:3]
    ds_read_b64_tr_b16 v[152:153], v224 offset:9472
    buffer_load_dwordx4 v244, s[16:19], s47 offen sc1 lds
    v_mfma_f32_16x16x32_bf16 v[4:7], v[120:123], v[104:107], v[4:7]
    ds_read_b64_tr_b16 v[154:155], v224 offset:10048
    v_mfma_f32_16x16x32_bf16 v[8:11], v[120:123], v[108:111], v[8:11]
    ds_read_b128 v[132:135], v223 offset:1024
    s_add_u32 m0, s79, 19456
    s_waitcnt lgkmcnt(3)
    v_mfma_f32_16x16x32_bf16 v[12:15], v[120:123], v[112:115], v[12:15]
    ds_read_b128 v[136:139], v223 offset:3072
    s_add_u32 s47, s47, s48
    v_mfma_f32_16x16x32_bf16 v[16:19], v[120:123], v[116:119], v[16:19]
    ds_read_b128 v[140:143], v223 offset:5120
    ds_read_b128 v[144:147], v223 offset:7168
    v_mfma_f32_16x16x32_bf16 v[20:23], v[124:127], v[100:103], v[20:23]
    ds_read_b128 v[148:151], v223 offset:9216
    v_mfma_f32_16x16x32_bf16 v[24:27], v[124:127], v[104:107], v[24:27]
    ds_read_b64_tr_b16 v[156:157], v224 offset:9504
    buffer_load_dwordx4 v245, s[12:15], s77 offen lds
    v_mfma_f32_16x16x32_bf16 v[28:31], v[124:127], v[108:111], v[28:31]
    ds_read_b64_tr_b16 v[158:159], v224 offset:10080
    s_add_u32 m0, s80, 19456
    v_mfma_f32_16x16x32_bf16 v[32:35], v[124:127], v[112:115], v[32:35]
    s_nop 0
    v_mfma_f32_16x16x32_bf16 v[36:39], v[124:127], v[116:119], v[36:39]
    buffer_load_dwordx4 v246, s[12:15], s77 offen lds
    s_add_u32 s77, s77, 73728
    s_waitcnt lgkmcnt(0)
    s_waitcnt vmcnt(10)
    s_barrier
    v_mfma_f32_16x16x32_bf16 v[0:3], v[152:155], v[132:135], v[0:3]
    ds_read_b64_tr_b16 v[120:121], v224 offset:19456
    buffer_load_dword v226, off, s[20:23], s98 sc1
    v_mfma_f32_16x16x32_bf16 v[4:7], v[152:155], v[136:139], v[4:7]
    ds_read_b64_tr_b16 v[122:123], v224 offset:20032
    s_add_u32 m0, s43, 38912
    v_mfma_f32_16x16x32_bf16 v[8:11], v[152:155], v[140:143], v[8:11]
    ds_read_b128 v[100:103], v223 offset:19456
    v_mfma_f32_16x16x32_bf16 v[12:15], v[152:155], v[144:147], v[12:15]
    ds_read_b128 v[104:107], v223 offset:21504
    s_add_u32 s45, s46, 8192
    v_mfma_f32_16x16x32_bf16 v[16:19], v[152:155], v[148:151], v[16:19]
    ds_read_b128 v[108:111], v223 offset:23552
    ds_read_b128 v[112:115], v223 offset:25600
    v_mfma_f32_16x16x32_bf16 v[20:23], v[156:159], v[132:135], v[20:23]
    ds_read_b128 v[116:119], v223 offset:27648
    buffer_load_dwordx4 v254, s[20:23], s46 offen sc1 lds
    v_mfma_f32_16x16x32_bf16 v[24:27], v[156:159], v[136:139], v[24:27]
    ds_read_b64_tr_b16 v[124:125], v224 offset:19488
    s_add_u32 m0, m0, 8192
    v_mfma_f32_16x16x32_bf16 v[28:31], v[156:159], v[140:143], v[28:31]
    ds_read_b64_tr_b16 v[126:127], v224 offset:20064
    v_mfma_f32_16x16x32_bf16 v[32:35], v[156:159], v[144:147], v[32:35]
    s_add_u32 s46, s46, 18432
    buffer_load_dwordx4 v254, s[20:23], s45 offen sc1 lds
    v_mfma_f32_16x16x32_bf16 v[36:39], v[156:159], v[148:151], v[36:39]
    s_add_u32 m0, s78, 38912
    s_nop 0
    s_waitcnt lgkmcnt(4)
    v_mfma_f32_16x16x32_bf16 v[0:3], v[120:123], v[100:103], v[0:3]
    ds_read_b64_tr_b16 v[152:153], v224 offset:28928
    buffer_load_dwordx4 v244, s[16:19], s47 offen sc1 lds
    v_mfma_f32_16x16x32_bf16 v[4:7], v[120:123], v[104:107], v[4:7]
    ds_read_b64_tr_b16 v[154:155], v224 offset:29504
    s_add_u32 m0, s79, 38912
    v_mfma_f32_16x16x32_bf16 v[8:11], v[120:123], v[108:111], v[8:11]
    ds_read_b128 v[132:135], v223 offset:20480
    s_waitcnt lgkmcnt(3)
    v_mfma_f32_16x16x32_bf16 v[12:15], v[120:123], v[112:115], v[12:15]
    ds_read_b128 v[136:139], v223 offset:22528
    s_add_u32 s47, s47, s48
    v_mfma_f32_16x16x32_bf16 v[16:19], v[120:123], v[116:119], v[16:19]
    ds_read_b128 v[140:143], v223 offset:24576
    ds_read_b128 v[144:147], v223 offset:26624
    v_mfma_f32_16x16x32_bf16 v[20:23], v[124:127], v[100:103], v[20:23]
    ds_read_b128 v[148:151], v223 offset:28672
    buffer_load_dwordx4 v245, s[12:15], s77 offen lds
    v_mfma_f32_16x16x32_bf16 v[24:27], v[124:127], v[104:107], v[24:27]
    ds_read_b64_tr_b16 v[156:157], v224 offset:28960
    s_add_u32 m0, s80, 38912
    v_mfma_f32_16x16x32_bf16 v[28:31], v[124:127], v[108:111], v[28:31]
    ds_read_b64_tr_b16 v[158:159], v224 offset:29536
    v_mfma_f32_16x16x32_bf16 v[32:35], v[124:127], v[112:115], v[32:35]
    s_nop 0
    buffer_load_dwordx4 v246, s[12:15], s77 offen lds
    v_mfma_f32_16x16x32_bf16 v[36:39], v[124:127], v[116:119], v[36:39]
    s_add_u32 s77, s77, 73728
    s_cmp_lt_u32 s42, 4
    s_waitcnt lgkmcnt(0)
    s_cbranch_scc1 op52_loop
    s_branch op52_done
op52_late:
op52_p1:
    buffer_load_dword v226, off, s[20:23], s98 sc1
    s_waitcnt vmcnt(0)
    v_readfirstlane_b32 s40, v226
    s_add_u32 s44, s42, s85
    s_and_b32 s44, s44, 3
    s_lshl_b32 s44, s44, 3
    s_bitcmp1_b32 s40, s44
    s_cbranch_scc1 op52_p1_ok
    s_sleep 4
    s_branch op52_p1
op52_p1_ok:
    s_branch op52_rdy
op52_done:
    v_mfma_f32_16x16x32_bf16 v[0:3], v[152:155], v[132:135], v[0:3]
    v_mfma_f32_16x16x32_bf16 v[4:7], v[152:155], v[136:139], v[4:7]
    v_mfma_f32_16x16x32_bf16 v[8:11], v[152:155], v[140:143], v[8:11]
    v_mfma_f32_16x16x32_bf16 v[12:15], v[152:155], v[144:147], v[12:15]
    v_mfma_f32_16x16x32_bf16 v[16:19], v[152:155], v[148:151], v[16:19]
    v_mfma_f32_16x16x32_bf16 v[20:23], v[156:159], v[132:135], v[20:23]
    v_mfma_f32_16x16x32_bf16 v[24:27], v[156:159], v[136:139], v[24:27]
    v_mfma_f32_16x16x32_bf16 v[28:31], v[156:159], v[140:143], v[28:31]
    v_mfma_f32_16x16x32_bf16 v[32:35], v[156:159], v[144:147], v[32:35]
    v_mfma_f32_16x16x32_bf16 v[36:39], v[156:159], v[148:151], v[36:39]
    s_cmp_eq_u32 s84, 0
    s_cbranch_scc1 op52_k0
    s_cmp_eq_u32 s84, 1
    s_cbranch_scc1 op52_k1
    s_cmp_eq_u32 s84, 2
    s_cbranch_scc1 op52_k2
op52_k3:
    s_nop 7
    s_add_u32 s44, s52, 98304
    v_cvt_pk_bf16_f32 v0, v0, v1
    v_cvt_pk_bf16_f32 v1, v2, v3
    v_cvt_pk_bf16_f32 v2, v16, v17
    v_cvt_pk_bf16_f32 v3, v18, v19
    buffer_store_dwordx4 v[0:3], v254, s[20:23], s44 offen offset:0 sc1
    v_cvt_pk_bf16_f32 v32, v32, v33
    v_cvt_pk_bf16_f32 v33, v34, v35
    buffer_store_dwordx4 v[32:35], v254, s[20:23], s44 offen offset:1024 sc1
    s_add_u32 s44, s52, 229376
    v_cvt_pk_bf16_f32 v4, v4, v5
    v_cvt_pk_bf16_f32 v5, v6, v7
    v_cvt_pk_bf16_f32 v6, v20, v21
    v_cvt_pk_bf16_f32 v7, v22, v23
    buffer_store_dwordx4 v[4:7], v254, s[20:23], s44 offen offset:0 sc1
    v_cvt_pk_bf16_f32 v36, v36, v37
    v_cvt_pk_bf16_f32 v37, v38, v39
    buffer_store_dwordx4 v[36:39], v254, s[20:23], s44 offen offset:1024 sc1
    s_add_u32 s44, s52, 360448
    v_cvt_pk_bf16_f32 v8, v8, v9
    v_cvt_pk_bf16_f32 v9, v10, v11
    v_cvt_pk_bf16_f32 v10, v24, v25
    v_cvt_pk_bf16_f32 v11, v26, v27
    buffer_store_dwordx4 v[8:11], v254, s[20:23], s44 offen offset:0 sc1
    s_waitcnt vmcnt(0)
    s_barrier
    s_cmp_lg_u32 s30, 0
    s_cbranch_scc1 op52_nr3
    v_lshlrev_b32 v226, 8, v250
    v_mov_b32 v251, 1
    s_add_u32 s44, s54, -765
    s_mov_b64 exec, 15
    buffer_store_byte v251, v226, s[20:23], s44 offen sc1
    s_mov_b64 exec, -1
op52_nr3:
op52_q3:
    buffer_load_dword v226, off, s[20:23], s54 sc1
    s_waitcnt vmcnt(0)
    v_readfirstlane_b32 s40, v226
    s_nop 0
    s_cmp_eq_u32 s40, 0x01010101
    s_cbranch_scc1 op52_q3_ok
    s_sleep 4
    s_branch op52_q3
op52_q3_ok:
    s_add_u32 s94, s52, 393216
    s_add_u32 s95, s52, 425984
    s_add_u32 s96, s52, 458752
    buffer_load_dwordx4 v[100:103], v254, s[20:23], s94 offen offset:0 sc1
    buffer_load_dwordx4 v[104:107], v254, s[20:23], s95 offen offset:0 sc1
    buffer_load_dwordx4 v[108:111], v254, s[20:23], s96 offen offset:0 sc1
    s_mov_b32 s99, 0xffff0000
    s_add_u32 s44, s53, 55296
    s_waitcnt vmcnt(0)
    v_lshlrev_b32 v251, 16, v100
    v_and_b32 v100, s99, v100
    v_lshlrev_b32 v252, 16, v101
    v_and_b32 v101, s99, v101
    v_add_f32 v12, v12, v251
    v_add_f32 v13, v13, v100
    v_add_f32 v14, v14, v252
    v_add_f32 v15, v15, v101
    v_lshlrev_b32 v251, 16, v104
    v_and_b32 v104, s99, v104
    v_lshlrev_b32 v252, 16, v105
    v_and_b32 v105, s99, v105
    v_add_f32 v12, v12, v251
    v_add_f32 v13, v13, v104
    v_add_f32 v14, v14, v252
    v_add_f32 v15, v15, v105
    v_lshlrev_b32 v251, 16, v108
    v_and_b32 v108, s99, v108
    v_lshlrev_b32 v252, 16, v109
    v_and_b32 v109, s99, v109
    v_add_f32 v12, v12, v251
    v_add_f32 v13, v13, v108
    v_add_f32 v14, v14, v252
    v_add_f32 v15, v15, v109
    v_cvt_pk_bf16_f32 v12, v12, v13
    v_cvt_pk_bf16_f32 v13, v14, v15
    buffer_store_dwordx2 v[12:13], v225, s[8:11], s44 offen
    s_add_u32 s44, s53, 36896
    v_lshlrev_b32 v251, 16, v102
    v_and_b32 v102, s99, v102
    v_lshlrev_b32 v252, 16, v103
    v_and_b32 v103, s99, v103
    v_add_f32 v28, v28, v251
    v_add_f32 v29, v29, v102
    v_add_f32 v30, v30, v252
    v_add_f32 v31, v31, v103
    v_lshlrev_b32 v251, 16, v106
    v_and_b32 v106, s99, v106
    v_lshlrev_b32 v252, 16, v107
    v_and_b32 v107, s99, v107
    v_add_f32 v28, v28, v251
    v_add_f32 v29, v29, v106
    v_add_f32 v30, v30, v252
    v_add_f32 v31, v31, v107
    v_lshlrev_b32 v251, 16, v110
    v_and_b32 v110, s99, v110
    v_lshlrev_b32 v252, 16, v111
    v_and_b32 v111, s99, v111
    v_add_f32 v28, v28, v251
    v_add_f32 v29, v29, v110
    v_add_f32 v30, v30, v252
    v_add_f32 v31, v31, v111
    v_cvt_pk_bf16_f32 v28, v28, v29
    v_cvt_pk_bf16_f32 v29, v30, v31
    buffer_store_dwordx2 v[28:29], v225, s[8:11], s44 offen
    s_branch attn_fin
op52_k0:
    s_nop 7
    s_add_u32 s44, s52, 131072
    v_cvt_pk_bf16_f32 v4, v4, v5
    v_cvt_pk_bf16_f32 v5, v6, v7
    v_cvt_pk_bf16_f32 v6, v20, v21
    v_cvt_pk_bf16_f32 v7, v22, v23
    buffer_store_dwordx4 v[4:7], v254, s[20:23], s44 offen offset:0 sc1
    v_cvt_pk_bf16_f32 v36, v36, v37
    v_cvt_pk_bf16_f32 v37, v38, v39
    buffer_store_dwordx4 v[36:39], v254, s[20:23], s44 offen offset:1024 sc1
    s_add_u32 s44, s52, 262144
    v_cvt_pk_bf16_f32 v8, v8, v9
    v_cvt_pk_bf16_f32 v9, v10, v11
    v_cvt_pk_bf16_f32 v10, v24, v25
    v_cvt_pk_bf16_f32 v11, v26, v27
    buffer_store_dwordx4 v[8:11], v254, s[20:23], s44 offen offset:0 sc1
    s_add_u32 s44, s52, 393216
    v_cvt_pk_bf16_f32 v12, v12, v13
    v_cvt_pk_bf16_f32 v13, v14, v15
    v_cvt_pk_bf16_f32 v14, v28, v29
    v_cvt_pk_bf16_f32 v15, v30, v31
    buffer_store_dwordx4 v[12:15], v254, s[20:23], s44 offen offset:0 sc1
    s_waitcnt vmcnt(0)
    s_barrier
    s_cmp_lg_u32 s30, 0
    s_cbranch_scc1 op52_nr0
    v_lshlrev_b32 v226, 8, v250
    v_mov_b32 v251, 1
    s_add_u32 s44, s54, 0
    s_mov_b64 exec, 15
    buffer_store_byte v251, v226, s[20:23], s44 offen sc1
    s_mov_b64 exec, -1
op52_nr0:
op52_q0:
    buffer_load_dword v226, off, s[20:23], s54 sc1
    s_waitcnt vmcnt(0)
    v_readfirstlane_b32 s40, v226
    s_nop 0
    s_cmp_eq_u32 s40, 0x01010101
    s_cbranch_scc1 op52_q0_ok
    s_sleep 4
    s_branch op52_q0
op52_q0_ok:
    s_add_u32 s94, s52, 32768
    s_add_u32 s95, s52, 65536
    s_add_u32 s96, s52, 98304
    buffer_load_dwordx4 v[100:103], v254, s[20:23], s94 offen offset:0 sc1
    buffer_load_dwordx4 v[104:107], v254, s[20:23], s95 offen offset:0 sc1
    buffer_load_dwordx4 v[108:111], v254, s[20:23], s96 offen offset:0 sc1
    buffer_load_dwordx4 v[112:115], v254, s[20:23], s94 offen offset:1024 sc1
    buffer_load_dwordx4 v[116:119], v254, s[20:23], s95 offen offset:1024 sc1
    buffer_load_dwordx4 v[120:123], v254, s[20:23], s96 offen offset:1024 sc1
    s_mov_b32 s99, 0xffff0000
    s_add_u32 s44, s53, 0
    s_waitcnt vmcnt(3)
    v_lshlrev_b32 v251, 16, v100
    v_and_b32 v100, s99, v100
    v_lshlrev_b32 v252, 16, v101
    v_and_b32 v101, s99, v101
    v_add_f32 v0, v0, v251
    v_add_f32 v1, v1, v100
    v_add_f32 v2, v2, v252
    v_add_f32 v3, v3, v101
    v_lshlrev_b32 v251, 16, v104
    v_and_b32 v104, s99, v104
    v_lshlrev_b32 v252, 16, v105
    v_and_b32 v105, s99, v105
    v_add_f32 v0, v0, v251
    v_add_f32 v1, v1, v104
    v_add_f32 v2, v2, v252
    v_add_f32 v3, v3, v105
    v_lshlrev_b32 v251, 16, v108
    v_and_b32 v108, s99, v108
    v_lshlrev_b32 v252, 16, v109
    v_and_b32 v109, s99, v109
    v_add_f32 v0, v0, v251
    v_add_f32 v1, v1, v108
    v_add_f32 v2, v2, v252
    v_add_f32 v3, v3, v109
    v_cvt_pk_bf16_f32 v0, v0, v1
    v_cvt_pk_bf16_f32 v1, v2, v3
    buffer_store_dwordx2 v[0:1], v225, s[8:11], s44 offen
    s_add_u32 s44, s53, 73728
    v_lshlrev_b32 v251, 16, v102
    v_and_b32 v102, s99, v102
    v_lshlrev_b32 v252, 16, v103
    v_and_b32 v103, s99, v103
    v_add_f32 v16, v16, v251
    v_add_f32 v17, v17, v102
    v_add_f32 v18, v18, v252
    v_add_f32 v19, v19, v103
    v_lshlrev_b32 v251, 16, v106
    v_and_b32 v106, s99, v106
    v_lshlrev_b32 v252, 16, v107
    v_and_b32 v107, s99, v107
    v_add_f32 v16, v16, v251
    v_add_f32 v17, v17, v106
    v_add_f32 v18, v18, v252
    v_add_f32 v19, v19, v107
    v_lshlrev_b32 v251, 16, v110
    v_and_b32 v110, s99, v110
    v_lshlrev_b32 v252, 16, v111
    v_and_b32 v111, s99, v111
    v_add_f32 v16, v16, v251
    v_add_f32 v17, v17, v110
    v_add_f32 v18, v18, v252
    v_add_f32 v19, v19, v111
    v_cvt_pk_bf16_f32 v16, v16, v17
    v_cvt_pk_bf16_f32 v17, v18, v19
    buffer_store_dwordx2 v[16:17], v225, s[8:11], s44 offen
    s_add_u32 s44, s53, 55328
    s_waitcnt vmcnt(2)
    v_lshlrev_b32 v251, 16, v112
    v_and_b32 v112, s99, v112
    v_lshlrev_b32 v252, 16, v113
    v_and_b32 v113, s99, v113
    v_add_f32 v32, v32, v251
    v_add_f32 v33, v33, v112
    v_add_f32 v34, v34, v252
    v_add_f32 v35, v35, v113
    v_lshlrev_b32 v251, 16, v116
    v_and_b32 v116, s99, v116
    v_lshlrev_b32 v252, 16, v117
    v_and_b32 v117, s99, v117
    v_add_f32 v32, v32, v251
    v_add_f32 v33, v33, v116
    v_add_f32 v34, v34, v252
    v_add_f32 v35, v35, v117
    v_lshlrev_b32 v251, 16, v120
    v_and_b32 v120, s99, v120
    v_lshlrev_b32 v252, 16, v121
    v_and_b32 v121, s99, v121
    v_add_f32 v32, v32, v251
    v_add_f32 v33, v33, v120
    v_add_f32 v34, v34, v252
    v_add_f32 v35, v35, v121
    v_cvt_pk_bf16_f32 v32, v32, v33
    v_cvt_pk_bf16_f32 v33, v34, v35
    buffer_store_dwordx2 v[32:33], v225, s[8:11], s44 offen
    s_branch attn_fin
op52_k1:
    s_nop 7
    s_add_u32 s44, s52, 32768
    v_cvt_pk_bf16_f32 v0, v0, v1
    v_cvt_pk_bf16_f32 v1, v2, v3
    v_cvt_pk_bf16_f32 v2, v16, v17
    v_cvt_pk_bf16_f32 v3, v18, v19
    buffer_store_dwordx4 v[0:3], v254, s[20:23], s44 offen offset:0 sc1
    v_cvt_pk_bf16_f32 v32, v32, v33
    v_cvt_pk_bf16_f32 v33, v34, v35
    buffer_store_dwordx4 v[32:35], v254, s[20:23], s44 offen offset:1024 sc1
    s_add_u32 s44, s52, 294912
    v_cvt_pk_bf16_f32 v8, v8, v9
    v_cvt_pk_bf16_f32 v9, v10, v11
    v_cvt_pk_bf16_f32 v10, v24, v25
    v_cvt_pk_bf16_f32 v11, v26, v27
    buffer_store_dwordx4 v[8:11], v254, s[20:23], s44 offen offset:0 sc1
    s_add_u32 s44, s52, 425984
    v_cvt_pk_bf16_f32 v12, v12, v13
    v_cvt_pk_bf16_f32 v13, v14, v15
    v_cvt_pk_bf16_f32 v14, v28, v29
    v_cvt_pk_bf16_f32 v15, v30, v31
    buffer_store_dwordx4 v[12:15], v254, s[20:23], s44 offen offset:0 sc1
    s_waitcnt vmcnt(0)
    s_barrier
    s_cmp_lg_u32 s30, 0
    s_cbranch_scc1 op52_nr1
    v_lshlrev_b32 v226, 8, v250
    v_mov_b32 v251, 1
    s_add_u32 s44, s54, -255
    s_mov_b64 exec, 15
    buffer_store_byte v251, v226, s[20:23], s44 offen sc1
    s_mov_b64 exec, -1
op52_nr1:
op52_q1:
    buffer_load_dword v226, off, s[20:23], s54 sc1
    s_waitcnt vmcnt(0)
    v_readfirstlane_b32 s40, v226
    s_nop 0
    s_cmp_eq_u32 s40, 0x01010101
    s_cbranch_scc1 op52_q1_ok
    s_sleep 4
    s_branch op52_q1
op52_q1_ok:
    s_add_u32 s94, s52, 131072
    s_add_u32 s95, s52, 196608
    s_add_u32 s96, s52, 229376
    buffer_load_dwordx4 v[100:103], v254, s[20:23], s94 offen offset:0 sc1
    buffer_load_dwordx4 v[104:107], v254, s[20:23], s95 offen offset:0 sc1
    buffer_load_dwordx4 v[108:111], v254, s[20:23], s96 offen offset:0 sc1
    buffer_load_dwordx4 v[112:115], v254, s[20:23], s94 offen offset:1024 sc1
    buffer_load_dwordx4 v[116:119], v254, s[20:23], s95 offen offset:1024 sc1
    buffer_load_dwordx4 v[120:123], v254, s[20:23], s96 offen offset:1024 sc1
    s_mov_b32 s99, 0xffff0000
    s_add_u32 s44, s53, 18432
    s_waitcnt vmcnt(3)
    v_lshlrev_b32 v251, 16, v100
    v_and_b32 v100, s99, v100
    v_lshlrev_b32 v252, 16, v101
    v_and_b32 v101, s99, v101
    v_add_f32 v4, v4, v251
    v_add_f32 v5, v5, v100
    v_add_f32 v6, v6, v252
    v_add_f32 v7, v7, v101
    v_lshlrev_b32 v251, 16, v104
    v_and_b32 v104, s99, v104
    v_lshlrev_b32 v252, 16, v105
    v_and_b32 v105, s99, v105
    v_add_f32 v4, v4, v251
    v_add_f32 v5, v5, v104
    v_add_f32 v6, v6, v252
    v_add_f32 v7, v7, v105
    v_lshlrev_b32 v251, 16, v108
    v_and_b32 v108, s99, v108
    v_lshlrev_b32 v252, 16, v109
    v_and_b32 v109, s99, v109
    v_add_f32 v4, v4, v251
    v_add_f32 v5, v5, v108
    v_add_f32 v6, v6, v252
    v_add_f32 v7, v7, v109
    v_cvt_pk_bf16_f32 v4, v4, v5
    v_cvt_pk_bf16_f32 v5, v6, v7
    buffer_store_dwordx2 v[4:5], v225, s[8:11], s44 offen
    s_add_u32 s44, s53, 32
    v_lshlrev_b32 v251, 16, v102
    v_and_b32 v102, s99, v102
    v_lshlrev_b32 v252, 16, v103
    v_and_b32 v103, s99, v103
    v_add_f32 v20, v20, v251
    v_add_f32 v21, v21, v102
    v_add_f32 v22, v22, v252
    v_add_f32 v23, v23, v103
    v_lshlrev_b32 v251, 16, v106
    v_and_b32 v106, s99, v106
    v_lshlrev_b32 v252, 16, v107
    v_and_b32 v107, s99, v107
    v_add_f32 v20, v20, v251
    v_add_f32 v21, v21, v106
    v_add_f32 v22, v22, v252
    v_add_f32 v23, v23, v107
    v_lshlrev_b32 v251, 16, v110
    v_and_b32 v110, s99, v110
    v_lshlrev_b32 v252, 16, v111
    v_and_b32 v111, s99, v111
    v_add_f32 v20, v20, v251
    v_add_f32 v21, v21, v110
    v_add_f32 v22, v22, v252
    v_add_f32 v23, v23, v111
    v_cvt_pk_bf16_f32 v20, v20, v21
    v_cvt_pk_bf16_f32 v21, v22, v23
    buffer_store_dwordx2 v[20:21], v225, s[8:11], s44 offen
    s_add_u32 s44, s53, 73760
    s_waitcnt vmcnt(2)
    v_lshlrev_b32 v251, 16, v112
    v_and_b32 v112, s99, v112
    v_lshlrev_b32 v252, 16, v113
    v_and_b32 v113, s99, v113
    v_add_f32 v36, v36, v251
    v_add_f32 v37, v37, v112
    v_add_f32 v38, v38, v252
    v_add_f32 v39, v39, v113
    v_lshlrev_b32 v251, 16, v116
    v_and_b32 v116, s99, v116
    v_lshlrev_b32 v252, 16, v117
    v_and_b32 v117, s99, v117
    v_add_f32 v36, v36, v251
    v_add_f32 v37, v37, v116
    v_add_f32 v38, v38, v252
    v_add_f32 v39, v39, v117
    v_lshlrev_b32 v251, 16, v120
    v_and_b32 v120, s99, v120
    v_lshlrev_b32 v252, 16, v121
    v_and_b32 v121, s99, v121
    v_add_f32 v36, v36, v251
    v_add_f32 v37, v37, v120
    v_add_f32 v38, v38, v252
    v_add_f32 v39, v39, v121
    v_cvt_pk_bf16_f32 v36, v36, v37
    v_cvt_pk_bf16_f32 v37, v38, v39
    buffer_store_dwordx2 v[36:37], v225, s[8:11], s44 offen
    s_branch attn_fin
op52_k2:
    s_nop 7
    s_add_u32 s44, s52, 65536
    v_cvt_pk_bf16_f32 v0, v0, v1
    v_cvt_pk_bf16_f32 v1, v2, v3
    v_cvt_pk_bf16_f32 v2, v16, v17
    v_cvt_pk_bf16_f32 v3, v18, v19
    buffer_store_dwordx4 v[0:3], v254, s[20:23], s44 offen offset:0 sc1
    v_cvt_pk_bf16_f32 v32, v32, v33
    v_cvt_pk_bf16_f32 v33, v34, v35
    buffer_store_dwordx4 v[32:35], v254, s[20:23], s44 offen offset:1024 sc1
    s_add_u32 s44, s52, 196608
    v_cvt_pk_bf16_f32 v4, v4, v5
    v_cvt_pk_bf16_f32 v5, v6, v7
    v_cvt_pk_bf16_f32 v6, v20, v21
    v_cvt_pk_bf16_f32 v7, v22, v23
    buffer_store_dwordx4 v[4:7], v254, s[20:23], s44 offen offset:0 sc1
    v_cvt_pk_bf16_f32 v36, v36, v37
    v_cvt_pk_bf16_f32 v37, v38, v39
    buffer_store_dwordx4 v[36:39], v254, s[20:23], s44 offen offset:1024 sc1
    s_add_u32 s44, s52, 458752
    v_cvt_pk_bf16_f32 v12, v12, v13
    v_cvt_pk_bf16_f32 v13, v14, v15
    v_cvt_pk_bf16_f32 v14, v28, v29
    v_cvt_pk_bf16_f32 v15, v30, v31
    buffer_store_dwordx4 v[12:15], v254, s[20:23], s44 offen offset:0 sc1
    s_waitcnt vmcnt(0)
    s_barrier
    s_cmp_lg_u32 s30, 0
    s_cbranch_scc1 op52_nr2
    v_lshlrev_b32 v226, 8, v250
    v_mov_b32 v251, 1
    s_add_u32 s44, s54, -510
    s_mov_b64 exec, 15
    buffer_store_byte v251, v226, s[20:23], s44 offen sc1
    s_mov_b64 exec, -1
op52_nr2:
op52_q2:
    buffer_load_dword v226, off, s[20:23], s54 sc1
    s_waitcnt vmcnt(0)
    v_readfirstlane_b32 s40, v226
    s_nop 0
    s_cmp_eq_u32 s40, 0x01010101
    s_cbranch_scc1 op52_q2_ok
    s_sleep 4
    s_branch op52_q2
op52_q2_ok:
    s_add_u32 s94, s52, 262144
    s_add_u32 s95, s52, 294912
    s_add_u32 s96, s52, 360448
    buffer_load_dwordx4 v[100:103], v254, s[20:23], s94 offen offset:0 sc1
    buffer_load_dwordx4 v[104:107], v254, s[20:23], s95 offen offset:0 sc1
    buffer_load_dwordx4 v[108:111], v254, s[20:23], s96 offen offset:0 sc1
    s_mov_b32 s99, 0xffff0000
    s_add_u32 s44, s53, 36864
    s_waitcnt vmcnt(0)
    v_lshlrev_b32 v251, 16, v100
    v_and_b32 v100, s99, v100
    v_lshlrev_b32 v252, 16, v101
    v_and_b32 v101, s99, v101
    v_add_f32 v8, v8, v251
    v_add_f32 v9, v9, v100
    v_add_f32 v10, v10, v252
    v_add_f32 v11, v11, v101
    v_lshlrev_b32 v251, 16, v104
    v_and_b32 v104, s99, v104
    v_lshlrev_b32 v252, 16, v105
    v_and_b32 v105, s99, v105
    v_add_f32 v8, v8, v251
    v_add_f32 v9, v9, v104
    v_add_f32 v10, v10, v252
    v_add_f32 v11, v11, v105
    v_lshlrev_b32 v251, 16, v108
    v_and_b32 v108, s99, v108
    v_lshlrev_b32 v252, 16, v109
    v_and_b32 v109, s99, v109
    v_add_f32 v8, v8, v251
    v_add_f32 v9, v9, v108
    v_add_f32 v10, v10, v252
    v_add_f32 v11, v11, v109
    v_cvt_pk_bf16_f32 v8, v8, v9
    v_cvt_pk_bf16_f32 v9, v10, v11
    buffer_store_dwordx2 v[8:9], v225, s[8:11], s44 offen
    s_add_u32 s44, s53, 18464
    v_lshlrev_b32 v251, 16, v102
    v_and_b32 v102, s99, v102
    v_lshlrev_b32 v252, 16, v103
    v_and_b32 v103, s99, v103
    v_add_f32 v24, v24, v251
    v_add_f32 v25, v25, v102
    v_add_f32 v26, v26, v252
    v_add_f32 v27, v27, v103
    v_lshlrev_b32 v251, 16, v106
    v_and_b32 v106, s99, v106
    v_lshlrev_b32 v252, 16, v107
    v_and_b32 v107, s99, v107
    v_add_f32 v24, v24, v251
    v_add_f32 v25, v25, v106
    v_add_f32 v26, v26, v252
    v_add_f32 v27, v27, v107
    v_lshlrev_b32 v251, 16, v110
    v_and_b32 v110, s99, v110
    v_lshlrev_b32 v252, 16, v111
    v_and_b32 v111, s99, v111
    v_add_f32 v24, v24, v251
    v_add_f32 v25, v25, v110
    v_add_f32 v26, v26, v252
    v_add_f32 v27, v27, v111
    v_cvt_pk_bf16_f32 v24, v24, v25
    v_cvt_pk_bf16_f32 v25, v26, v27
    buffer_store_dwordx2 v[24:25], v225, s[8:11], s44 offen
    s_branch attn_fin
attn_fin:
attn_end:
    s_endpgm
.section .rodata,"a"
.p2align 6
.amdhsa_kernel standalone__mha_block_cached__near_ridge_kernel
  .amdhsa_next_free_vgpr 256
  .amdhsa_next_free_sgpr 102
  .amdhsa_accum_offset 256
  .amdhsa_group_segment_fixed_size 0
  .amdhsa_kernarg_size 64
  .amdhsa_user_sgpr_count 2
  .amdhsa_user_sgpr_kernarg_segment_ptr 1
  .amdhsa_system_sgpr_workgroup_id_x 1
  .amdhsa_float_denorm_mode_32 3
.end_amdhsa_kernel
```
